```python
import torch

def _softmax(x, axis=-1):
    return torch.softmax(x, dim=axis)
def _gelu(x):
    return torch.nn.functional.gelu(x, approximate="tanh")
def _silu(x):
    return torch.nn.functional.silu(x)
def _sigmoid(x):
    return torch.sigmoid(x)
def _layernorm(x, axis=-1, eps=1e-5):
    m = x.mean(dim=axis, keepdim=True)
    v = x.var(dim=axis, keepdim=True, unbiased=False)
    return (x - m) / torch.sqrt(v + eps)
def _scatter_add(tgt, idx, src, axis=0):
    return tgt.clone().index_add_(axis, idx, src)
def _segment_sum(src, seg, n):
    out = torch.zeros((n,) + src.shape[1:], dtype=src.dtype)
    return out.index_add_(0, seg, src)
def _pad(x, pw):
    flat = tuple(v for pair in reversed(pw) for v in pair)
    return torch.nn.functional.pad(x, flat)

kernel_name = 'parallel_sum__mha_block__dense_activation_relu__prompt'

def setup_inputs():

    _w = (lambda a: (lambda t: t.to(torch.bfloat16) if t.is_floating_point() else t)(torch.as_tensor(a)))
    def _A_setup():
        B, S, D, H = 1, 2048, 512, 32
        return {
            "x": _w((lambda *s: torch.randn(*s, dtype=torch.bfloat16) * 0.05)(B, S, D)),
            "wqkv": _w((lambda *s: torch.randn(*s, dtype=torch.bfloat16) * 0.2)(D, 3 * D)),
            "wo": _w((lambda *s: torch.randn(*s, dtype=torch.bfloat16) * 0.1)(D, D)),
        }
    _A_in = _A_setup()

    def _B_setup():
        B, S, D, Dff = 1, 2048, 512, 1792
        return {
            "x": _w((lambda *s: torch.randn(*s, dtype=torch.bfloat16) * 0.05)(B, S, D)),
            "w1": _w((lambda *s: torch.randn(*s, dtype=torch.bfloat16) * 0.2)(D, Dff)),
            "w2": _w((lambda *s: torch.randn(*s, dtype=torch.bfloat16) * 0.2)(Dff, D)),
        }
    _B_in = _B_setup()

    return {
        "A_x": _A_in["x"],
        "A_wqkv": _A_in["wqkv"],
        "A_wo": _A_in["wo"],
        "B_x": _B_in["x"],
        "B_w1": _B_in["w1"],
        "B_w2": _B_in["w2"],
    }

def reference(A_x, A_wqkv, A_wo, B_x, B_w1, B_w2):
    def _A_ref(x, wqkv, wo):
        B, S, D = x.shape
        H = 32
        Dh = D // H
        qkv = (lambda x, *d: x.permute(*d))((x @ wqkv).reshape(B, S, 3, H, Dh), 2, 0, 3, 1, 4)
        q, k, v = qkv[0], qkv[1], qkv[2]
        scores = torch.einsum("bhqd,bhkd->bhqk", q, k) * (Dh ** -0.5)
        p = _softmax(scores, axis=-1)
        o = torch.einsum("bhqk,bhkd->bhqd", p, v)
        return (lambda x, *d: x.permute(*d))(o, 0, 2, 1, 3).reshape(B, S, D) @ wo

    def _B_ref(x, w1, w2):
        h = torch.einsum("bsd,df->bsf", x, w1)
        zero = torch.zeros_like(h)
        h = torch.maximum(h, zero)
        return torch.einsum("bsf,fd->bsd", h, w2)

    x = A_x
    xn = _layernorm(x, axis=-1)
    return x + _A_ref(xn, A_wqkv, A_wo) + _B_ref(xn, B_w1, B_w2)
```

```asm
; @launch kernel=k1_kernel grid=(256,1,1) block=(256,1,1) lds=153600
; @launch kernel=k2_kernel grid=(256,1,1) block=(768,1,1) lds=148496
.amdgcn_target "amdgcn-amd-amdhsa--gfx950"
.text
.macro ma d,a,b,c
 v_mfma_f32_16x16x32_bf16 a[\d:\d+3], v[\a:\a+3], v[\b:\b+3], a[\c:\c+3]
.endm
.macro mg d,x,a,y,b,c
 v_mfma_f32_16x16x32_bf16 v[\d:\d+3], \x[\a:\a+3], \y[\b:\b+3], v[\c:\c+3]
.endm
.macro mv d,a,b,c
 v_mfma_f32_16x16x32_bf16 v[\d:\d+3], v[\a:\a+3], v[\b:\b+3], v[\c:\c+3]
.endm
.macro mw d,a,b,c
 v_mfma_f32_32x32x16_bf16 v[\d:\d+15], v[\a:\a+3], v[\b:\b+3], v[\c:\c+15]
.endm
.macro tr d,a,o
 ds_read_b64_tr_b16 v[\d:\d+1], v\a offset:\o
.endm
.macro rq d,a,o
 ds_read_b128 v[\d:\d+3], v\a offset:\o
.endm
.macro ds d,a,c
 v_dot2_f32_bf16 v\d, v\a, s49, v\c
.endm
.macro dq d,a,b,c
 v_dot2_f32_bf16 v\d, v\a, v\b, v\c
.endm
.macro wl n
 s_waitcnt lgkmcnt(\n)
.endm
.macro ex d,a
 v_exp_f32 v\d, v\a
.endm
.macro pk d,a,b
 v_cvt_pk_bf16_f32 v\d, v\a, v\b
.endm
.macro ar d,a
 v_accvgpr_read_b32 v\d, a\a
.endm
.globl k1_kernel
.p2align 8
.type k1_kernel,@function
k1_kernel:
 s_cmp_ge_u32 s2, 256
 s_cbranch_scc1 K1_exit
 s_load_dwordx4 s[28:31], s[0:1], 0
 s_load_dwordx2 s[32:33], s[0:1], 16
 s_load_dwordx4 s[36:39], s[0:1], 32
 s_load_dwordx2 s[40:41], s[0:1], 64
 v_lshrrev_b32 v1, 6, v0
 s_nop 0
 v_readfirstlane_b32 s3, v1
 v_and_b32 v1, 63, v0
 v_lshrrev_b32 v2, 4, v1
 v_and_b32 v3, 15, v1
 s_and_b32 s42, s2, 3
 s_lshr_b32 s43, s2, 1
 s_and_b32 s43, s43, 12
 s_add_u32 s42, s42, s43
 s_lshr_b32 s43, s2, 5
 s_lshl_b32 s48, s2, 1
 s_and_b32 s48, s48, 8
 s_add_u32 s43, s43, s48
 s_lshl_b32 s45, s43, 7
 s_lshl_b32 s48, s3, 5
 s_add_u32 s45, s45, s48
 s_mov_b32 s49, 0x3f803f80
 s_lshl_b32 s51, s2, 2
 s_add_u32 s51, s51, s3
 v_lshlrev_b32 v4, 4, v1
wl 0
 s_mov_b32 s8, s28
 s_and_b32 s9, s29, 0xffff
 s_mov_b32 s10, 2097152
 s_mov_b32 s11, 0x00020000
 s_mov_b32 s16, s40
 s_and_b32 s17, s41, 0xffff
 s_mov_b32 s18, 25165824
 s_mov_b32 s19, 0x00020000
 v_mov_b32 v5, 0
 v_lshlrev_b32 v6, 2, v3
 s_lshl_b32 s48, s51, 6
 s_add_u32 s48, s48, 16777216
 buffer_store_dword v5, v6, s[16:19], s48 offen sc1
 s_lshr_b32 s48, s51, 3
 s_cmp_lt_u32 s48, 16
 s_mov_b32 s22, 1835008
 s_cselect_b32 s20, s32, s38
 s_cselect_b32 s21, s33, s39
 s_cselect_b32 s22, 524288, s22
 s_mov_b32 s23, 0x00020000
 s_cselect_b32 s52, 0, 16
 s_and_b32 s21, s21, 0xffff
 s_sub_u32 s48, s48, s52
 s_lshl_b32 s48, s48, 15
 s_and_b32 s52, s51, 7
 s_lshl_b32 s52, s52, 7
 s_add_u32 s57, s48, s52
 s_cmp_ge_u32 s42, 8
 s_cbranch_scc1 K1_isH
 s_mov_b32 s12, s30
 s_and_b32 s13, s31, 0xffff
 s_mov_b32 s14, 1572864
 s_mov_b32 s15, 0x00020000
 s_mul_i32 s44, s42, 192
 s_cmp_lt_u32 s42, 5
 s_cbranch_scc1 K1_QK
 s_cmp_eq_u32 s42, 5
 s_cbranch_scc1 K1_KV
 s_branch K1_VV
K1_isH:
 s_mov_b32 s12, s36
 s_and_b32 s13, s37, 0xffff
 s_mov_b32 s14, 1835008
 s_mov_b32 s15, 0x00020000
 s_sub_u32 s44, s42, 8
 s_mul_i32 s44, s44, 224
 s_add_u32 s55, s44, 192
 s_add_u32 s48, s44, 32
 s_bitcmp1_b32 s42, 0
 s_cselect_b32 s55, s44, s55
 s_cselect_b32 s44, s48, s44
 s_branch K1_HH
K1_exit:
 s_endpgm
K1_QK:
 s_lshl_b32 s47, s3, 14
 s_lshl_b32 s50, s45, 10
 v_lshrrev_b32 v14, 5, v1
 v_and_b32 v15, 31, v1
 v_xor_b32 v15, v15, v14
 v_lshlrev_b32 v15, 4, v15
 v_lshl_add_u32 v5, v14, 10, v15
 v_xor_b32 v14, 0, v5
 s_add_u32 m0, s47, 0
 s_nop 0
 buffer_load_dwordx4 v14, s[8:11], s50 offen lds
 s_add_u32 s50, s50, 2048
 v_xor_b32 v15, 32, v5
 s_add_u32 m0, s47, 1024
 s_nop 0
 buffer_load_dwordx4 v15, s[8:11], s50 offen lds
 s_add_u32 s50, s50, 2048
 v_xor_b32 v14, 64, v5
 s_add_u32 m0, s47, 2048
 s_nop 0
 buffer_load_dwordx4 v14, s[8:11], s50 offen lds
 s_add_u32 s50, s50, 2048
 v_xor_b32 v15, 96, v5
 s_add_u32 m0, s47, 3072
 s_nop 0
 buffer_load_dwordx4 v15, s[8:11], s50 offen lds
 s_add_u32 s50, s50, 2048
 v_xor_b32 v14, 128, v5
 s_add_u32 m0, s47, 4096
 s_nop 0
 buffer_load_dwordx4 v14, s[8:11], s50 offen lds
 s_add_u32 s50, s50, 2048
 v_xor_b32 v15, 160, v5
 s_add_u32 m0, s47, 5120
 s_nop 0
 buffer_load_dwordx4 v15, s[8:11], s50 offen lds
 s_add_u32 s50, s50, 2048
 v_xor_b32 v14, 192, v5
 s_add_u32 m0, s47, 6144
 s_nop 0
 buffer_load_dwordx4 v14, s[8:11], s50 offen lds
 s_add_u32 s50, s50, 2048
 v_xor_b32 v15, 224, v5
 s_add_u32 m0, s47, 7168
 s_nop 0
 buffer_load_dwordx4 v15, s[8:11], s50 offen lds
 s_add_u32 s50, s50, 2048
 v_xor_b32 v14, 0, v5
 s_add_u32 m0, s47, 8192
 s_nop 0
 buffer_load_dwordx4 v14, s[8:11], s50 offen lds
 s_add_u32 s50, s50, 2048
 v_xor_b32 v15, 32, v5
 s_add_u32 m0, s47, 9216
 s_nop 0
 buffer_load_dwordx4 v15, s[8:11], s50 offen lds
 s_add_u32 s50, s50, 2048
 v_xor_b32 v14, 64, v5
 s_add_u32 m0, s47, 10240
 s_nop 0
 buffer_load_dwordx4 v14, s[8:11], s50 offen lds
 s_add_u32 s50, s50, 2048
 v_xor_b32 v15, 96, v5
 s_add_u32 m0, s47, 11264
 s_nop 0
 buffer_load_dwordx4 v15, s[8:11], s50 offen lds
 s_add_u32 s50, s50, 2048
 v_xor_b32 v14, 128, v5
 s_add_u32 m0, s47, 12288
 s_nop 0
 buffer_load_dwordx4 v14, s[8:11], s50 offen lds
 s_add_u32 s50, s50, 2048
 v_xor_b32 v15, 160, v5
 s_add_u32 m0, s47, 13312
 s_nop 0
 buffer_load_dwordx4 v15, s[8:11], s50 offen lds
 s_add_u32 s50, s50, 2048
 v_xor_b32 v14, 192, v5
 s_add_u32 m0, s47, 14336
 s_nop 0
 buffer_load_dwordx4 v14, s[8:11], s50 offen lds
 s_add_u32 s50, s50, 2048
 v_xor_b32 v15, 224, v5
 s_add_u32 m0, s47, 15360
 s_nop 0
 buffer_load_dwordx4 v15, s[8:11], s50 offen lds
 s_add_u32 s50, s50, 2048
 s_sub_u32 s50, s50, 32256
 s_mov_b32 s48, 3072
 v_lshrrev_b32 v14, 3, v1
 v_mul_lo_u32 v15, v14, s48
 v_and_b32 v16, 7, v1
 v_and_b32 v17, 2, v14
 v_xor_b32 v16, v16, v17
 v_lshl_add_u32 v6, v16, 4, v15
 v_xor_b32 v16, 4, v16
 v_lshl_add_u32 v7, v16, 4, v15
 v_add_u32 v7, 24576, v7
 s_mul_i32 s46, s3, 49152
 s_lshl_b32 s48, s44, 1
 s_add_u32 s46, s46, s48
 s_mul_i32 s54, s3, 6144
 s_lshl_b32 s56, s3, 10
 s_add_u32 m0, s54, 65536
 s_nop 0
 buffer_load_dwordx4 v6, s[12:15], s46 offen offset:0 lds
 s_add_u32 m0, s54, 66432
 s_nop 0
 buffer_load_dwordx4 v6, s[12:15], s46 offen offset:128 lds
 s_add_u32 m0, s54, 67328
 s_nop 0
 buffer_load_dwordx4 v6, s[12:15], s46 offen offset:256 lds
 s_add_u32 m0, s54, 68608
 s_nop 0
 buffer_load_dwordx4 v7, s[12:15], s46 offen offset:0 lds
 s_add_u32 m0, s54, 69504
 s_nop 0
 buffer_load_dwordx4 v7, s[12:15], s46 offen offset:128 lds
 s_add_u32 m0, s54, 70400
 s_nop 0
 buffer_load_dwordx4 v7, s[12:15], s46 offen offset:256 lds
 s_add_u32 s46, s46, 196608
 v_lshlrev_b32 v14, 9, v3
 v_add_u32 v14, s47, v14
 v_or_b32 v15, 0, v2
 v_xor_b32 v15, v15, v3
 v_lshl_add_u32 v28, v15, 4, v14
 v_or_b32 v15, 4, v2
 v_xor_b32 v15, v15, v3
 v_lshl_add_u32 v29, v15, 4, v14
 v_or_b32 v15, 8, v2
 v_xor_b32 v15, v15, v3
 v_lshl_add_u32 v30, v15, 4, v14
 v_or_b32 v15, 12, v2
 v_xor_b32 v15, v15, v3
 v_lshl_add_u32 v31, v15, 4, v14
 v_bfe_u32 v14, v1, 2, 2
 v_and_b32 v15, 1, v1
 v_lshlrev_b32 v15, 3, v15
 v_bfe_u32 v16, v1, 1, 1
 v_lshl_add_u32 v15, v16, 4, v15
 v_lshrrev_b32 v16, 1, v14
 v_and_b32 v17, 1, v2
 v_lshl_add_u32 v16, v17, 1, v16
 s_movk_i32 s48, 3072
 v_mul_lo_u32 v18, v2, s48
 v_lshl_add_u32 v18, v14, 7, v18
 v_add_u32 v18, v18, v15
 s_xor_b32 s24, s3, 0
 s_xor_b32 s25, s3, 1
 s_xor_b32 s26, s3, 2
 s_xor_b32 s27, s3, 3
 v_xor_b32 v19, s24, v16
 v_lshl_add_u32 v19, v19, 5, v18
 v_add_u32 v52, 65536, v19
 v_add_u32 v56, 122880, v19
 v_xor_b32 v19, s25, v16
 v_lshl_add_u32 v19, v19, 5, v18
 v_add_u32 v53, 65536, v19
 v_add_u32 v57, 122880, v19
 v_xor_b32 v19, s26, v16
 v_lshl_add_u32 v19, v19, 5, v18
 v_add_u32 v54, 65536, v19
 v_add_u32 v58, 122880, v19
 v_xor_b32 v19, s27, v16
 v_lshl_add_u32 v19, v19, 5, v18
 v_add_u32 v55, 65536, v19
 v_add_u32 v59, 122880, v19
 v_mov_b32 v48, s49
 v_mov_b32 v49, s49
 v_mov_b32 v50, s49
 v_mov_b32 v51, s49
 s_waitcnt vmcnt(6)
 ds_read_b128 a[0:3], v28 offset:0
 ds_read_b128 a[4:7], v29 offset:0
 ds_read_b128 a[8:11], v30 offset:0
 ds_read_b128 a[12:15], v31 offset:0
 ds_read_b128 a[16:19], v28 offset:256
 ds_read_b128 a[20:23], v29 offset:256
 ds_read_b128 a[24:27], v30 offset:256
 ds_read_b128 a[28:31], v31 offset:256
 ds_read_b128 a[64:67], v28 offset:8192
 ds_read_b128 a[68:71], v29 offset:8192
 ds_read_b128 a[72:75], v30 offset:8192
 ds_read_b128 a[76:79], v31 offset:8192
 ds_read_b128 a[80:83], v28 offset:8448
 ds_read_b128 a[84:87], v29 offset:8448
 ds_read_b128 a[88:91], v30 offset:8448
 ds_read_b128 a[92:95], v31 offset:8448
 s_add_u32 m0, s54, 94208
 s_nop 0
 buffer_load_dwordx4 v6, s[12:15], s46 offen offset:0 lds
 s_add_u32 m0, s54, 95104
 s_nop 0
 buffer_load_dwordx4 v6, s[12:15], s46 offen offset:128 lds
 s_add_u32 m0, s54, 96000
 s_nop 0
 buffer_load_dwordx4 v6, s[12:15], s46 offen offset:256 lds
 s_add_u32 m0, s54, 97280
 s_nop 0
 buffer_load_dwordx4 v7, s[12:15], s46 offen offset:0 lds
 s_add_u32 m0, s54, 98176
 s_nop 0
 buffer_load_dwordx4 v7, s[12:15], s46 offen offset:128 lds
 s_add_u32 m0, s54, 99072
 s_nop 0
 buffer_load_dwordx4 v7, s[12:15], s46 offen offset:256 lds
 s_add_u32 s46, s46, 196608
 s_waitcnt vmcnt(6) lgkmcnt(0)
 s_barrier
tr 208,52,0
tr 210,52,512
tr 212,53,0
tr 214,53,512
tr 216,54,0
tr 218,54,512
tr 220,55,0
tr 222,55,512
tr 224,52,1024
tr 226,52,1536
tr 228,53,1024
tr 230,53,1536
tr 232,54,1024
tr 234,54,1536
wl 10
 v_mfma_f32_16x16x32_bf16 v[64:67], v[208:211], a[0:3], 0
 s_add_u32 m0, s54, 122880
 s_nop 0
 buffer_load_dwordx4 v6, s[12:15], s46 offen offset:0 lds
 v_mfma_f32_16x16x32_bf16 v[68:71], v[208:211], a[64:67], 0
 s_add_u32 m0, s54, 123776
 s_nop 0
 buffer_load_dwordx4 v6, s[12:15], s46 offen offset:128 lds
 v_mfma_f32_16x16x32_bf16 v[176:179], v[208:211], v[48:51], 0
tr 236,55,1024
tr 238,55,1536
 v_mfma_f32_16x16x32_bf16 v[72:75], v[212:215], a[0:3], 0
 s_add_u32 m0, s54, 124672
 s_nop 0
 buffer_load_dwordx4 v6, s[12:15], s46 offen offset:256 lds
 v_mfma_f32_16x16x32_bf16 v[76:79], v[212:215], a[64:67], 0
 s_add_u32 m0, s54, 125952
 s_nop 0
 buffer_load_dwordx4 v7, s[12:15], s46 offen offset:0 lds
 v_mfma_f32_16x16x32_bf16 v[32:35], v[48:51], a[0:3], 0
tr 208,52,2048
tr 210,52,2560
wl 10
 v_mfma_f32_16x16x32_bf16 v[80:83], v[216:219], a[0:3], 0
 s_add_u32 m0, s54, 126848
 s_nop 0
 buffer_load_dwordx4 v7, s[12:15], s46 offen offset:128 lds
 v_mfma_f32_16x16x32_bf16 v[84:87], v[216:219], a[64:67], 0
 s_add_u32 m0, s54, 127744
 s_nop 0
 buffer_load_dwordx4 v7, s[12:15], s46 offen offset:256 lds
 s_add_u32 s46, s46, 196608
tr 212,53,2048
tr 214,53,2560
 v_mfma_f32_16x16x32_bf16 v[88:91], v[220:223], a[0:3], 0
 v_xor_b32 v14, 0, v5
 s_add_u32 m0, s47, 0
 s_nop 0
 buffer_load_dwordx4 v14, s[8:11], s50 offen lds
 s_add_u32 s50, s50, 2048
 v_mfma_f32_16x16x32_bf16 v[92:95], v[220:223], a[64:67], 0
 v_xor_b32 v15, 32, v5
 s_add_u32 m0, s47, 1024
 s_nop 0
 buffer_load_dwordx4 v15, s[8:11], s50 offen lds
 s_add_u32 s50, s50, 2048
tr 216,54,2048
tr 218,54,2560
wl 10
 v_mfma_f32_16x16x32_bf16 v[96:99], v[224:227], a[0:3], 0
 v_xor_b32 v14, 64, v5
 s_add_u32 m0, s47, 2048
 s_nop 0
 buffer_load_dwordx4 v14, s[8:11], s50 offen lds
 s_add_u32 s50, s50, 2048
 v_mfma_f32_16x16x32_bf16 v[100:103], v[224:227], a[64:67], 0
 v_mfma_f32_16x16x32_bf16 v[36:39], v[48:51], a[64:67], 0
 v_mfma_f32_16x16x32_bf16 v[180:183], v[224:227], v[48:51], 0
tr 220,55,2048
tr 222,55,2560
 v_mfma_f32_16x16x32_bf16 v[104:107], v[228:231], a[0:3], 0
 v_xor_b32 v15, 96, v5
 s_add_u32 m0, s47, 3072
 s_nop 0
 buffer_load_dwordx4 v15, s[8:11], s50 offen lds
 s_add_u32 s50, s50, 2048
 v_mfma_f32_16x16x32_bf16 v[108:111], v[228:231], a[64:67], 0
tr 224,52,12288
tr 226,52,12800
wl 10
 v_mfma_f32_16x16x32_bf16 v[112:115], v[232:235], a[0:3], 0
 v_xor_b32 v14, 128, v5
 s_add_u32 m0, s47, 4096
 s_nop 0
 buffer_load_dwordx4 v14, s[8:11], s50 offen lds
 s_add_u32 s50, s50, 2048
 v_mfma_f32_16x16x32_bf16 v[116:119], v[232:235], a[64:67], 0
tr 228,53,12288
tr 230,53,12800
 v_mfma_f32_16x16x32_bf16 v[120:123], v[236:239], a[0:3], 0
 v_xor_b32 v15, 160, v5
 s_add_u32 m0, s47, 5120
 s_nop 0
 buffer_load_dwordx4 v15, s[8:11], s50 offen lds
 s_add_u32 s50, s50, 2048
 v_mfma_f32_16x16x32_bf16 v[124:127], v[236:239], a[64:67], 0
 v_mfma_f32_16x16x32_bf16 v[40:43], a[0:3], a[0:3], 0
tr 232,54,12288
tr 234,54,12800
wl 10
 v_mfma_f32_16x16x32_bf16 v[128:131], v[208:211], a[0:3], 0
 v_xor_b32 v14, 192, v5
 s_add_u32 m0, s47, 6144
 s_nop 0
 buffer_load_dwordx4 v14, s[8:11], s50 offen lds
 s_add_u32 s50, s50, 2048
 v_mfma_f32_16x16x32_bf16 v[132:135], v[208:211], a[64:67], 0
 v_mfma_f32_16x16x32_bf16 v[184:187], v[208:211], v[48:51], 0
tr 236,55,12288
tr 238,55,12800
 v_mfma_f32_16x16x32_bf16 v[136:139], v[212:215], a[0:3], 0
 v_xor_b32 v15, 224, v5
 s_add_u32 m0, s47, 7168
 s_nop 0
 buffer_load_dwordx4 v15, s[8:11], s50 offen lds
 s_add_u32 s50, s50, 2048
 v_mfma_f32_16x16x32_bf16 v[140:143], v[212:215], a[64:67], 0
tr 208,52,13312
tr 210,52,13824
wl 10
 v_mfma_f32_16x16x32_bf16 v[144:147], v[216:219], a[0:3], 0
 v_xor_b32 v14, 0, v5
 s_add_u32 m0, s47, 8192
 s_nop 0
 buffer_load_dwordx4 v14, s[8:11], s50 offen lds
 s_add_u32 s50, s50, 2048
 v_mfma_f32_16x16x32_bf16 v[148:151], v[216:219], a[64:67], 0
 v_mfma_f32_16x16x32_bf16 v[44:47], a[64:67], a[64:67], 0
tr 212,53,13312
tr 214,53,13824
 v_mfma_f32_16x16x32_bf16 v[152:155], v[220:223], a[0:3], 0
 v_xor_b32 v15, 32, v5
 s_add_u32 m0, s47, 9216
 s_nop 0
 buffer_load_dwordx4 v15, s[8:11], s50 offen lds
 s_add_u32 s50, s50, 2048
 v_mfma_f32_16x16x32_bf16 v[156:159], v[220:223], a[64:67], 0
tr 216,54,13312
tr 218,54,13824
wl 10
mg 64,v,224,a,4,64
 v_xor_b32 v14, 64, v5
 s_add_u32 m0, s47, 10240
 s_nop 0
 buffer_load_dwordx4 v14, s[8:11], s50 offen lds
 s_add_u32 s50, s50, 2048
mg 68,v,224,a,68,68
mg 176,v,224,v,48,176
tr 220,55,13312
tr 222,55,13824
mg 72,v,228,a,4,72
 v_xor_b32 v15, 96, v5
 s_add_u32 m0, s47, 11264
 s_nop 0
 buffer_load_dwordx4 v15, s[8:11], s50 offen lds
 s_add_u32 s50, s50, 2048
mg 76,v,228,a,68,76
mg 32,v,48,a,4,32
tr 224,52,14336
tr 226,52,14848
wl 10
mg 80,v,232,a,4,80
 v_xor_b32 v14, 128, v5
 s_add_u32 m0, s47, 12288
 s_nop 0
 buffer_load_dwordx4 v14, s[8:11], s50 offen lds
 s_add_u32 s50, s50, 2048
mg 84,v,232,a,68,84
tr 228,53,14336
tr 230,53,14848
mg 88,v,236,a,4,88
 v_xor_b32 v15, 160, v5
 s_add_u32 m0, s47, 13312
 s_nop 0
 buffer_load_dwordx4 v15, s[8:11], s50 offen lds
 s_add_u32 s50, s50, 2048
mg 92,v,236,a,68,92
tr 232,54,14336
tr 234,54,14848
wl 10
mg 96,v,208,a,4,96
 v_xor_b32 v14, 192, v5
 s_add_u32 m0, s47, 14336
 s_nop 0
 buffer_load_dwordx4 v14, s[8:11], s50 offen lds
 s_add_u32 s50, s50, 2048
mg 100,v,208,a,68,100
mg 36,v,48,a,68,36
mg 180,v,208,v,48,180
tr 236,55,14336
tr 238,55,14848
mg 104,v,212,a,4,104
 v_xor_b32 v15, 224, v5
 s_add_u32 m0, s47, 15360
 s_nop 0
 buffer_load_dwordx4 v15, s[8:11], s50 offen lds
 s_add_u32 s50, s50, 2048
 s_sub_u32 s50, s50, 32256
mg 108,v,212,a,68,108
 s_waitcnt vmcnt(22) lgkmcnt(0)
 s_barrier
 s_add_u32 m0, s54, 65536
 s_nop 0
 buffer_load_dwordx4 v6, s[12:15], s46 offen offset:0 lds
 s_add_u32 m0, s54, 66432
 s_nop 0
 buffer_load_dwordx4 v6, s[12:15], s46 offen offset:128 lds
 s_add_u32 m0, s54, 67328
 s_nop 0
 buffer_load_dwordx4 v6, s[12:15], s46 offen offset:256 lds
 s_add_u32 m0, s54, 68608
 s_nop 0
 buffer_load_dwordx4 v7, s[12:15], s46 offen offset:0 lds
 s_add_u32 m0, s54, 69504
 s_nop 0
 buffer_load_dwordx4 v7, s[12:15], s46 offen offset:128 lds
 s_add_u32 m0, s54, 70400
 s_nop 0
 buffer_load_dwordx4 v7, s[12:15], s46 offen offset:256 lds
 s_add_u32 s46, s46, 196608
tr 208,52,28672
tr 210,52,29184
wl 10
mg 112,v,216,a,4,112
mg 116,v,216,a,68,116
tr 212,53,28672
tr 214,53,29184
mg 120,v,220,a,4,120
mg 124,v,220,a,68,124
mg 40,a,4,a,4,40
tr 216,54,28672
tr 218,54,29184
wl 10
mg 128,v,224,a,4,128
mg 132,v,224,a,68,132
mg 184,v,224,v,48,184
tr 220,55,28672
tr 222,55,29184
mg 136,v,228,a,4,136
mg 140,v,228,a,68,140
tr 224,52,29696
tr 226,52,30208
wl 10
mg 144,v,232,a,4,144
mg 148,v,232,a,68,148
mg 44,a,68,a,68,44
tr 228,53,29696
tr 230,53,30208
mg 152,v,236,a,4,152
mg 156,v,236,a,68,156
tr 232,54,29696
tr 234,54,30208
wl 10
mg 64,v,208,a,8,64
mg 68,v,208,a,72,68
mg 176,v,208,v,48,176
tr 236,55,29696
tr 238,55,30208
mg 72,v,212,a,8,72
mg 76,v,212,a,72,76
mg 32,v,48,a,8,32
tr 208,52,30720
tr 210,52,31232
wl 10
mg 80,v,216,a,8,80
mg 84,v,216,a,72,84
tr 212,53,30720
tr 214,53,31232
mg 88,v,220,a,8,88
mg 92,v,220,a,72,92
tr 216,54,30720
tr 218,54,31232
wl 10
mg 96,v,224,a,8,96
mg 100,v,224,a,72,100
mg 36,v,48,a,72,36
mg 180,v,224,v,48,180
tr 220,55,30720
tr 222,55,31232
mg 104,v,228,a,8,104
mg 108,v,228,a,72,108
tr 224,52,40960
tr 226,52,41472
wl 10
mg 112,v,232,a,8,112
mg 116,v,232,a,72,116
tr 228,53,40960
tr 230,53,41472
mg 120,v,236,a,8,120
mg 124,v,236,a,72,124
mg 40,a,8,a,8,40
tr 232,54,40960
tr 234,54,41472
wl 10
mg 128,v,208,a,8,128
mg 132,v,208,a,72,132
mg 184,v,208,v,48,184
tr 236,55,40960
tr 238,55,41472
mg 136,v,212,a,8,136
mg 140,v,212,a,72,140
tr 208,52,41984
tr 210,52,42496
wl 10
mg 144,v,216,a,8,144
mg 148,v,216,a,72,148
mg 44,a,72,a,72,44
tr 212,53,41984
tr 214,53,42496
mg 152,v,220,a,8,152
mg 156,v,220,a,72,156
tr 216,54,41984
tr 218,54,42496
wl 10
mg 64,v,224,a,12,64
mg 68,v,224,a,76,68
mg 176,v,224,v,48,176
tr 220,55,41984
tr 222,55,42496
mg 72,v,228,a,12,72
mg 76,v,228,a,76,76
mg 32,v,48,a,12,32
tr 224,52,43008
tr 226,52,43520
wl 10
mg 80,v,232,a,12,80
mg 84,v,232,a,76,84
tr 228,53,43008
tr 230,53,43520
mg 88,v,236,a,12,88
mg 92,v,236,a,76,92
tr 232,54,43008
tr 234,54,43520
wl 10
mg 96,v,208,a,12,96
mg 100,v,208,a,76,100
mg 36,v,48,a,76,36
mg 180,v,208,v,48,180
tr 236,55,43008
tr 238,55,43520
mg 104,v,212,a,12,104
mg 108,v,212,a,76,108
 s_waitcnt vmcnt(22) lgkmcnt(0)
 s_barrier
 s_add_u32 m0, s54, 94208
 s_nop 0
 buffer_load_dwordx4 v6, s[12:15], s46 offen offset:0 lds
 s_add_u32 m0, s54, 95104
 s_nop 0
 buffer_load_dwordx4 v6, s[12:15], s46 offen offset:128 lds
 s_add_u32 m0, s54, 96000
 s_nop 0
 buffer_load_dwordx4 v6, s[12:15], s46 offen offset:256 lds
 s_add_u32 m0, s54, 97280
 s_nop 0
 buffer_load_dwordx4 v7, s[12:15], s46 offen offset:0 lds
 s_add_u32 m0, s54, 98176
 s_nop 0
 buffer_load_dwordx4 v7, s[12:15], s46 offen offset:128 lds
 s_add_u32 m0, s54, 99072
 s_nop 0
 buffer_load_dwordx4 v7, s[12:15], s46 offen offset:256 lds
 s_add_u32 s46, s46, 196608
tr 208,56,0
tr 210,56,512
wl 10
mg 112,v,216,a,12,112
mg 116,v,216,a,76,116
tr 212,57,0
tr 214,57,512
mg 120,v,220,a,12,120
mg 124,v,220,a,76,124
mg 40,a,12,a,12,40
tr 216,58,0
tr 218,58,512
wl 10
mg 128,v,224,a,12,128
mg 132,v,224,a,76,132
mg 184,v,224,v,48,184
tr 220,59,0
tr 222,59,512
mg 136,v,228,a,12,136
mg 140,v,228,a,76,140
tr 224,56,1024
tr 226,56,1536
wl 10
mg 144,v,232,a,12,144
mg 148,v,232,a,76,148
mg 44,a,76,a,76,44
tr 228,57,1024
tr 230,57,1536
mg 152,v,236,a,12,152
mg 156,v,236,a,76,156
tr 232,58,1024
tr 234,58,1536
wl 10
mg 64,v,208,a,16,64
mg 68,v,208,a,80,68
mg 176,v,208,v,48,176
tr 236,59,1024
tr 238,59,1536
mg 72,v,212,a,16,72
mg 76,v,212,a,80,76
mg 32,v,48,a,16,32
tr 208,56,2048
tr 210,56,2560
wl 10
mg 80,v,216,a,16,80
mg 84,v,216,a,80,84
tr 212,57,2048
tr 214,57,2560
mg 88,v,220,a,16,88
mg 92,v,220,a,80,92
tr 216,58,2048
tr 218,58,2560
wl 10
mg 96,v,224,a,16,96
mg 100,v,224,a,80,100
mg 36,v,48,a,80,36
mg 180,v,224,v,48,180
tr 220,59,2048
tr 222,59,2560
mg 104,v,228,a,16,104
mg 108,v,228,a,80,108
tr 224,56,12288
tr 226,56,12800
wl 10
mg 112,v,232,a,16,112
mg 116,v,232,a,80,116
tr 228,57,12288
tr 230,57,12800
mg 120,v,236,a,16,120
mg 124,v,236,a,80,124
mg 40,a,16,a,16,40
tr 232,58,12288
tr 234,58,12800
wl 10
mg 128,v,208,a,16,128
mg 132,v,208,a,80,132
mg 184,v,208,v,48,184
tr 236,59,12288
tr 238,59,12800
mg 136,v,212,a,16,136
mg 140,v,212,a,80,140
tr 208,56,13312
tr 210,56,13824
wl 10
mg 144,v,216,a,16,144
mg 148,v,216,a,80,148
mg 44,a,80,a,80,44
tr 212,57,13312
tr 214,57,13824
mg 152,v,220,a,16,152
mg 156,v,220,a,80,156
tr 216,58,13312
tr 218,58,13824
wl 10
mg 64,v,224,a,20,64
mg 68,v,224,a,84,68
mg 176,v,224,v,48,176
tr 220,59,13312
tr 222,59,13824
mg 72,v,228,a,20,72
mg 76,v,228,a,84,76
mg 32,v,48,a,20,32
tr 224,56,14336
tr 226,56,14848
wl 10
mg 80,v,232,a,20,80
mg 84,v,232,a,84,84
tr 228,57,14336
tr 230,57,14848
mg 88,v,236,a,20,88
mg 92,v,236,a,84,92
tr 232,58,14336
tr 234,58,14848
wl 10
mg 96,v,208,a,20,96
mg 100,v,208,a,84,100
mg 36,v,48,a,84,36
mg 180,v,208,v,48,180
tr 236,59,14336
tr 238,59,14848
mg 104,v,212,a,20,104
mg 108,v,212,a,84,108
 s_waitcnt vmcnt(6) lgkmcnt(0)
 s_barrier
 s_add_u32 m0, s54, 122880
 s_nop 0
 buffer_load_dwordx4 v6, s[12:15], s46 offen offset:0 lds
 s_add_u32 m0, s54, 123776
 s_nop 0
 buffer_load_dwordx4 v6, s[12:15], s46 offen offset:128 lds
 s_add_u32 m0, s54, 124672
 s_nop 0
 buffer_load_dwordx4 v6, s[12:15], s46 offen offset:256 lds
 s_add_u32 m0, s54, 125952
 s_nop 0
 buffer_load_dwordx4 v7, s[12:15], s46 offen offset:0 lds
 s_add_u32 m0, s54, 126848
 s_nop 0
 buffer_load_dwordx4 v7, s[12:15], s46 offen offset:128 lds
 s_add_u32 m0, s54, 127744
 s_nop 0
 buffer_load_dwordx4 v7, s[12:15], s46 offen offset:256 lds
 s_add_u32 s46, s46, 196608
 ds_read_b128 a[32:35], v28 offset:0
 ds_read_b128 a[36:39], v29 offset:0
 ds_read_b128 a[40:43], v30 offset:0
 ds_read_b128 a[44:47], v31 offset:0
 ds_read_b128 a[48:51], v28 offset:256
 ds_read_b128 a[52:55], v29 offset:256
 ds_read_b128 a[56:59], v30 offset:256
 ds_read_b128 a[60:63], v31 offset:256
 ds_read_b128 a[96:99], v28 offset:8192
 ds_read_b128 a[100:103], v29 offset:8192
 ds_read_b128 a[104:107], v30 offset:8192
 ds_read_b128 a[108:111], v31 offset:8192
 ds_read_b128 a[112:115], v28 offset:8448
 ds_read_b128 a[116:119], v29 offset:8448
 ds_read_b128 a[120:123], v30 offset:8448
 ds_read_b128 a[124:127], v31 offset:8448
tr 208,52,0
tr 210,52,512
wl 10
mg 112,v,216,a,20,112
mg 116,v,216,a,84,116
tr 212,53,0
tr 214,53,512
mg 120,v,220,a,20,120
mg 124,v,220,a,84,124
mg 40,a,20,a,20,40
tr 216,54,0
tr 218,54,512
wl 10
mg 128,v,224,a,20,128
mg 132,v,224,a,84,132
mg 184,v,224,v,48,184
tr 220,55,0
tr 222,55,512
mg 136,v,228,a,20,136
mg 140,v,228,a,84,140
tr 224,52,1024
tr 226,52,1536
wl 10
mg 144,v,232,a,20,144
mg 148,v,232,a,84,148
mg 44,a,84,a,84,44
tr 228,53,1024
tr 230,53,1536
mg 152,v,236,a,20,152
mg 156,v,236,a,84,156
tr 232,54,1024
tr 234,54,1536
wl 10
mg 64,v,208,a,24,64
mg 68,v,208,a,88,68
mg 176,v,208,v,48,176
tr 236,55,1024
tr 238,55,1536
mg 72,v,212,a,24,72
mg 76,v,212,a,88,76
mg 32,v,48,a,24,32
tr 208,52,2048
tr 210,52,2560
wl 10
mg 80,v,216,a,24,80
mg 84,v,216,a,88,84
tr 212,53,2048
tr 214,53,2560
mg 88,v,220,a,24,88
mg 92,v,220,a,88,92
tr 216,54,2048
tr 218,54,2560
wl 10
mg 96,v,224,a,24,96
mg 100,v,224,a,88,100
mg 36,v,48,a,88,36
mg 180,v,224,v,48,180
tr 220,55,2048
tr 222,55,2560
mg 104,v,228,a,24,104
mg 108,v,228,a,88,108
tr 224,52,12288
tr 226,52,12800
wl 10
mg 112,v,232,a,24,112
mg 116,v,232,a,88,116
tr 228,53,12288
tr 230,53,12800
mg 120,v,236,a,24,120
mg 124,v,236,a,88,124
mg 40,a,24,a,24,40
tr 232,54,12288
tr 234,54,12800
wl 10
mg 128,v,208,a,24,128
mg 132,v,208,a,88,132
mg 184,v,208,v,48,184
tr 236,55,12288
tr 238,55,12800
mg 136,v,212,a,24,136
mg 140,v,212,a,88,140
tr 208,52,13312
tr 210,52,13824
wl 10
mg 144,v,216,a,24,144
mg 148,v,216,a,88,148
mg 44,a,88,a,88,44
tr 212,53,13312
tr 214,53,13824
mg 152,v,220,a,24,152
mg 156,v,220,a,88,156
tr 216,54,13312
tr 218,54,13824
wl 10
mg 64,v,224,a,28,64
mg 68,v,224,a,92,68
mg 176,v,224,v,48,176
tr 220,55,13312
tr 222,55,13824
mg 72,v,228,a,28,72
mg 76,v,228,a,92,76
mg 32,v,48,a,28,32
tr 224,52,14336
tr 226,52,14848
wl 10
mg 80,v,232,a,28,80
mg 84,v,232,a,92,84
tr 228,53,14336
tr 230,53,14848
mg 88,v,236,a,28,88
mg 92,v,236,a,92,92
tr 232,54,14336
tr 234,54,14848
wl 10
mg 96,v,208,a,28,96
mg 100,v,208,a,92,100
mg 36,v,48,a,92,36
mg 180,v,208,v,48,180
tr 236,55,14336
tr 238,55,14848
mg 104,v,212,a,28,104
mg 108,v,212,a,92,108
 s_waitcnt vmcnt(6) lgkmcnt(0)
 s_barrier
 s_cmp_ge_u32 s51, 576
 s_cbranch_scc1 K1_QK_nojob0
 v_lshrrev_b32 v22, 3, v1
 v_and_b32 v23, 7, v1
 v_and_b32 v24, 2, v22
 v_xor_b32 v23, v23, v24
 v_lshlrev_b32 v22, 10, v22
 v_lshl_add_u32 v24, v23, 4, v22
 v_xor_b32 v23, 4, v23
 v_lshl_add_u32 v25, v23, 4, v22
 s_add_u32 m0, s47, 0
 s_nop 0
 buffer_load_dwordx4 v24, s[20:23], s57 offen lds
 s_add_u32 s57, s57, 8192
 s_add_u32 m0, s47, 1024
 s_nop 0
 buffer_load_dwordx4 v25, s[20:23], s57 offen lds
 s_add_u32 s57, s57, 8192
 s_add_u32 m0, s47, 2048
 s_nop 0
 buffer_load_dwordx4 v24, s[20:23], s57 offen lds
 s_add_u32 s57, s57, 8192
 s_add_u32 m0, s47, 3072
 s_nop 0
 buffer_load_dwordx4 v25, s[20:23], s57 offen lds
 s_add_u32 s57, s57, 8192
K1_QK_nojob0:
 s_add_u32 m0, s54, 65536
 s_nop 0
 buffer_load_dwordx4 v6, s[12:15], s46 offen offset:0 lds
 s_add_u32 m0, s54, 66432
 s_nop 0
 buffer_load_dwordx4 v6, s[12:15], s46 offen offset:128 lds
 s_add_u32 m0, s54, 67328
 s_nop 0
 buffer_load_dwordx4 v6, s[12:15], s46 offen offset:256 lds
 s_add_u32 m0, s54, 68608
 s_nop 0
 buffer_load_dwordx4 v7, s[12:15], s46 offen offset:0 lds
 s_add_u32 m0, s54, 69504
 s_nop 0
 buffer_load_dwordx4 v7, s[12:15], s46 offen offset:128 lds
 s_add_u32 m0, s54, 70400
 s_nop 0
 buffer_load_dwordx4 v7, s[12:15], s46 offen offset:256 lds
 s_add_u32 s46, s46, 196608
tr 208,52,28672
tr 210,52,29184
wl 10
mg 112,v,216,a,28,112
mg 116,v,216,a,92,116
tr 212,53,28672
tr 214,53,29184
mg 120,v,220,a,28,120
mg 124,v,220,a,92,124
mg 40,a,28,a,28,40
tr 216,54,28672
tr 218,54,29184
wl 10
mg 128,v,224,a,28,128
mg 132,v,224,a,92,132
mg 184,v,224,v,48,184
tr 220,55,28672
tr 222,55,29184
mg 136,v,228,a,28,136
mg 140,v,228,a,92,140
tr 224,52,29696
tr 226,52,30208
wl 10
mg 144,v,232,a,28,144
mg 148,v,232,a,92,148
mg 44,a,92,a,92,44
tr 228,53,29696
tr 230,53,30208
mg 152,v,236,a,28,152
mg 156,v,236,a,92,156
tr 232,54,29696
tr 234,54,30208
wl 10
mg 64,v,208,a,32,64
mg 68,v,208,a,96,68
mg 176,v,208,v,48,176
tr 236,55,29696
tr 238,55,30208
mg 72,v,212,a,32,72
mg 76,v,212,a,96,76
mg 32,v,48,a,32,32
tr 208,52,30720
tr 210,52,31232
wl 10
mg 80,v,216,a,32,80
mg 84,v,216,a,96,84
tr 212,53,30720
tr 214,53,31232
mg 88,v,220,a,32,88
mg 92,v,220,a,96,92
tr 216,54,30720
tr 218,54,31232
wl 10
mg 96,v,224,a,32,96
mg 100,v,224,a,96,100
mg 36,v,48,a,96,36
mg 180,v,224,v,48,180
tr 220,55,30720
tr 222,55,31232
mg 104,v,228,a,32,104
mg 108,v,228,a,96,108
tr 224,52,40960
tr 226,52,41472
wl 10
mg 112,v,232,a,32,112
mg 116,v,232,a,96,116
tr 228,53,40960
tr 230,53,41472
mg 120,v,236,a,32,120
mg 124,v,236,a,96,124
mg 40,a,32,a,32,40
tr 232,54,40960
tr 234,54,41472
wl 10
mg 128,v,208,a,32,128
mg 132,v,208,a,96,132
mg 184,v,208,v,48,184
tr 236,55,40960
tr 238,55,41472
mg 136,v,212,a,32,136
mg 140,v,212,a,96,140
tr 208,52,41984
tr 210,52,42496
wl 10
mg 144,v,216,a,32,144
mg 148,v,216,a,96,148
mg 44,a,96,a,96,44
tr 212,53,41984
tr 214,53,42496
mg 152,v,220,a,32,152
mg 156,v,220,a,96,156
tr 216,54,41984
tr 218,54,42496
wl 10
mg 64,v,224,a,36,64
mg 68,v,224,a,100,68
mg 176,v,224,v,48,176
tr 220,55,41984
tr 222,55,42496
mg 72,v,228,a,36,72
mg 76,v,228,a,100,76
mg 32,v,48,a,36,32
tr 224,52,43008
tr 226,52,43520
wl 10
mg 80,v,232,a,36,80
mg 84,v,232,a,100,84
tr 228,53,43008
tr 230,53,43520
mg 88,v,236,a,36,88
mg 92,v,236,a,100,92
tr 232,54,43008
tr 234,54,43520
wl 10
mg 96,v,208,a,36,96
mg 100,v,208,a,100,100
mg 36,v,48,a,100,36
mg 180,v,208,v,48,180
tr 236,55,43008
tr 238,55,43520
mg 104,v,212,a,36,104
mg 108,v,212,a,100,108
 s_waitcnt vmcnt(6) lgkmcnt(0)
 s_barrier
 s_add_u32 m0, s54, 94208
 s_nop 0
 buffer_load_dwordx4 v6, s[12:15], s46 offen offset:0 lds
 s_add_u32 m0, s54, 95104
 s_nop 0
 buffer_load_dwordx4 v6, s[12:15], s46 offen offset:128 lds
 s_add_u32 m0, s54, 96000
 s_nop 0
 buffer_load_dwordx4 v6, s[12:15], s46 offen offset:256 lds
 s_add_u32 m0, s54, 97280
 s_nop 0
 buffer_load_dwordx4 v7, s[12:15], s46 offen offset:0 lds
 s_add_u32 m0, s54, 98176
 s_nop 0
 buffer_load_dwordx4 v7, s[12:15], s46 offen offset:128 lds
 s_add_u32 m0, s54, 99072
 s_nop 0
 buffer_load_dwordx4 v7, s[12:15], s46 offen offset:256 lds
 s_add_u32 s46, s46, 196608
 s_cmp_ge_u32 s51, 576
 s_cbranch_scc1 K1_QK_nojob
 s_sub_u32 s48, s47, 65536
 v_lshlrev_b32 v14, 11, v2
 v_sub_u32 v14, s48, v14
 v_add_u32 v16, v14, v52
 v_add_u32 v17, v14, v53
 v_add_u32 v18, v14, v54
 v_add_u32 v19, v14, v55
tr 192,16,0
tr 194,16,512
tr 196,17,0
tr 198,17,512
tr 200,18,0
tr 202,18,512
tr 204,19,0
tr 206,19,512
 s_and_b32 s48, s51, 7
 s_mul_i32 s48, s48, 288
 s_lshr_b32 s52, s51, 3
 s_add_u32 s48, s48, s52
 s_lshl_b32 s48, s48, 10
 s_add_u32 s48, s48, 20971520
wl 0
 s_mul_i32 s52, s24, 73728
 s_add_u32 s52, s52, s48
 buffer_store_dwordx4 v[192:195], v4, s[16:19], s52 offen sc1
 s_mul_i32 s52, s25, 73728
 s_add_u32 s52, s52, s48
 buffer_store_dwordx4 v[196:199], v4, s[16:19], s52 offen sc1
 s_mul_i32 s52, s26, 73728
 s_add_u32 s52, s52, s48
 buffer_store_dwordx4 v[200:203], v4, s[16:19], s52 offen sc1
 s_mul_i32 s52, s27, 73728
 s_add_u32 s52, s52, s48
 buffer_store_dwordx4 v[204:207], v4, s[16:19], s52 offen sc1
K1_QK_nojob:
tr 208,56,0
tr 210,56,512
wl 10
mg 112,v,216,a,36,112
mg 116,v,216,a,100,116
tr 212,57,0
tr 214,57,512
mg 120,v,220,a,36,120
mg 124,v,220,a,100,124
mg 40,a,36,a,36,40
tr 216,58,0
tr 218,58,512
wl 10
mg 128,v,224,a,36,128
mg 132,v,224,a,100,132
mg 184,v,224,v,48,184
tr 220,59,0
tr 222,59,512
mg 136,v,228,a,36,136
mg 140,v,228,a,100,140
tr 224,56,1024
tr 226,56,1536
wl 10
mg 144,v,232,a,36,144
mg 148,v,232,a,100,148
mg 44,a,100,a,100,44
tr 228,57,1024
tr 230,57,1536
mg 152,v,236,a,36,152
mg 156,v,236,a,100,156
tr 232,58,1024
tr 234,58,1536
wl 10
mg 64,v,208,a,40,64
mg 68,v,208,a,104,68
mg 176,v,208,v,48,176
tr 236,59,1024
tr 238,59,1536
mg 72,v,212,a,40,72
mg 76,v,212,a,104,76
mg 32,v,48,a,40,32
tr 208,56,2048
tr 210,56,2560
wl 10
mg 80,v,216,a,40,80
mg 84,v,216,a,104,84
tr 212,57,2048
tr 214,57,2560
mg 88,v,220,a,40,88
mg 92,v,220,a,104,92
tr 216,58,2048
tr 218,58,2560
wl 10
mg 96,v,224,a,40,96
mg 100,v,224,a,104,100
mg 36,v,48,a,104,36
mg 180,v,224,v,48,180
tr 220,59,2048
tr 222,59,2560
mg 104,v,228,a,40,104
mg 108,v,228,a,104,108
tr 224,56,12288
tr 226,56,12800
wl 10
mg 112,v,232,a,40,112
mg 116,v,232,a,104,116
tr 228,57,12288
tr 230,57,12800
mg 120,v,236,a,40,120
mg 124,v,236,a,104,124
mg 40,a,40,a,40,40
tr 232,58,12288
tr 234,58,12800
wl 10
mg 128,v,208,a,40,128
mg 132,v,208,a,104,132
mg 184,v,208,v,48,184
tr 236,59,12288
tr 238,59,12800
mg 136,v,212,a,40,136
mg 140,v,212,a,104,140
tr 208,56,13312
tr 210,56,13824
wl 10
mg 144,v,216,a,40,144
mg 148,v,216,a,104,148
mg 44,a,104,a,104,44
tr 212,57,13312
tr 214,57,13824
mg 152,v,220,a,40,152
mg 156,v,220,a,104,156
tr 216,58,13312
tr 218,58,13824
wl 10
mg 64,v,224,a,44,64
mg 68,v,224,a,108,68
mg 176,v,224,v,48,176
tr 220,59,13312
tr 222,59,13824
mg 72,v,228,a,44,72
mg 76,v,228,a,108,76
mg 32,v,48,a,44,32
tr 224,56,14336
tr 226,56,14848
wl 10
mg 80,v,232,a,44,80
mg 84,v,232,a,108,84
tr 228,57,14336
tr 230,57,14848
mg 88,v,236,a,44,88
mg 92,v,236,a,108,92
tr 232,58,14336
tr 234,58,14848
wl 10
mg 96,v,208,a,44,96
mg 100,v,208,a,108,100
mg 36,v,48,a,108,36
mg 180,v,208,v,48,180
tr 236,59,14336
tr 238,59,14848
mg 104,v,212,a,44,104
mg 108,v,212,a,108,108
 s_waitcnt vmcnt(6) lgkmcnt(0)
 s_barrier
tr 208,52,0
tr 210,52,512
wl 10
mg 112,v,216,a,44,112
mg 116,v,216,a,108,116
tr 212,53,0
tr 214,53,512
mg 120,v,220,a,44,120
mg 124,v,220,a,108,124
mg 40,a,44,a,44,40
tr 216,54,0
tr 218,54,512
wl 10
mg 128,v,224,a,44,128
mg 132,v,224,a,108,132
mg 184,v,224,v,48,184
tr 220,55,0
tr 222,55,512
mg 136,v,228,a,44,136
mg 140,v,228,a,108,140
tr 224,52,1024
tr 226,52,1536
wl 10
mg 144,v,232,a,44,144
mg 148,v,232,a,108,148
mg 44,a,108,a,108,44
tr 228,53,1024
tr 230,53,1536
mg 152,v,236,a,44,152
mg 156,v,236,a,108,156
tr 232,54,1024
tr 234,54,1536
wl 10
mg 64,v,208,a,48,64
mg 68,v,208,a,112,68
mg 176,v,208,v,48,176
tr 236,55,1024
tr 238,55,1536
mg 72,v,212,a,48,72
mg 76,v,212,a,112,76
mg 32,v,48,a,48,32
tr 208,52,2048
tr 210,52,2560
wl 10
mg 80,v,216,a,48,80
mg 84,v,216,a,112,84
tr 212,53,2048
tr 214,53,2560
mg 88,v,220,a,48,88
mg 92,v,220,a,112,92
tr 216,54,2048
tr 218,54,2560
wl 10
mg 96,v,224,a,48,96
mg 100,v,224,a,112,100
mg 36,v,48,a,112,36
mg 180,v,224,v,48,180
tr 220,55,2048
tr 222,55,2560
mg 104,v,228,a,48,104
mg 108,v,228,a,112,108
tr 224,52,12288
tr 226,52,12800
wl 10
mg 112,v,232,a,48,112
mg 116,v,232,a,112,116
tr 228,53,12288
tr 230,53,12800
mg 120,v,236,a,48,120
mg 124,v,236,a,112,124
mg 40,a,48,a,48,40
tr 232,54,12288
tr 234,54,12800
wl 10
mg 128,v,208,a,48,128
mg 132,v,208,a,112,132
mg 184,v,208,v,48,184
tr 236,55,12288
tr 238,55,12800
mg 136,v,212,a,48,136
mg 140,v,212,a,112,140
tr 208,52,13312
tr 210,52,13824
wl 10
mg 144,v,216,a,48,144
mg 148,v,216,a,112,148
mg 44,a,112,a,112,44
tr 212,53,13312
tr 214,53,13824
mg 152,v,220,a,48,152
mg 156,v,220,a,112,156
tr 216,54,13312
tr 218,54,13824
wl 10
mg 64,v,224,a,52,64
mg 68,v,224,a,116,68
mg 176,v,224,v,48,176
tr 220,55,13312
tr 222,55,13824
mg 72,v,228,a,52,72
mg 76,v,228,a,116,76
mg 32,v,48,a,52,32
tr 224,52,14336
tr 226,52,14848
wl 10
mg 80,v,232,a,52,80
mg 84,v,232,a,116,84
tr 228,53,14336
tr 230,53,14848
mg 88,v,236,a,52,88
mg 92,v,236,a,116,92
tr 232,54,14336
tr 234,54,14848
wl 10
mg 96,v,208,a,52,96
mg 100,v,208,a,116,100
mg 36,v,48,a,116,36
mg 180,v,208,v,48,180
tr 236,55,14336
tr 238,55,14848
mg 104,v,212,a,52,104
mg 108,v,212,a,116,108
 s_waitcnt vmcnt(0) lgkmcnt(0)
 s_barrier
tr 208,52,28672
tr 210,52,29184
wl 10
mg 112,v,216,a,52,112
mg 116,v,216,a,116,116
tr 212,52,29696
tr 214,52,30208
mg 120,v,220,a,52,120
mg 124,v,220,a,116,124
mg 40,a,52,a,52,40
tr 216,52,30720
tr 218,52,31232
wl 10
mg 128,v,224,a,52,128
mg 132,v,224,a,116,132
mg 184,v,224,v,48,184
tr 220,52,40960
tr 222,52,41472
mg 136,v,228,a,52,136
mg 140,v,228,a,116,140
tr 224,52,41984
tr 226,52,42496
wl 10
mg 144,v,232,a,52,144
mg 148,v,232,a,116,148
mg 44,a,116,a,116,44
tr 228,52,43008
tr 230,52,43520
mg 152,v,236,a,52,152
mg 156,v,236,a,116,156
tr 232,53,28672
tr 234,53,29184
wl 10
mg 64,v,208,a,56,64
mg 68,v,208,a,120,68
mg 32,v,48,a,56,32
mg 44,a,120,a,120,44
mg 176,v,208,v,48,176
tr 236,53,40960
tr 238,53,41472
mg 96,v,212,a,56,96
mg 100,v,212,a,120,100
mg 36,v,48,a,120,36
mg 180,v,212,v,48,180
tr 208,54,28672
tr 210,54,29184
wl 10
mg 128,v,216,a,56,128
mg 132,v,216,a,120,132
mg 40,a,56,a,56,40
mg 184,v,216,v,48,184
tr 212,54,40960
tr 214,54,41472
mg 64,v,220,a,60,64
mg 68,v,220,a,124,68
mg 32,v,48,a,60,32
mg 44,a,124,a,124,44
mg 176,v,220,v,48,176
tr 216,55,28672
tr 218,55,29184
wl 10
mg 96,v,224,a,60,96
mg 100,v,224,a,124,100
mg 36,v,48,a,124,36
mg 180,v,224,v,48,180
tr 220,55,40960
tr 222,55,41472
mg 128,v,228,a,60,128
mg 132,v,228,a,124,132
mg 40,a,60,a,60,40
mg 184,v,228,v,48,184
tr 224,53,29696
tr 226,53,30208
wl 10
mg 72,v,232,a,56,72
mg 76,v,232,a,120,76
 s_lshl_b32 s48, s3, 6
 s_add_u32 s48, s48, 151552
 v_lshlrev_b32 v14, 4, v2
 v_add_u32 v15, s48, v14
 s_and_b32 s48, s3, 1
 s_lshl_b32 s48, s48, 6
 s_add_u32 s48, s48, 151552
 v_add_u32 v14, s48, v14
 s_nop 7
 ds_write_b128 v15, v[176:179] offset:0
 ds_write_b128 v15, v[180:183] offset:256
 ds_write_b128 v15, v[184:187] offset:512
 v_and_b32 v22, 3, v3
 v_cmp_eq_u32 vcc, 1, v22
 v_cndmask_b32 v40, v40, v41, vcc
 v_cndmask_b32 v44, v44, v45, vcc
 v_cmp_eq_u32 vcc, 2, v22
 v_cndmask_b32 v40, v40, v42, vcc
 v_cndmask_b32 v44, v44, v46, vcc
 v_cmp_eq_u32 vcc, 3, v22
 v_cndmask_b32 v40, v40, v43, vcc
 v_cndmask_b32 v44, v44, v47, vcc
 v_lshrrev_b32 v22, 2, v3
 v_lshl_add_u32 v22, v22, 4, v3
 v_lshlrev_b32 v22, 2, v22
 ds_bpermute_b32 v34, v22, v40
 ds_bpermute_b32 v38, v22, v44
tr 228,53,41984
tr 230,53,42496
mg 72,v,236,a,60,72
mg 76,v,236,a,124,76
tr 232,54,29696
tr 234,54,30208
wl 15
mg 80,v,208,a,56,80
mg 84,v,208,a,120,84
wl 4
 s_barrier
 s_mov_b32 s48, 989855744
 s_mov_b32 s52, 925353388
 v_mul_f32 v32, s48, v32
 v_mul_f32 v34, s48, v34
 v_fma_f32 v34, -v32, v32, v34
 v_max_f32 v34, 0, v34
 v_add_f32 v34, s52, v34
 v_rsq_f32 v10, v34
 v_sub_f32 v11, 0, v32
 v_mul_f32 v36, s48, v36
 v_mul_f32 v38, s48, v38
 v_fma_f32 v38, -v36, v36, v38
 v_max_f32 v38, 0, v38
 v_add_f32 v38, s52, v38
 v_rsq_f32 v12, v38
 v_sub_f32 v13, 0, v36
 v_lshlrev_b32 v26, 4, v2
 v_add_u32 v26, 151552, v26
 v_lshlrev_b32 v27, 2, v3
 v_add_u32 v27, 151552, v27
 s_lshl_b32 s52, s24, 6
 v_add_u32 v196, s52, v26
rq 192,196,0
 s_lshl_b32 s52, s24, 6
 v_add_u32 v204, s52, v26
rq 200,204,256
 v_and_b32 v16, 1, v2
 v_lshl_add_u32 v16, v16, 4, v3
 v_add_u32 v14, s45, v16
 v_lshlrev_b32 v14, 5, v14
 v_lshrrev_b32 v17, 1, v2
 v_lshl_add_u32 v14, v17, 4, v14
 s_lshl_b32 s48, s45, 5
 v_add_u32 v15, s48, v4
 s_lshl_b32 s48, s44, 12
tr 236,54,41984
tr 238,54,42496
mg 80,v,212,a,60,80
mg 84,v,212,a,124,84
 s_lshl_b32 s54, s24, 16
 s_add_u32 s54, s54, s48
 s_lshl_b32 s52, s24, 4
 s_add_u32 s52, s52, s44
 s_cmp_lt_u32 s52, 512
 s_cselect_b32 s52, 1052289595, 1.0
 v_mul_f32 v22, s52, v10
 v_mul_f32 v24, s52, v12
wl 3
 v_pk_fma_f32 v[64:65], v[192:193], v[10:11], v[64:65] op_sel:[0,1,0] op_sel_hi:[1,1,1]
 v_pk_fma_f32 v[66:67], v[194:195], v[10:11], v[66:67] op_sel:[0,1,0] op_sel_hi:[1,1,1]
 v_pk_mul_f32 v[64:65], v[64:65], v[22:23] op_sel:[0,0] op_sel_hi:[1,0]
 v_pk_mul_f32 v[66:67], v[66:67], v[22:23] op_sel:[0,0] op_sel_hi:[1,0]
pk 64,64,65
pk 65,66,67
 v_pk_fma_f32 v[68:69], v[192:193], v[12:13], v[68:69] op_sel:[0,1,0] op_sel_hi:[1,1,1]
 v_pk_fma_f32 v[70:71], v[194:195], v[12:13], v[70:71] op_sel:[0,1,0] op_sel_hi:[1,1,1]
 v_pk_mul_f32 v[68:69], v[68:69], v[24:25] op_sel:[0,0] op_sel_hi:[1,0]
 v_pk_mul_f32 v[70:71], v[70:71], v[24:25] op_sel:[0,0] op_sel_hi:[1,0]
pk 66,68,69
pk 67,70,71
 s_lshl_b32 s52, s24, 6
 v_add_u32 v196, s52, v26
rq 192,196,512
 v_permlane16_swap_b32 v64, v66
 v_permlane16_swap_b32 v65, v67
 buffer_store_dwordx4 v[64:67], v14, s[16:19], s54 offen sc1
tr 208,55,29696
tr 210,55,30208
wl 15
mg 88,v,216,a,56,88
mg 92,v,216,a,120,92
 s_lshl_b32 s54, s24, 16
 s_add_u32 s54, s54, s48
 s_add_u32 s54, s54, 262144
 s_lshl_b32 s52, s24, 4
 s_add_u32 s52, s52, s44
 s_cmp_lt_u32 s52, 448
 s_cselect_b32 s52, 1052289595, 1.0
 v_mul_f32 v22, s52, v10
 v_mul_f32 v24, s52, v12
wl 5
 v_pk_fma_f32 v[96:97], v[200:201], v[10:11], v[96:97] op_sel:[0,1,0] op_sel_hi:[1,1,1]
 v_pk_fma_f32 v[98:99], v[202:203], v[10:11], v[98:99] op_sel:[0,1,0] op_sel_hi:[1,1,1]
 v_pk_mul_f32 v[96:97], v[96:97], v[22:23] op_sel:[0,0] op_sel_hi:[1,0]
 v_pk_mul_f32 v[98:99], v[98:99], v[22:23] op_sel:[0,0] op_sel_hi:[1,0]
pk 96,96,97
pk 97,98,99
 v_pk_fma_f32 v[100:101], v[200:201], v[12:13], v[100:101] op_sel:[0,1,0] op_sel_hi:[1,1,1]
 v_pk_fma_f32 v[102:103], v[202:203], v[12:13], v[102:103] op_sel:[0,1,0] op_sel_hi:[1,1,1]
 v_pk_mul_f32 v[100:101], v[100:101], v[24:25] op_sel:[0,0] op_sel_hi:[1,0]
 v_pk_mul_f32 v[102:103], v[102:103], v[24:25] op_sel:[0,0] op_sel_hi:[1,0]
pk 98,100,101
pk 99,102,103
 s_lshl_b32 s52, s25, 6
 v_add_u32 v204, s52, v26
rq 200,204,0
 v_permlane16_swap_b32 v96, v98
 v_permlane16_swap_b32 v97, v99
 buffer_store_dwordx4 v[96:99], v14, s[16:19], s54 offen sc1
tr 212,55,41984
tr 214,55,42496
mg 88,v,220,a,60,88
mg 92,v,220,a,124,92
 s_lshl_b32 s54, s24, 16
 s_add_u32 s54, s54, s48
 s_add_u32 s54, s54, 524288
 s_lshl_b32 s52, s24, 4
 s_add_u32 s52, s52, s44
 s_cmp_lt_u32 s52, 384
 s_cselect_b32 s52, 1052289595, 1.0
 v_mul_f32 v22, s52, v10
 v_mul_f32 v24, s52, v12
wl 5
 v_pk_fma_f32 v[128:129], v[192:193], v[10:11], v[128:129] op_sel:[0,1,0] op_sel_hi:[1,1,1]
 v_pk_fma_f32 v[130:131], v[194:195], v[10:11], v[130:131] op_sel:[0,1,0] op_sel_hi:[1,1,1]
 v_pk_mul_f32 v[128:129], v[128:129], v[22:23] op_sel:[0,0] op_sel_hi:[1,0]
 v_pk_mul_f32 v[130:131], v[130:131], v[22:23] op_sel:[0,0] op_sel_hi:[1,0]
pk 128,128,129
pk 129,130,131
 v_pk_fma_f32 v[132:133], v[192:193], v[12:13], v[132:133] op_sel:[0,1,0] op_sel_hi:[1,1,1]
 v_pk_fma_f32 v[134:135], v[194:195], v[12:13], v[134:135] op_sel:[0,1,0] op_sel_hi:[1,1,1]
 v_pk_mul_f32 v[132:133], v[132:133], v[24:25] op_sel:[0,0] op_sel_hi:[1,0]
 v_pk_mul_f32 v[134:135], v[134:135], v[24:25] op_sel:[0,0] op_sel_hi:[1,0]
pk 130,132,133
pk 131,134,135
 s_lshl_b32 s52, s26, 6
 v_add_u32 v196, s52, v26
rq 192,196,0
 v_permlane16_swap_b32 v128, v130
 v_permlane16_swap_b32 v129, v131
 buffer_store_dwordx4 v[128:131], v14, s[16:19], s54 offen sc1
tr 216,53,30720
tr 218,53,31232
wl 15
mg 104,v,224,a,56,104
mg 108,v,224,a,120,108
 s_lshl_b32 s54, s25, 16
 s_add_u32 s54, s54, s48
 s_lshl_b32 s52, s25, 4
 s_add_u32 s52, s52, s44
 s_cmp_lt_u32 s52, 512
 s_cselect_b32 s52, 1052289595, 1.0
 v_mul_f32 v22, s52, v10
 v_mul_f32 v24, s52, v12
wl 5
 v_pk_fma_f32 v[72:73], v[200:201], v[10:11], v[72:73] op_sel:[0,1,0] op_sel_hi:[1,1,1]
 v_pk_fma_f32 v[74:75], v[202:203], v[10:11], v[74:75] op_sel:[0,1,0] op_sel_hi:[1,1,1]
 v_pk_mul_f32 v[72:73], v[72:73], v[22:23] op_sel:[0,0] op_sel_hi:[1,0]
 v_pk_mul_f32 v[74:75], v[74:75], v[22:23] op_sel:[0,0] op_sel_hi:[1,0]
pk 72,72,73
pk 73,74,75
 v_pk_fma_f32 v[76:77], v[200:201], v[12:13], v[76:77] op_sel:[0,1,0] op_sel_hi:[1,1,1]
 v_pk_fma_f32 v[78:79], v[202:203], v[12:13], v[78:79] op_sel:[0,1,0] op_sel_hi:[1,1,1]
 v_pk_mul_f32 v[76:77], v[76:77], v[24:25] op_sel:[0,0] op_sel_hi:[1,0]
 v_pk_mul_f32 v[78:79], v[78:79], v[24:25] op_sel:[0,0] op_sel_hi:[1,0]
pk 74,76,77
pk 75,78,79
 s_lshl_b32 s52, s27, 6
 v_add_u32 v204, s52, v26
rq 200,204,0
 v_permlane16_swap_b32 v72, v74
 v_permlane16_swap_b32 v73, v75
 buffer_store_dwordx4 v[72:75], v14, s[16:19], s54 offen sc1
tr 220,53,43008
tr 222,53,43520
mg 104,v,228,a,60,104
mg 108,v,228,a,124,108
 s_lshl_b32 s54, s26, 16
 s_add_u32 s54, s54, s48
 s_lshl_b32 s52, s26, 4
 s_add_u32 s52, s52, s44
 s_cmp_lt_u32 s52, 512
 s_cselect_b32 s52, 1052289595, 1.0
 v_mul_f32 v22, s52, v10
 v_mul_f32 v24, s52, v12
wl 5
 v_pk_fma_f32 v[80:81], v[192:193], v[10:11], v[80:81] op_sel:[0,1,0] op_sel_hi:[1,1,1]
 v_pk_fma_f32 v[82:83], v[194:195], v[10:11], v[82:83] op_sel:[0,1,0] op_sel_hi:[1,1,1]
 v_pk_mul_f32 v[80:81], v[80:81], v[22:23] op_sel:[0,0] op_sel_hi:[1,0]
 v_pk_mul_f32 v[82:83], v[82:83], v[22:23] op_sel:[0,0] op_sel_hi:[1,0]
pk 80,80,81
pk 81,82,83
 v_pk_fma_f32 v[84:85], v[192:193], v[12:13], v[84:85] op_sel:[0,1,0] op_sel_hi:[1,1,1]
 v_pk_fma_f32 v[86:87], v[194:195], v[12:13], v[86:87] op_sel:[0,1,0] op_sel_hi:[1,1,1]
 v_pk_mul_f32 v[84:85], v[84:85], v[24:25] op_sel:[0,0] op_sel_hi:[1,0]
 v_pk_mul_f32 v[86:87], v[86:87], v[24:25] op_sel:[0,0] op_sel_hi:[1,0]
pk 82,84,85
pk 83,86,87
 s_lshl_b32 s52, s25, 6
 v_add_u32 v196, s52, v26
rq 192,196,256
 v_permlane16_swap_b32 v80, v82
 v_permlane16_swap_b32 v81, v83
 buffer_store_dwordx4 v[80:83], v14, s[16:19], s54 offen sc1
tr 224,54,30720
tr 226,54,31232
wl 15
mg 112,v,232,a,56,112
mg 116,v,232,a,120,116
 s_lshl_b32 s54, s27, 16
 s_add_u32 s54, s54, s48
 s_lshl_b32 s52, s27, 4
 s_add_u32 s52, s52, s44
 s_cmp_lt_u32 s52, 512
 s_cselect_b32 s52, 1052289595, 1.0
 v_mul_f32 v22, s52, v10
 v_mul_f32 v24, s52, v12
wl 5
 v_pk_fma_f32 v[88:89], v[200:201], v[10:11], v[88:89] op_sel:[0,1,0] op_sel_hi:[1,1,1]
 v_pk_fma_f32 v[90:91], v[202:203], v[10:11], v[90:91] op_sel:[0,1,0] op_sel_hi:[1,1,1]
 v_pk_mul_f32 v[88:89], v[88:89], v[22:23] op_sel:[0,0] op_sel_hi:[1,0]
 v_pk_mul_f32 v[90:91], v[90:91], v[22:23] op_sel:[0,0] op_sel_hi:[1,0]
pk 88,88,89
pk 89,90,91
 v_pk_fma_f32 v[92:93], v[200:201], v[12:13], v[92:93] op_sel:[0,1,0] op_sel_hi:[1,1,1]
 v_pk_fma_f32 v[94:95], v[202:203], v[12:13], v[94:95] op_sel:[0,1,0] op_sel_hi:[1,1,1]
 v_pk_mul_f32 v[92:93], v[92:93], v[24:25] op_sel:[0,0] op_sel_hi:[1,0]
 v_pk_mul_f32 v[94:95], v[94:95], v[24:25] op_sel:[0,0] op_sel_hi:[1,0]
pk 90,92,93
pk 91,94,95
 s_lshl_b32 s52, s26, 6
 v_add_u32 v204, s52, v26
rq 200,204,256
 v_permlane16_swap_b32 v88, v90
 v_permlane16_swap_b32 v89, v91
 buffer_store_dwordx4 v[88:91], v14, s[16:19], s54 offen sc1
tr 228,54,43008
tr 230,54,43520
mg 112,v,236,a,60,112
mg 116,v,236,a,124,116
 s_lshl_b32 s54, s25, 16
 s_add_u32 s54, s54, s48
 s_add_u32 s54, s54, 262144
 s_lshl_b32 s52, s25, 4
 s_add_u32 s52, s52, s44
 s_cmp_lt_u32 s52, 448
 s_cselect_b32 s52, 1052289595, 1.0
 v_mul_f32 v22, s52, v10
 v_mul_f32 v24, s52, v12
wl 5
 v_pk_fma_f32 v[104:105], v[192:193], v[10:11], v[104:105] op_sel:[0,1,0] op_sel_hi:[1,1,1]
 v_pk_fma_f32 v[106:107], v[194:195], v[10:11], v[106:107] op_sel:[0,1,0] op_sel_hi:[1,1,1]
 v_pk_mul_f32 v[104:105], v[104:105], v[22:23] op_sel:[0,0] op_sel_hi:[1,0]
 v_pk_mul_f32 v[106:107], v[106:107], v[22:23] op_sel:[0,0] op_sel_hi:[1,0]
pk 104,104,105
pk 105,106,107
 v_pk_fma_f32 v[108:109], v[192:193], v[12:13], v[108:109] op_sel:[0,1,0] op_sel_hi:[1,1,1]
 v_pk_fma_f32 v[110:111], v[194:195], v[12:13], v[110:111] op_sel:[0,1,0] op_sel_hi:[1,1,1]
 v_pk_mul_f32 v[108:109], v[108:109], v[24:25] op_sel:[0,0] op_sel_hi:[1,0]
 v_pk_mul_f32 v[110:111], v[110:111], v[24:25] op_sel:[0,0] op_sel_hi:[1,0]
pk 106,108,109
pk 107,110,111
 s_lshl_b32 s52, s27, 6
 v_add_u32 v196, s52, v26
rq 192,196,256
 v_permlane16_swap_b32 v104, v106
 v_permlane16_swap_b32 v105, v107
 buffer_store_dwordx4 v[104:107], v14, s[16:19], s54 offen sc1
tr 232,55,30720
tr 234,55,31232
wl 15
mg 120,v,208,a,56,120
mg 124,v,208,a,120,124
tr 236,55,43008
tr 238,55,43520
mg 120,v,212,a,60,120
mg 124,v,212,a,124,124
 s_lshl_b32 s54, s26, 16
 s_add_u32 s54, s54, s48
 s_add_u32 s54, s54, 262144
 s_lshl_b32 s52, s26, 4
 s_add_u32 s52, s52, s44
 s_cmp_lt_u32 s52, 448
 s_cselect_b32 s52, 1052289595, 1.0
 v_mul_f32 v22, s52, v10
 v_mul_f32 v24, s52, v12
wl 7
 v_pk_fma_f32 v[112:113], v[200:201], v[10:11], v[112:113] op_sel:[0,1,0] op_sel_hi:[1,1,1]
 v_pk_fma_f32 v[114:115], v[202:203], v[10:11], v[114:115] op_sel:[0,1,0] op_sel_hi:[1,1,1]
 v_pk_mul_f32 v[112:113], v[112:113], v[22:23] op_sel:[0,0] op_sel_hi:[1,0]
 v_pk_mul_f32 v[114:115], v[114:115], v[22:23] op_sel:[0,0] op_sel_hi:[1,0]
pk 112,112,113
pk 113,114,115
 v_pk_fma_f32 v[116:117], v[200:201], v[12:13], v[116:117] op_sel:[0,1,0] op_sel_hi:[1,1,1]
 v_pk_fma_f32 v[118:119], v[202:203], v[12:13], v[118:119] op_sel:[0,1,0] op_sel_hi:[1,1,1]
 v_pk_mul_f32 v[116:117], v[116:117], v[24:25] op_sel:[0,0] op_sel_hi:[1,0]
 v_pk_mul_f32 v[118:119], v[118:119], v[24:25] op_sel:[0,0] op_sel_hi:[1,0]
pk 114,116,117
pk 115,118,119
 s_lshl_b32 s52, s25, 6
 v_add_u32 v204, s52, v26
rq 200,204,512
 v_permlane16_swap_b32 v112, v114
 v_permlane16_swap_b32 v113, v115
 buffer_store_dwordx4 v[112:115], v14, s[16:19], s54 offen sc1
wl 12
mg 136,v,216,a,56,136
mg 140,v,216,a,120,140
mg 136,v,220,a,60,136
mg 140,v,220,a,124,140
 s_lshl_b32 s54, s27, 16
 s_add_u32 s54, s54, s48
 s_add_u32 s54, s54, 262144
 s_lshl_b32 s52, s27, 4
 s_add_u32 s52, s52, s44
 s_cmp_lt_u32 s52, 448
 s_cselect_b32 s52, 1052289595, 1.0
 v_mul_f32 v22, s52, v10
 v_mul_f32 v24, s52, v12
wl 5
 v_pk_fma_f32 v[120:121], v[192:193], v[10:11], v[120:121] op_sel:[0,1,0] op_sel_hi:[1,1,1]
 v_pk_fma_f32 v[122:123], v[194:195], v[10:11], v[122:123] op_sel:[0,1,0] op_sel_hi:[1,1,1]
 v_pk_mul_f32 v[120:121], v[120:121], v[22:23] op_sel:[0,0] op_sel_hi:[1,0]
 v_pk_mul_f32 v[122:123], v[122:123], v[22:23] op_sel:[0,0] op_sel_hi:[1,0]
pk 120,120,121
pk 121,122,123
 v_pk_fma_f32 v[124:125], v[192:193], v[12:13], v[124:125] op_sel:[0,1,0] op_sel_hi:[1,1,1]
 v_pk_fma_f32 v[126:127], v[194:195], v[12:13], v[126:127] op_sel:[0,1,0] op_sel_hi:[1,1,1]
 v_pk_mul_f32 v[124:125], v[124:125], v[24:25] op_sel:[0,0] op_sel_hi:[1,0]
 v_pk_mul_f32 v[126:127], v[126:127], v[24:25] op_sel:[0,0] op_sel_hi:[1,0]
pk 122,124,125
pk 123,126,127
 s_lshl_b32 s52, s26, 6
 v_add_u32 v196, s52, v26
rq 192,196,512
 v_permlane16_swap_b32 v120, v122
 v_permlane16_swap_b32 v121, v123
 buffer_store_dwordx4 v[120:123], v14, s[16:19], s54 offen sc1
wl 7
mg 144,v,224,a,56,144
mg 148,v,224,a,120,148
mg 144,v,228,a,60,144
mg 148,v,228,a,124,148
 s_lshl_b32 s54, s25, 16
 s_add_u32 s54, s54, s48
 s_add_u32 s54, s54, 524288
 s_lshl_b32 s52, s25, 4
 s_add_u32 s52, s52, s44
 s_cmp_lt_u32 s52, 384
 s_cselect_b32 s52, 1052289595, 1.0
 v_mul_f32 v22, s52, v10
 v_mul_f32 v24, s52, v12
wl 1
 v_pk_fma_f32 v[136:137], v[200:201], v[10:11], v[136:137] op_sel:[0,1,0] op_sel_hi:[1,1,1]
 v_pk_fma_f32 v[138:139], v[202:203], v[10:11], v[138:139] op_sel:[0,1,0] op_sel_hi:[1,1,1]
 v_pk_mul_f32 v[136:137], v[136:137], v[22:23] op_sel:[0,0] op_sel_hi:[1,0]
 v_pk_mul_f32 v[138:139], v[138:139], v[22:23] op_sel:[0,0] op_sel_hi:[1,0]
pk 136,136,137
pk 137,138,139
 v_pk_fma_f32 v[140:141], v[200:201], v[12:13], v[140:141] op_sel:[0,1,0] op_sel_hi:[1,1,1]
 v_pk_fma_f32 v[142:143], v[202:203], v[12:13], v[142:143] op_sel:[0,1,0] op_sel_hi:[1,1,1]
 v_pk_mul_f32 v[140:141], v[140:141], v[24:25] op_sel:[0,0] op_sel_hi:[1,0]
 v_pk_mul_f32 v[142:143], v[142:143], v[24:25] op_sel:[0,0] op_sel_hi:[1,0]
pk 138,140,141
pk 139,142,143
 s_lshl_b32 s52, s27, 6
 v_add_u32 v204, s52, v26
rq 200,204,512
 v_permlane16_swap_b32 v136, v138
 v_permlane16_swap_b32 v137, v139
 buffer_store_dwordx4 v[136:139], v14, s[16:19], s54 offen sc1
wl 3
mg 152,v,232,a,56,152
mg 156,v,232,a,120,156
mg 152,v,236,a,60,152
mg 156,v,236,a,124,156
 s_lshl_b32 s54, s26, 16
 s_add_u32 s54, s54, s48
 s_add_u32 s54, s54, 524288
 s_lshl_b32 s52, s26, 4
 s_add_u32 s52, s52, s44
 s_cmp_lt_u32 s52, 384
 s_cselect_b32 s52, 1052289595, 1.0
 v_mul_f32 v22, s52, v10
 v_mul_f32 v24, s52, v12
wl 1
 v_pk_fma_f32 v[144:145], v[192:193], v[10:11], v[144:145] op_sel:[0,1,0] op_sel_hi:[1,1,1]
 v_pk_fma_f32 v[146:147], v[194:195], v[10:11], v[146:147] op_sel:[0,1,0] op_sel_hi:[1,1,1]
 v_pk_mul_f32 v[144:145], v[144:145], v[22:23] op_sel:[0,0] op_sel_hi:[1,0]
 v_pk_mul_f32 v[146:147], v[146:147], v[22:23] op_sel:[0,0] op_sel_hi:[1,0]
pk 144,144,145
pk 145,146,147
 v_pk_fma_f32 v[148:149], v[192:193], v[12:13], v[148:149] op_sel:[0,1,0] op_sel_hi:[1,1,1]
 v_pk_fma_f32 v[150:151], v[194:195], v[12:13], v[150:151] op_sel:[0,1,0] op_sel_hi:[1,1,1]
 v_pk_mul_f32 v[148:149], v[148:149], v[24:25] op_sel:[0,0] op_sel_hi:[1,0]
 v_pk_mul_f32 v[150:151], v[150:151], v[24:25] op_sel:[0,0] op_sel_hi:[1,0]
pk 146,148,149
pk 147,150,151
 s_nop 1
 v_permlane16_swap_b32 v144, v146
 v_permlane16_swap_b32 v145, v147
 buffer_store_dwordx4 v[144:147], v14, s[16:19], s54 offen sc1
 s_nop 7
 s_lshl_b32 s54, s27, 16
 s_add_u32 s54, s54, s48
 s_add_u32 s54, s54, 524288
 s_lshl_b32 s52, s27, 4
 s_add_u32 s52, s52, s44
 s_cmp_lt_u32 s52, 384
 s_cselect_b32 s52, 1052289595, 1.0
 v_mul_f32 v22, s52, v10
 v_mul_f32 v24, s52, v12
wl 0
 v_pk_fma_f32 v[152:153], v[200:201], v[10:11], v[152:153] op_sel:[0,1,0] op_sel_hi:[1,1,1]
 v_pk_fma_f32 v[154:155], v[202:203], v[10:11], v[154:155] op_sel:[0,1,0] op_sel_hi:[1,1,1]
 v_pk_mul_f32 v[152:153], v[152:153], v[22:23] op_sel:[0,0] op_sel_hi:[1,0]
 v_pk_mul_f32 v[154:155], v[154:155], v[22:23] op_sel:[0,0] op_sel_hi:[1,0]
pk 152,152,153
pk 153,154,155
 v_pk_fma_f32 v[156:157], v[200:201], v[12:13], v[156:157] op_sel:[0,1,0] op_sel_hi:[1,1,1]
 v_pk_fma_f32 v[158:159], v[202:203], v[12:13], v[158:159] op_sel:[0,1,0] op_sel_hi:[1,1,1]
 v_pk_mul_f32 v[156:157], v[156:157], v[24:25] op_sel:[0,0] op_sel_hi:[1,0]
 v_pk_mul_f32 v[158:159], v[158:159], v[24:25] op_sel:[0,0] op_sel_hi:[1,0]
pk 154,156,157
pk 155,158,159
 s_nop 1
 v_permlane16_swap_b32 v152, v154
 v_permlane16_swap_b32 v153, v155
 buffer_store_dwordx4 v[152:155], v14, s[16:19], s54 offen sc1
 s_endpgm
K1_KV:
 s_lshl_b32 s47, s3, 14
 s_lshl_b32 s50, s45, 10
 v_lshrrev_b32 v14, 5, v1
 v_and_b32 v15, 31, v1
 v_xor_b32 v15, v15, v14
 v_lshlrev_b32 v15, 4, v15
 v_lshl_add_u32 v5, v14, 10, v15
 v_xor_b32 v14, 0, v5
 s_add_u32 m0, s47, 0
 s_nop 0
 buffer_load_dwordx4 v14, s[8:11], s50 offen lds
 s_add_u32 s50, s50, 2048
 v_xor_b32 v15, 32, v5
 s_add_u32 m0, s47, 1024
 s_nop 0
 buffer_load_dwordx4 v15, s[8:11], s50 offen lds
 s_add_u32 s50, s50, 2048
 v_xor_b32 v14, 64, v5
 s_add_u32 m0, s47, 2048
 s_nop 0
 buffer_load_dwordx4 v14, s[8:11], s50 offen lds
 s_add_u32 s50, s50, 2048
 v_xor_b32 v15, 96, v5
 s_add_u32 m0, s47, 3072
 s_nop 0
 buffer_load_dwordx4 v15, s[8:11], s50 offen lds
 s_add_u32 s50, s50, 2048
 v_xor_b32 v14, 128, v5
 s_add_u32 m0, s47, 4096
 s_nop 0
 buffer_load_dwordx4 v14, s[8:11], s50 offen lds
 s_add_u32 s50, s50, 2048
 v_xor_b32 v15, 160, v5
 s_add_u32 m0, s47, 5120
 s_nop 0
 buffer_load_dwordx4 v15, s[8:11], s50 offen lds
 s_add_u32 s50, s50, 2048
 v_xor_b32 v14, 192, v5
 s_add_u32 m0, s47, 6144
 s_nop 0
 buffer_load_dwordx4 v14, s[8:11], s50 offen lds
 s_add_u32 s50, s50, 2048
 v_xor_b32 v15, 224, v5
 s_add_u32 m0, s47, 7168
 s_nop 0
 buffer_load_dwordx4 v15, s[8:11], s50 offen lds
 s_add_u32 s50, s50, 2048
 v_xor_b32 v14, 0, v5
 s_add_u32 m0, s47, 8192
 s_nop 0
 buffer_load_dwordx4 v14, s[8:11], s50 offen lds
 s_add_u32 s50, s50, 2048
 v_xor_b32 v15, 32, v5
 s_add_u32 m0, s47, 9216
 s_nop 0
 buffer_load_dwordx4 v15, s[8:11], s50 offen lds
 s_add_u32 s50, s50, 2048
 v_xor_b32 v14, 64, v5
 s_add_u32 m0, s47, 10240
 s_nop 0
 buffer_load_dwordx4 v14, s[8:11], s50 offen lds
 s_add_u32 s50, s50, 2048
 v_xor_b32 v15, 96, v5
 s_add_u32 m0, s47, 11264
 s_nop 0
 buffer_load_dwordx4 v15, s[8:11], s50 offen lds
 s_add_u32 s50, s50, 2048
 v_xor_b32 v14, 128, v5
 s_add_u32 m0, s47, 12288
 s_nop 0
 buffer_load_dwordx4 v14, s[8:11], s50 offen lds
 s_add_u32 s50, s50, 2048
 v_xor_b32 v15, 160, v5
 s_add_u32 m0, s47, 13312
 s_nop 0
 buffer_load_dwordx4 v15, s[8:11], s50 offen lds
 s_add_u32 s50, s50, 2048
 v_xor_b32 v14, 192, v5
 s_add_u32 m0, s47, 14336
 s_nop 0
 buffer_load_dwordx4 v14, s[8:11], s50 offen lds
 s_add_u32 s50, s50, 2048
 v_xor_b32 v15, 224, v5
 s_add_u32 m0, s47, 15360
 s_nop 0
 buffer_load_dwordx4 v15, s[8:11], s50 offen lds
 s_add_u32 s50, s50, 2048
 s_sub_u32 s50, s50, 32256
 s_mov_b32 s48, 3072
 v_lshrrev_b32 v14, 3, v1
 v_mul_lo_u32 v15, v14, s48
 v_and_b32 v16, 7, v1
 v_and_b32 v17, 2, v14
 v_xor_b32 v16, v16, v17
 v_lshl_add_u32 v6, v16, 4, v15
 v_xor_b32 v16, 4, v16
 v_lshl_add_u32 v7, v16, 4, v15
 v_add_u32 v7, 24576, v7
 s_mul_i32 s46, s3, 49152
 s_lshl_b32 s48, s44, 1
 s_add_u32 s46, s46, s48
 s_mul_i32 s54, s3, 6144
 s_lshl_b32 s56, s3, 10
 s_add_u32 m0, s54, 65536
 s_nop 0
 buffer_load_dwordx4 v6, s[12:15], s46 offen offset:0 lds
 s_add_u32 m0, s54, 66432
 s_nop 0
 buffer_load_dwordx4 v6, s[12:15], s46 offen offset:128 lds
 s_add_u32 m0, s54, 67328
 s_nop 0
 buffer_load_dwordx4 v6, s[12:15], s46 offen offset:256 lds
 s_add_u32 m0, s54, 68608
 s_nop 0
 buffer_load_dwordx4 v7, s[12:15], s46 offen offset:0 lds
 s_add_u32 m0, s54, 69504
 s_nop 0
 buffer_load_dwordx4 v7, s[12:15], s46 offen offset:128 lds
 s_add_u32 m0, s54, 70400
 s_nop 0
 buffer_load_dwordx4 v7, s[12:15], s46 offen offset:256 lds
 s_add_u32 s46, s46, 196608
 v_lshlrev_b32 v14, 9, v3
 v_add_u32 v14, s47, v14
 v_or_b32 v15, 0, v2
 v_xor_b32 v15, v15, v3
 v_lshl_add_u32 v28, v15, 4, v14
 v_or_b32 v15, 4, v2
 v_xor_b32 v15, v15, v3
 v_lshl_add_u32 v29, v15, 4, v14
 v_or_b32 v15, 8, v2
 v_xor_b32 v15, v15, v3
 v_lshl_add_u32 v30, v15, 4, v14
 v_or_b32 v15, 12, v2
 v_xor_b32 v15, v15, v3
 v_lshl_add_u32 v31, v15, 4, v14
 v_bfe_u32 v14, v1, 2, 2
 v_and_b32 v15, 1, v1
 v_lshlrev_b32 v15, 3, v15
 v_bfe_u32 v16, v1, 1, 1
 v_lshl_add_u32 v15, v16, 4, v15
 v_lshrrev_b32 v16, 1, v14
 v_and_b32 v17, 1, v2
 v_lshl_add_u32 v16, v17, 1, v16
 s_movk_i32 s48, 3072
 v_mul_lo_u32 v18, v2, s48
 v_lshl_add_u32 v18, v14, 7, v18
 v_add_u32 v18, v18, v15
 s_xor_b32 s24, s3, 0
 s_xor_b32 s25, s3, 1
 s_xor_b32 s26, s3, 2
 s_xor_b32 s27, s3, 3
 v_xor_b32 v19, s24, v16
 v_lshl_add_u32 v19, v19, 5, v18
 v_add_u32 v52, 65536, v19
 v_add_u32 v56, 122880, v19
 v_xor_b32 v19, s25, v16
 v_lshl_add_u32 v19, v19, 5, v18
 v_add_u32 v53, 65536, v19
 v_add_u32 v57, 122880, v19
 v_xor_b32 v19, s26, v16
 v_lshl_add_u32 v19, v19, 5, v18
 v_add_u32 v54, 65536, v19
 v_add_u32 v58, 122880, v19
 v_xor_b32 v19, s27, v16
 v_lshl_add_u32 v19, v19, 5, v18
 v_add_u32 v55, 65536, v19
 v_add_u32 v59, 122880, v19
 v_mov_b32 v48, s49
 v_mov_b32 v49, s49
 v_mov_b32 v50, s49
 v_mov_b32 v51, s49
 s_waitcnt vmcnt(6)
 ds_read_b128 a[0:3], v28 offset:0
 ds_read_b128 a[4:7], v29 offset:0
 ds_read_b128 a[8:11], v30 offset:0
 ds_read_b128 a[12:15], v31 offset:0
 ds_read_b128 a[16:19], v28 offset:256
 ds_read_b128 a[20:23], v29 offset:256
 ds_read_b128 a[24:27], v30 offset:256
 ds_read_b128 a[28:31], v31 offset:256
 ds_read_b128 a[64:67], v28 offset:8192
 ds_read_b128 a[68:71], v29 offset:8192
 ds_read_b128 a[72:75], v30 offset:8192
 ds_read_b128 a[76:79], v31 offset:8192
 ds_read_b128 a[80:83], v28 offset:8448
 ds_read_b128 a[84:87], v29 offset:8448
 ds_read_b128 a[88:91], v30 offset:8448
 ds_read_b128 a[92:95], v31 offset:8448
 s_add_u32 m0, s54, 94208
 s_nop 0
 buffer_load_dwordx4 v6, s[12:15], s46 offen offset:0 lds
 s_add_u32 m0, s54, 95104
 s_nop 0
 buffer_load_dwordx4 v6, s[12:15], s46 offen offset:128 lds
 s_add_u32 m0, s54, 96000
 s_nop 0
 buffer_load_dwordx4 v6, s[12:15], s46 offen offset:256 lds
 s_add_u32 m0, s54, 97280
 s_nop 0
 buffer_load_dwordx4 v7, s[12:15], s46 offen offset:0 lds
 s_add_u32 m0, s54, 98176
 s_nop 0
 buffer_load_dwordx4 v7, s[12:15], s46 offen offset:128 lds
 s_add_u32 m0, s54, 99072
 s_nop 0
 buffer_load_dwordx4 v7, s[12:15], s46 offen offset:256 lds
 s_add_u32 s46, s46, 196608
 s_waitcnt vmcnt(6) lgkmcnt(0)
 s_barrier
tr 208,52,0
tr 210,52,512
tr 212,53,0
tr 214,53,512
tr 216,54,0
tr 218,54,512
tr 220,55,0
tr 222,55,512
tr 224,52,1024
tr 226,52,1536
tr 228,53,1024
tr 230,53,1536
tr 232,54,1024
tr 234,54,1536
wl 10
 v_mfma_f32_16x16x32_bf16 v[64:67], v[208:211], a[0:3], 0
 s_add_u32 m0, s54, 122880
 s_nop 0
 buffer_load_dwordx4 v6, s[12:15], s46 offen offset:0 lds
 v_mfma_f32_16x16x32_bf16 v[68:71], v[208:211], a[64:67], 0
 s_add_u32 m0, s54, 123776
 s_nop 0
 buffer_load_dwordx4 v6, s[12:15], s46 offen offset:128 lds
 v_mfma_f32_16x16x32_bf16 v[176:179], v[208:211], v[48:51], 0
tr 236,55,1024
tr 238,55,1536
 v_mfma_f32_16x16x32_bf16 v[72:75], v[212:215], a[0:3], 0
 s_add_u32 m0, s54, 124672
 s_nop 0
 buffer_load_dwordx4 v6, s[12:15], s46 offen offset:256 lds
 v_mfma_f32_16x16x32_bf16 v[76:79], v[212:215], a[64:67], 0
 s_add_u32 m0, s54, 125952
 s_nop 0
 buffer_load_dwordx4 v7, s[12:15], s46 offen offset:0 lds
 v_mfma_f32_16x16x32_bf16 v[32:35], v[48:51], a[0:3], 0
tr 208,52,2048
tr 210,52,2560
wl 10
 v_mfma_f32_16x16x32_bf16 v[80:83], v[216:219], a[0:3], 0
 s_add_u32 m0, s54, 126848
 s_nop 0
 buffer_load_dwordx4 v7, s[12:15], s46 offen offset:128 lds
 v_mfma_f32_16x16x32_bf16 v[84:87], v[216:219], a[64:67], 0
 s_add_u32 m0, s54, 127744
 s_nop 0
 buffer_load_dwordx4 v7, s[12:15], s46 offen offset:256 lds
 s_add_u32 s46, s46, 196608
tr 212,53,2048
tr 214,53,2560
 v_mfma_f32_16x16x32_bf16 v[88:91], v[220:223], a[0:3], 0
 v_xor_b32 v14, 0, v5
 s_add_u32 m0, s47, 0
 s_nop 0
 buffer_load_dwordx4 v14, s[8:11], s50 offen lds
 s_add_u32 s50, s50, 2048
 v_mfma_f32_16x16x32_bf16 v[92:95], v[220:223], a[64:67], 0
 v_xor_b32 v15, 32, v5
 s_add_u32 m0, s47, 1024
 s_nop 0
 buffer_load_dwordx4 v15, s[8:11], s50 offen lds
 s_add_u32 s50, s50, 2048
tr 216,54,2048
tr 218,54,2560
wl 10
 v_mfma_f32_16x16x32_bf16 v[96:99], a[0:3], v[224:227], 0
 v_xor_b32 v14, 64, v5
 s_add_u32 m0, s47, 2048
 s_nop 0
 buffer_load_dwordx4 v14, s[8:11], s50 offen lds
 s_add_u32 s50, s50, 2048
 v_mfma_f32_16x16x32_bf16 v[100:103], a[64:67], v[224:227], 0
 v_mfma_f32_16x16x32_bf16 v[36:39], v[48:51], a[64:67], 0
 v_mfma_f32_16x16x32_bf16 v[180:183], v[224:227], v[48:51], 0
tr 220,55,2048
tr 222,55,2560
 v_mfma_f32_16x16x32_bf16 v[104:107], a[0:3], v[228:231], 0
 v_xor_b32 v15, 96, v5
 s_add_u32 m0, s47, 3072
 s_nop 0
 buffer_load_dwordx4 v15, s[8:11], s50 offen lds
 s_add_u32 s50, s50, 2048
 v_mfma_f32_16x16x32_bf16 v[108:111], a[64:67], v[228:231], 0
tr 224,52,12288
tr 226,52,12800
wl 10
 v_mfma_f32_16x16x32_bf16 v[112:115], a[0:3], v[232:235], 0
 v_xor_b32 v14, 128, v5
 s_add_u32 m0, s47, 4096
 s_nop 0
 buffer_load_dwordx4 v14, s[8:11], s50 offen lds
 s_add_u32 s50, s50, 2048
 v_mfma_f32_16x16x32_bf16 v[116:119], a[64:67], v[232:235], 0
tr 228,53,12288
tr 230,53,12800
 v_mfma_f32_16x16x32_bf16 v[120:123], a[0:3], v[236:239], 0
 v_xor_b32 v15, 160, v5
 s_add_u32 m0, s47, 5120
 s_nop 0
 buffer_load_dwordx4 v15, s[8:11], s50 offen lds
 s_add_u32 s50, s50, 2048
 v_mfma_f32_16x16x32_bf16 v[124:127], a[64:67], v[236:239], 0
 v_mfma_f32_16x16x32_bf16 v[40:43], a[0:3], a[0:3], 0
tr 232,54,12288
tr 234,54,12800
wl 10
 v_mfma_f32_16x16x32_bf16 v[128:131], a[0:3], v[208:211], 0
 v_xor_b32 v14, 192, v5
 s_add_u32 m0, s47, 6144
 s_nop 0
 buffer_load_dwordx4 v14, s[8:11], s50 offen lds
 s_add_u32 s50, s50, 2048
 v_mfma_f32_16x16x32_bf16 v[132:135], a[64:67], v[208:211], 0
 v_mfma_f32_16x16x32_bf16 v[184:187], v[208:211], v[48:51], 0
tr 236,55,12288
tr 238,55,12800
 v_mfma_f32_16x16x32_bf16 v[136:139], a[0:3], v[212:215], 0
 v_xor_b32 v15, 224, v5
 s_add_u32 m0, s47, 7168
 s_nop 0
 buffer_load_dwordx4 v15, s[8:11], s50 offen lds
 s_add_u32 s50, s50, 2048
 v_mfma_f32_16x16x32_bf16 v[140:143], a[64:67], v[212:215], 0
tr 208,52,13312
tr 210,52,13824
wl 10
 v_mfma_f32_16x16x32_bf16 v[144:147], a[0:3], v[216:219], 0
 v_xor_b32 v14, 0, v5
 s_add_u32 m0, s47, 8192
 s_nop 0
 buffer_load_dwordx4 v14, s[8:11], s50 offen lds
 s_add_u32 s50, s50, 2048
 v_mfma_f32_16x16x32_bf16 v[148:151], a[64:67], v[216:219], 0
 v_mfma_f32_16x16x32_bf16 v[44:47], a[64:67], a[64:67], 0
tr 212,53,13312
tr 214,53,13824
 v_mfma_f32_16x16x32_bf16 v[152:155], a[0:3], v[220:223], 0
 v_xor_b32 v15, 32, v5
 s_add_u32 m0, s47, 9216
 s_nop 0
 buffer_load_dwordx4 v15, s[8:11], s50 offen lds
 s_add_u32 s50, s50, 2048
 v_mfma_f32_16x16x32_bf16 v[156:159], a[64:67], v[220:223], 0
tr 216,54,13312
tr 218,54,13824
wl 10
mg 64,v,224,a,4,64
 v_xor_b32 v14, 64, v5
 s_add_u32 m0, s47, 10240
 s_nop 0
 buffer_load_dwordx4 v14, s[8:11], s50 offen lds
 s_add_u32 s50, s50, 2048
mg 68,v,224,a,68,68
mg 176,v,224,v,48,176
tr 220,55,13312
tr 222,55,13824
mg 72,v,228,a,4,72
 v_xor_b32 v15, 96, v5
 s_add_u32 m0, s47, 11264
 s_nop 0
 buffer_load_dwordx4 v15, s[8:11], s50 offen lds
 s_add_u32 s50, s50, 2048
mg 76,v,228,a,68,76
mg 32,v,48,a,4,32
tr 224,52,14336
tr 226,52,14848
wl 10
mg 80,v,232,a,4,80
 v_xor_b32 v14, 128, v5
 s_add_u32 m0, s47, 12288
 s_nop 0
 buffer_load_dwordx4 v14, s[8:11], s50 offen lds
 s_add_u32 s50, s50, 2048
mg 84,v,232,a,68,84
tr 228,53,14336
tr 230,53,14848
mg 88,v,236,a,4,88
 v_xor_b32 v15, 160, v5
 s_add_u32 m0, s47, 13312
 s_nop 0
 buffer_load_dwordx4 v15, s[8:11], s50 offen lds
 s_add_u32 s50, s50, 2048
mg 92,v,236,a,68,92
tr 232,54,14336
tr 234,54,14848
wl 10
mg 96,a,4,v,208,96
 v_xor_b32 v14, 192, v5
 s_add_u32 m0, s47, 14336
 s_nop 0
 buffer_load_dwordx4 v14, s[8:11], s50 offen lds
 s_add_u32 s50, s50, 2048
mg 100,a,68,v,208,100
mg 36,v,48,a,68,36
mg 180,v,208,v,48,180
tr 236,55,14336
tr 238,55,14848
mg 104,a,4,v,212,104
 v_xor_b32 v15, 224, v5
 s_add_u32 m0, s47, 15360
 s_nop 0
 buffer_load_dwordx4 v15, s[8:11], s50 offen lds
 s_add_u32 s50, s50, 2048
 s_sub_u32 s50, s50, 32256
mg 108,a,68,v,212,108
 s_waitcnt vmcnt(22) lgkmcnt(0)
 s_barrier
 s_add_u32 m0, s54, 65536
 s_nop 0
 buffer_load_dwordx4 v6, s[12:15], s46 offen offset:0 lds
 s_add_u32 m0, s54, 66432
 s_nop 0
 buffer_load_dwordx4 v6, s[12:15], s46 offen offset:128 lds
 s_add_u32 m0, s54, 67328
 s_nop 0
 buffer_load_dwordx4 v6, s[12:15], s46 offen offset:256 lds
 s_add_u32 m0, s54, 68608
 s_nop 0
 buffer_load_dwordx4 v7, s[12:15], s46 offen offset:0 lds
 s_add_u32 m0, s54, 69504
 s_nop 0
 buffer_load_dwordx4 v7, s[12:15], s46 offen offset:128 lds
 s_add_u32 m0, s54, 70400
 s_nop 0
 buffer_load_dwordx4 v7, s[12:15], s46 offen offset:256 lds
 s_add_u32 s46, s46, 196608
tr 208,52,28672
tr 210,52,29184
wl 10
mg 112,a,4,v,216,112
mg 116,a,68,v,216,116
tr 212,53,28672
tr 214,53,29184
mg 120,a,4,v,220,120
mg 124,a,68,v,220,124
mg 40,a,4,a,4,40
tr 216,54,28672
tr 218,54,29184
wl 10
mg 128,a,4,v,224,128
mg 132,a,68,v,224,132
mg 184,v,224,v,48,184
tr 220,55,28672
tr 222,55,29184
mg 136,a,4,v,228,136
mg 140,a,68,v,228,140
tr 224,52,29696
tr 226,52,30208
wl 10
mg 144,a,4,v,232,144
mg 148,a,68,v,232,148
mg 44,a,68,a,68,44
tr 228,53,29696
tr 230,53,30208
mg 152,a,4,v,236,152
mg 156,a,68,v,236,156
tr 232,54,29696
tr 234,54,30208
wl 10
mg 64,v,208,a,8,64
mg 68,v,208,a,72,68
mg 176,v,208,v,48,176
tr 236,55,29696
tr 238,55,30208
mg 72,v,212,a,8,72
mg 76,v,212,a,72,76
mg 32,v,48,a,8,32
tr 208,52,30720
tr 210,52,31232
wl 10
mg 80,v,216,a,8,80
mg 84,v,216,a,72,84
tr 212,53,30720
tr 214,53,31232
mg 88,v,220,a,8,88
mg 92,v,220,a,72,92
tr 216,54,30720
tr 218,54,31232
wl 10
mg 96,a,8,v,224,96
mg 100,a,72,v,224,100
mg 36,v,48,a,72,36
mg 180,v,224,v,48,180
tr 220,55,30720
tr 222,55,31232
mg 104,a,8,v,228,104
mg 108,a,72,v,228,108
tr 224,52,40960
tr 226,52,41472
wl 10
mg 112,a,8,v,232,112
mg 116,a,72,v,232,116
tr 228,53,40960
tr 230,53,41472
mg 120,a,8,v,236,120
mg 124,a,72,v,236,124
mg 40,a,8,a,8,40
tr 232,54,40960
tr 234,54,41472
wl 10
mg 128,a,8,v,208,128
mg 132,a,72,v,208,132
mg 184,v,208,v,48,184
tr 236,55,40960
tr 238,55,41472
mg 136,a,8,v,212,136
mg 140,a,72,v,212,140
tr 208,52,41984
tr 210,52,42496
wl 10
mg 144,a,8,v,216,144
mg 148,a,72,v,216,148
mg 44,a,72,a,72,44
tr 212,53,41984
tr 214,53,42496
mg 152,a,8,v,220,152
mg 156,a,72,v,220,156
tr 216,54,41984
tr 218,54,42496
wl 10
mg 64,v,224,a,12,64
mg 68,v,224,a,76,68
mg 176,v,224,v,48,176
tr 220,55,41984
tr 222,55,42496
mg 72,v,228,a,12,72
mg 76,v,228,a,76,76
mg 32,v,48,a,12,32
tr 224,52,43008
tr 226,52,43520
wl 10
mg 80,v,232,a,12,80
mg 84,v,232,a,76,84
tr 228,53,43008
tr 230,53,43520
mg 88,v,236,a,12,88
mg 92,v,236,a,76,92
tr 232,54,43008
tr 234,54,43520
wl 10
mg 96,a,12,v,208,96
mg 100,a,76,v,208,100
mg 36,v,48,a,76,36
mg 180,v,208,v,48,180
tr 236,55,43008
tr 238,55,43520
mg 104,a,12,v,212,104
mg 108,a,76,v,212,108
 s_waitcnt vmcnt(22) lgkmcnt(0)
 s_barrier
 s_add_u32 m0, s54, 94208
 s_nop 0
 buffer_load_dwordx4 v6, s[12:15], s46 offen offset:0 lds
 s_add_u32 m0, s54, 95104
 s_nop 0
 buffer_load_dwordx4 v6, s[12:15], s46 offen offset:128 lds
 s_add_u32 m0, s54, 96000
 s_nop 0
 buffer_load_dwordx4 v6, s[12:15], s46 offen offset:256 lds
 s_add_u32 m0, s54, 97280
 s_nop 0
 buffer_load_dwordx4 v7, s[12:15], s46 offen offset:0 lds
 s_add_u32 m0, s54, 98176
 s_nop 0
 buffer_load_dwordx4 v7, s[12:15], s46 offen offset:128 lds
 s_add_u32 m0, s54, 99072
 s_nop 0
 buffer_load_dwordx4 v7, s[12:15], s46 offen offset:256 lds
 s_add_u32 s46, s46, 196608
tr 208,56,0
tr 210,56,512
wl 10
mg 112,a,12,v,216,112
mg 116,a,76,v,216,116
tr 212,57,0
tr 214,57,512
mg 120,a,12,v,220,120
mg 124,a,76,v,220,124
mg 40,a,12,a,12,40
tr 216,58,0
tr 218,58,512
wl 10
mg 128,a,12,v,224,128
mg 132,a,76,v,224,132
mg 184,v,224,v,48,184
tr 220,59,0
tr 222,59,512
mg 136,a,12,v,228,136
mg 140,a,76,v,228,140
tr 224,56,1024
tr 226,56,1536
wl 10
mg 144,a,12,v,232,144
mg 148,a,76,v,232,148
mg 44,a,76,a,76,44
tr 228,57,1024
tr 230,57,1536
mg 152,a,12,v,236,152
mg 156,a,76,v,236,156
tr 232,58,1024
tr 234,58,1536
wl 10
mg 64,v,208,a,16,64
mg 68,v,208,a,80,68
mg 176,v,208,v,48,176
tr 236,59,1024
tr 238,59,1536
mg 72,v,212,a,16,72
mg 76,v,212,a,80,76
mg 32,v,48,a,16,32
tr 208,56,2048
tr 210,56,2560
wl 10
mg 80,v,216,a,16,80
mg 84,v,216,a,80,84
tr 212,57,2048
tr 214,57,2560
mg 88,v,220,a,16,88
mg 92,v,220,a,80,92
tr 216,58,2048
tr 218,58,2560
wl 10
mg 96,a,16,v,224,96
mg 100,a,80,v,224,100
mg 36,v,48,a,80,36
mg 180,v,224,v,48,180
tr 220,59,2048
tr 222,59,2560
mg 104,a,16,v,228,104
mg 108,a,80,v,228,108
tr 224,56,12288
tr 226,56,12800
wl 10
mg 112,a,16,v,232,112
mg 116,a,80,v,232,116
tr 228,57,12288
tr 230,57,12800
mg 120,a,16,v,236,120
mg 124,a,80,v,236,124
mg 40,a,16,a,16,40
tr 232,58,12288
tr 234,58,12800
wl 10
mg 128,a,16,v,208,128
mg 132,a,80,v,208,132
mg 184,v,208,v,48,184
tr 236,59,12288
tr 238,59,12800
mg 136,a,16,v,212,136
mg 140,a,80,v,212,140
tr 208,56,13312
tr 210,56,13824
wl 10
mg 144,a,16,v,216,144
mg 148,a,80,v,216,148
mg 44,a,80,a,80,44
tr 212,57,13312
tr 214,57,13824
mg 152,a,16,v,220,152
mg 156,a,80,v,220,156
tr 216,58,13312
tr 218,58,13824
wl 10
mg 64,v,224,a,20,64
mg 68,v,224,a,84,68
mg 176,v,224,v,48,176
tr 220,59,13312
tr 222,59,13824
mg 72,v,228,a,20,72
mg 76,v,228,a,84,76
mg 32,v,48,a,20,32
tr 224,56,14336
tr 226,56,14848
wl 10
mg 80,v,232,a,20,80
mg 84,v,232,a,84,84
tr 228,57,14336
tr 230,57,14848
mg 88,v,236,a,20,88
mg 92,v,236,a,84,92
tr 232,58,14336
tr 234,58,14848
wl 10
mg 96,a,20,v,208,96
mg 100,a,84,v,208,100
mg 36,v,48,a,84,36
mg 180,v,208,v,48,180
tr 236,59,14336
tr 238,59,14848
mg 104,a,20,v,212,104
mg 108,a,84,v,212,108
 s_waitcnt vmcnt(6) lgkmcnt(0)
 s_barrier
 s_add_u32 m0, s54, 122880
 s_nop 0
 buffer_load_dwordx4 v6, s[12:15], s46 offen offset:0 lds
 s_add_u32 m0, s54, 123776
 s_nop 0
 buffer_load_dwordx4 v6, s[12:15], s46 offen offset:128 lds
 s_add_u32 m0, s54, 124672
 s_nop 0
 buffer_load_dwordx4 v6, s[12:15], s46 offen offset:256 lds
 s_add_u32 m0, s54, 125952
 s_nop 0
 buffer_load_dwordx4 v7, s[12:15], s46 offen offset:0 lds
 s_add_u32 m0, s54, 126848
 s_nop 0
 buffer_load_dwordx4 v7, s[12:15], s46 offen offset:128 lds
 s_add_u32 m0, s54, 127744
 s_nop 0
 buffer_load_dwordx4 v7, s[12:15], s46 offen offset:256 lds
 s_add_u32 s46, s46, 196608
 ds_read_b128 a[32:35], v28 offset:0
 ds_read_b128 a[36:39], v29 offset:0
 ds_read_b128 a[40:43], v30 offset:0
 ds_read_b128 a[44:47], v31 offset:0
 ds_read_b128 a[48:51], v28 offset:256
 ds_read_b128 a[52:55], v29 offset:256
 ds_read_b128 a[56:59], v30 offset:256
 ds_read_b128 a[60:63], v31 offset:256
 ds_read_b128 a[96:99], v28 offset:8192
 ds_read_b128 a[100:103], v29 offset:8192
 ds_read_b128 a[104:107], v30 offset:8192
 ds_read_b128 a[108:111], v31 offset:8192
 ds_read_b128 a[112:115], v28 offset:8448
 ds_read_b128 a[116:119], v29 offset:8448
 ds_read_b128 a[120:123], v30 offset:8448
 ds_read_b128 a[124:127], v31 offset:8448
tr 208,52,0
tr 210,52,512
wl 10
mg 112,a,20,v,216,112
mg 116,a,84,v,216,116
tr 212,53,0
tr 214,53,512
mg 120,a,20,v,220,120
mg 124,a,84,v,220,124
mg 40,a,20,a,20,40
tr 216,54,0
tr 218,54,512
wl 10
mg 128,a,20,v,224,128
mg 132,a,84,v,224,132
mg 184,v,224,v,48,184
tr 220,55,0
tr 222,55,512
mg 136,a,20,v,228,136
mg 140,a,84,v,228,140
tr 224,52,1024
tr 226,52,1536
wl 10
mg 144,a,20,v,232,144
mg 148,a,84,v,232,148
mg 44,a,84,a,84,44
tr 228,53,1024
tr 230,53,1536
mg 152,a,20,v,236,152
mg 156,a,84,v,236,156
tr 232,54,1024
tr 234,54,1536
wl 10
mg 64,v,208,a,24,64
mg 68,v,208,a,88,68
mg 176,v,208,v,48,176
tr 236,55,1024
tr 238,55,1536
mg 72,v,212,a,24,72
mg 76,v,212,a,88,76
mg 32,v,48,a,24,32
tr 208,52,2048
tr 210,52,2560
wl 10
mg 80,v,216,a,24,80
mg 84,v,216,a,88,84
tr 212,53,2048
tr 214,53,2560
mg 88,v,220,a,24,88
mg 92,v,220,a,88,92
tr 216,54,2048
tr 218,54,2560
wl 10
mg 96,a,24,v,224,96
mg 100,a,88,v,224,100
mg 36,v,48,a,88,36
mg 180,v,224,v,48,180
tr 220,55,2048
tr 222,55,2560
mg 104,a,24,v,228,104
mg 108,a,88,v,228,108
tr 224,52,12288
tr 226,52,12800
wl 10
mg 112,a,24,v,232,112
mg 116,a,88,v,232,116
tr 228,53,12288
tr 230,53,12800
mg 120,a,24,v,236,120
mg 124,a,88,v,236,124
mg 40,a,24,a,24,40
tr 232,54,12288
tr 234,54,12800
wl 10
mg 128,a,24,v,208,128
mg 132,a,88,v,208,132
mg 184,v,208,v,48,184
tr 236,55,12288
tr 238,55,12800
mg 136,a,24,v,212,136
mg 140,a,88,v,212,140
tr 208,52,13312
tr 210,52,13824
wl 10
mg 144,a,24,v,216,144
mg 148,a,88,v,216,148
mg 44,a,88,a,88,44
tr 212,53,13312
tr 214,53,13824
mg 152,a,24,v,220,152
mg 156,a,88,v,220,156
tr 216,54,13312
tr 218,54,13824
wl 10
mg 64,v,224,a,28,64
mg 68,v,224,a,92,68
mg 176,v,224,v,48,176
tr 220,55,13312
tr 222,55,13824
mg 72,v,228,a,28,72
mg 76,v,228,a,92,76
mg 32,v,48,a,28,32
tr 224,52,14336
tr 226,52,14848
wl 10
mg 80,v,232,a,28,80
mg 84,v,232,a,92,84
tr 228,53,14336
tr 230,53,14848
mg 88,v,236,a,28,88
mg 92,v,236,a,92,92
tr 232,54,14336
tr 234,54,14848
wl 10
mg 96,a,28,v,208,96
mg 100,a,92,v,208,100
mg 36,v,48,a,92,36
mg 180,v,208,v,48,180
tr 236,55,14336
tr 238,55,14848
mg 104,a,28,v,212,104
mg 108,a,92,v,212,108
 s_waitcnt vmcnt(6) lgkmcnt(0)
 s_barrier
 s_cmp_ge_u32 s51, 576
 s_cbranch_scc1 K1_KV_nojob0
 v_lshrrev_b32 v22, 3, v1
 v_and_b32 v23, 7, v1
 v_and_b32 v24, 2, v22
 v_xor_b32 v23, v23, v24
 v_lshlrev_b32 v22, 10, v22
 v_lshl_add_u32 v24, v23, 4, v22
 v_xor_b32 v23, 4, v23
 v_lshl_add_u32 v25, v23, 4, v22
 s_add_u32 m0, s47, 0
 s_nop 0
 buffer_load_dwordx4 v24, s[20:23], s57 offen lds
 s_add_u32 s57, s57, 8192
 s_add_u32 m0, s47, 1024
 s_nop 0
 buffer_load_dwordx4 v25, s[20:23], s57 offen lds
 s_add_u32 s57, s57, 8192
 s_add_u32 m0, s47, 2048
 s_nop 0
 buffer_load_dwordx4 v24, s[20:23], s57 offen lds
 s_add_u32 s57, s57, 8192
 s_add_u32 m0, s47, 3072
 s_nop 0
 buffer_load_dwordx4 v25, s[20:23], s57 offen lds
 s_add_u32 s57, s57, 8192
K1_KV_nojob0:
 s_add_u32 m0, s54, 65536
 s_nop 0
 buffer_load_dwordx4 v6, s[12:15], s46 offen offset:0 lds
 s_add_u32 m0, s54, 66432
 s_nop 0
 buffer_load_dwordx4 v6, s[12:15], s46 offen offset:128 lds
 s_add_u32 m0, s54, 67328
 s_nop 0
 buffer_load_dwordx4 v6, s[12:15], s46 offen offset:256 lds
 s_add_u32 m0, s54, 68608
 s_nop 0
 buffer_load_dwordx4 v7, s[12:15], s46 offen offset:0 lds
 s_add_u32 m0, s54, 69504
 s_nop 0
 buffer_load_dwordx4 v7, s[12:15], s46 offen offset:128 lds
 s_add_u32 m0, s54, 70400
 s_nop 0
 buffer_load_dwordx4 v7, s[12:15], s46 offen offset:256 lds
 s_add_u32 s46, s46, 196608
tr 208,52,28672
tr 210,52,29184
wl 10
mg 112,a,28,v,216,112
mg 116,a,92,v,216,116
tr 212,53,28672
tr 214,53,29184
mg 120,a,28,v,220,120
mg 124,a,92,v,220,124
mg 40,a,28,a,28,40
tr 216,54,28672
tr 218,54,29184
wl 10
mg 128,a,28,v,224,128
mg 132,a,92,v,224,132
mg 184,v,224,v,48,184
tr 220,55,28672
tr 222,55,29184
mg 136,a,28,v,228,136
mg 140,a,92,v,228,140
tr 224,52,29696
tr 226,52,30208
wl 10
mg 144,a,28,v,232,144
mg 148,a,92,v,232,148
mg 44,a,92,a,92,44
tr 228,53,29696
tr 230,53,30208
mg 152,a,28,v,236,152
mg 156,a,92,v,236,156
tr 232,54,29696
tr 234,54,30208
wl 10
mg 64,v,208,a,32,64
mg 68,v,208,a,96,68
mg 176,v,208,v,48,176
tr 236,55,29696
tr 238,55,30208
mg 72,v,212,a,32,72
mg 76,v,212,a,96,76
mg 32,v,48,a,32,32
tr 208,52,30720
tr 210,52,31232
wl 10
mg 80,v,216,a,32,80
mg 84,v,216,a,96,84
tr 212,53,30720
tr 214,53,31232
mg 88,v,220,a,32,88
mg 92,v,220,a,96,92
tr 216,54,30720
tr 218,54,31232
wl 10
mg 96,a,32,v,224,96
mg 100,a,96,v,224,100
mg 36,v,48,a,96,36
mg 180,v,224,v,48,180
tr 220,55,30720
tr 222,55,31232
mg 104,a,32,v,228,104
mg 108,a,96,v,228,108
tr 224,52,40960
tr 226,52,41472
wl 10
mg 112,a,32,v,232,112
mg 116,a,96,v,232,116
tr 228,53,40960
tr 230,53,41472
mg 120,a,32,v,236,120
mg 124,a,96,v,236,124
mg 40,a,32,a,32,40
tr 232,54,40960
tr 234,54,41472
wl 10
mg 128,a,32,v,208,128
mg 132,a,96,v,208,132
mg 184,v,208,v,48,184
tr 236,55,40960
tr 238,55,41472
mg 136,a,32,v,212,136
mg 140,a,96,v,212,140
tr 208,52,41984
tr 210,52,42496
wl 10
mg 144,a,32,v,216,144
mg 148,a,96,v,216,148
mg 44,a,96,a,96,44
tr 212,53,41984
tr 214,53,42496
mg 152,a,32,v,220,152
mg 156,a,96,v,220,156
tr 216,54,41984
tr 218,54,42496
wl 10
mg 64,v,224,a,36,64
mg 68,v,224,a,100,68
mg 176,v,224,v,48,176
tr 220,55,41984
tr 222,55,42496
mg 72,v,228,a,36,72
mg 76,v,228,a,100,76
mg 32,v,48,a,36,32
tr 224,52,43008
tr 226,52,43520
wl 10
mg 80,v,232,a,36,80
mg 84,v,232,a,100,84
tr 228,53,43008
tr 230,53,43520
mg 88,v,236,a,36,88
mg 92,v,236,a,100,92
tr 232,54,43008
tr 234,54,43520
wl 10
mg 96,a,36,v,208,96
mg 100,a,100,v,208,100
mg 36,v,48,a,100,36
mg 180,v,208,v,48,180
tr 236,55,43008
tr 238,55,43520
mg 104,a,36,v,212,104
mg 108,a,100,v,212,108
 s_waitcnt vmcnt(6) lgkmcnt(0)
 s_barrier
 s_add_u32 m0, s54, 94208
 s_nop 0
 buffer_load_dwordx4 v6, s[12:15], s46 offen offset:0 lds
 s_add_u32 m0, s54, 95104
 s_nop 0
 buffer_load_dwordx4 v6, s[12:15], s46 offen offset:128 lds
 s_add_u32 m0, s54, 96000
 s_nop 0
 buffer_load_dwordx4 v6, s[12:15], s46 offen offset:256 lds
 s_add_u32 m0, s54, 97280
 s_nop 0
 buffer_load_dwordx4 v7, s[12:15], s46 offen offset:0 lds
 s_add_u32 m0, s54, 98176
 s_nop 0
 buffer_load_dwordx4 v7, s[12:15], s46 offen offset:128 lds
 s_add_u32 m0, s54, 99072
 s_nop 0
 buffer_load_dwordx4 v7, s[12:15], s46 offen offset:256 lds
 s_add_u32 s46, s46, 196608
 s_cmp_ge_u32 s51, 576
 s_cbranch_scc1 K1_KV_nojob
 s_sub_u32 s48, s47, 65536
 v_lshlrev_b32 v14, 11, v2
 v_sub_u32 v14, s48, v14
 v_add_u32 v16, v14, v52
 v_add_u32 v17, v14, v53
 v_add_u32 v18, v14, v54
 v_add_u32 v19, v14, v55
tr 192,16,0
tr 194,16,512
tr 196,17,0
tr 198,17,512
tr 200,18,0
tr 202,18,512
tr 204,19,0
tr 206,19,512
 s_and_b32 s48, s51, 7
 s_mul_i32 s48, s48, 288
 s_lshr_b32 s52, s51, 3
 s_add_u32 s48, s48, s52
 s_lshl_b32 s48, s48, 10
 s_add_u32 s48, s48, 20971520
wl 0
 s_mul_i32 s52, s24, 73728
 s_add_u32 s52, s52, s48
 buffer_store_dwordx4 v[192:195], v4, s[16:19], s52 offen sc1
 s_mul_i32 s52, s25, 73728
 s_add_u32 s52, s52, s48
 buffer_store_dwordx4 v[196:199], v4, s[16:19], s52 offen sc1
 s_mul_i32 s52, s26, 73728
 s_add_u32 s52, s52, s48
 buffer_store_dwordx4 v[200:203], v4, s[16:19], s52 offen sc1
 s_mul_i32 s52, s27, 73728
 s_add_u32 s52, s52, s48
 buffer_store_dwordx4 v[204:207], v4, s[16:19], s52 offen sc1
K1_KV_nojob:
tr 208,56,0
tr 210,56,512
wl 10
mg 112,a,36,v,216,112
mg 116,a,100,v,216,116
tr 212,57,0
tr 214,57,512
mg 120,a,36,v,220,120
mg 124,a,100,v,220,124
mg 40,a,36,a,36,40
tr 216,58,0
tr 218,58,512
wl 10
mg 128,a,36,v,224,128
mg 132,a,100,v,224,132
mg 184,v,224,v,48,184
tr 220,59,0
tr 222,59,512
mg 136,a,36,v,228,136
mg 140,a,100,v,228,140
tr 224,56,1024
tr 226,56,1536
wl 10
mg 144,a,36,v,232,144
mg 148,a,100,v,232,148
mg 44,a,100,a,100,44
tr 228,57,1024
tr 230,57,1536
mg 152,a,36,v,236,152
mg 156,a,100,v,236,156
tr 232,58,1024
tr 234,58,1536
wl 10
mg 64,v,208,a,40,64
mg 68,v,208,a,104,68
mg 176,v,208,v,48,176
tr 236,59,1024
tr 238,59,1536
mg 72,v,212,a,40,72
mg 76,v,212,a,104,76
mg 32,v,48,a,40,32
tr 208,56,2048
tr 210,56,2560
wl 10
mg 80,v,216,a,40,80
mg 84,v,216,a,104,84
tr 212,57,2048
tr 214,57,2560
mg 88,v,220,a,40,88
mg 92,v,220,a,104,92
tr 216,58,2048
tr 218,58,2560
wl 10
mg 96,a,40,v,224,96
mg 100,a,104,v,224,100
mg 36,v,48,a,104,36
mg 180,v,224,v,48,180
tr 220,59,2048
tr 222,59,2560
mg 104,a,40,v,228,104
mg 108,a,104,v,228,108
tr 224,56,12288
tr 226,56,12800
wl 10
mg 112,a,40,v,232,112
mg 116,a,104,v,232,116
tr 228,57,12288
tr 230,57,12800
mg 120,a,40,v,236,120
mg 124,a,104,v,236,124
mg 40,a,40,a,40,40
tr 232,58,12288
tr 234,58,12800
wl 10
mg 128,a,40,v,208,128
mg 132,a,104,v,208,132
mg 184,v,208,v,48,184
tr 236,59,12288
tr 238,59,12800
mg 136,a,40,v,212,136
mg 140,a,104,v,212,140
tr 208,56,13312
tr 210,56,13824
wl 10
mg 144,a,40,v,216,144
mg 148,a,104,v,216,148
mg 44,a,104,a,104,44
tr 212,57,13312
tr 214,57,13824
mg 152,a,40,v,220,152
mg 156,a,104,v,220,156
tr 216,58,13312
tr 218,58,13824
wl 10
mg 64,v,224,a,44,64
mg 68,v,224,a,108,68
mg 176,v,224,v,48,176
tr 220,59,13312
tr 222,59,13824
mg 72,v,228,a,44,72
mg 76,v,228,a,108,76
mg 32,v,48,a,44,32
tr 224,56,14336
tr 226,56,14848
wl 10
mg 80,v,232,a,44,80
mg 84,v,232,a,108,84
tr 228,57,14336
tr 230,57,14848
mg 88,v,236,a,44,88
mg 92,v,236,a,108,92
tr 232,58,14336
tr 234,58,14848
wl 10
mg 96,a,44,v,208,96
mg 100,a,108,v,208,100
mg 36,v,48,a,108,36
mg 180,v,208,v,48,180
tr 236,59,14336
tr 238,59,14848
mg 104,a,44,v,212,104
mg 108,a,108,v,212,108
 s_waitcnt vmcnt(6) lgkmcnt(0)
 s_barrier
tr 208,52,0
tr 210,52,512
wl 10
mg 112,a,44,v,216,112
mg 116,a,108,v,216,116
tr 212,53,0
tr 214,53,512
mg 120,a,44,v,220,120
mg 124,a,108,v,220,124
mg 40,a,44,a,44,40
tr 216,54,0
tr 218,54,512
wl 10
mg 128,a,44,v,224,128
mg 132,a,108,v,224,132
mg 184,v,224,v,48,184
tr 220,55,0
tr 222,55,512
mg 136,a,44,v,228,136
mg 140,a,108,v,228,140
tr 224,52,1024
tr 226,52,1536
wl 10
mg 144,a,44,v,232,144
mg 148,a,108,v,232,148
mg 44,a,108,a,108,44
tr 228,53,1024
tr 230,53,1536
mg 152,a,44,v,236,152
mg 156,a,108,v,236,156
tr 232,54,1024
tr 234,54,1536
wl 10
mg 64,v,208,a,48,64
mg 68,v,208,a,112,68
mg 176,v,208,v,48,176
tr 236,55,1024
tr 238,55,1536
mg 72,v,212,a,48,72
mg 76,v,212,a,112,76
mg 32,v,48,a,48,32
tr 208,52,2048
tr 210,52,2560
wl 10
mg 80,v,216,a,48,80
mg 84,v,216,a,112,84
tr 212,53,2048
tr 214,53,2560
mg 88,v,220,a,48,88
mg 92,v,220,a,112,92
tr 216,54,2048
tr 218,54,2560
wl 10
mg 96,a,48,v,224,96
mg 100,a,112,v,224,100
mg 36,v,48,a,112,36
mg 180,v,224,v,48,180
tr 220,55,2048
tr 222,55,2560
mg 104,a,48,v,228,104
mg 108,a,112,v,228,108
tr 224,52,12288
tr 226,52,12800
wl 10
mg 112,a,48,v,232,112
mg 116,a,112,v,232,116
tr 228,53,12288
tr 230,53,12800
mg 120,a,48,v,236,120
mg 124,a,112,v,236,124
mg 40,a,48,a,48,40
tr 232,54,12288
tr 234,54,12800
wl 10
mg 128,a,48,v,208,128
mg 132,a,112,v,208,132
mg 184,v,208,v,48,184
tr 236,55,12288
tr 238,55,12800
mg 136,a,48,v,212,136
mg 140,a,112,v,212,140
tr 208,52,13312
tr 210,52,13824
wl 10
mg 144,a,48,v,216,144
mg 148,a,112,v,216,148
mg 44,a,112,a,112,44
tr 212,53,13312
tr 214,53,13824
mg 152,a,48,v,220,152
mg 156,a,112,v,220,156
tr 216,54,13312
tr 218,54,13824
wl 10
mg 64,v,224,a,52,64
mg 68,v,224,a,116,68
mg 176,v,224,v,48,176
tr 220,55,13312
tr 222,55,13824
mg 72,v,228,a,52,72
mg 76,v,228,a,116,76
mg 32,v,48,a,52,32
tr 224,52,14336
tr 226,52,14848
wl 10
mg 80,v,232,a,52,80
mg 84,v,232,a,116,84
tr 228,53,14336
tr 230,53,14848
mg 88,v,236,a,52,88
mg 92,v,236,a,116,92
tr 232,54,14336
tr 234,54,14848
wl 10
mg 96,a,52,v,208,96
mg 100,a,116,v,208,100
mg 36,v,48,a,116,36
mg 180,v,208,v,48,180
tr 236,55,14336
tr 238,55,14848
mg 104,a,52,v,212,104
mg 108,a,116,v,212,108
 s_waitcnt vmcnt(0) lgkmcnt(0)
 s_barrier
tr 208,52,28672
tr 210,52,29184
wl 10
mg 112,a,52,v,216,112
mg 116,a,116,v,216,116
tr 212,52,29696
tr 214,52,30208
mg 120,a,52,v,220,120
mg 124,a,116,v,220,124
mg 40,a,52,a,52,40
tr 216,52,30720
tr 218,52,31232
wl 10
mg 128,a,52,v,224,128
mg 132,a,116,v,224,132
mg 184,v,224,v,48,184
tr 220,52,40960
tr 222,52,41472
mg 136,a,52,v,228,136
mg 140,a,116,v,228,140
tr 224,52,41984
tr 226,52,42496
wl 10
mg 144,a,52,v,232,144
mg 148,a,116,v,232,148
mg 44,a,116,a,116,44
tr 228,52,43008
tr 230,52,43520
mg 152,a,52,v,236,152
mg 156,a,116,v,236,156
tr 232,53,28672
tr 234,53,29184
wl 10
mg 64,v,208,a,56,64
mg 68,v,208,a,120,68
mg 32,v,48,a,56,32
mg 44,a,120,a,120,44
mg 176,v,208,v,48,176
tr 236,53,40960
tr 238,53,41472
mg 96,a,56,v,212,96
mg 100,a,120,v,212,100
mg 36,v,48,a,120,36
mg 180,v,212,v,48,180
tr 208,54,28672
tr 210,54,29184
wl 10
mg 128,a,56,v,216,128
mg 132,a,120,v,216,132
mg 40,a,56,a,56,40
mg 184,v,216,v,48,184
tr 212,54,40960
tr 214,54,41472
mg 64,v,220,a,60,64
mg 68,v,220,a,124,68
mg 32,v,48,a,60,32
mg 44,a,124,a,124,44
mg 176,v,220,v,48,176
tr 216,55,28672
tr 218,55,29184
wl 10
mg 96,a,60,v,224,96
mg 100,a,124,v,224,100
mg 36,v,48,a,124,36
mg 180,v,224,v,48,180
tr 220,55,40960
tr 222,55,41472
mg 128,a,60,v,228,128
mg 132,a,124,v,228,132
mg 40,a,60,a,60,40
mg 184,v,228,v,48,184
tr 224,53,29696
tr 226,53,30208
wl 10
mg 72,v,232,a,56,72
mg 76,v,232,a,120,76
 s_lshl_b32 s48, s3, 6
 s_add_u32 s48, s48, 151552
 v_lshlrev_b32 v14, 4, v2
 v_add_u32 v15, s48, v14
 s_and_b32 s48, s3, 1
 s_lshl_b32 s48, s48, 6
 s_add_u32 s48, s48, 151552
 v_add_u32 v14, s48, v14
 s_nop 7
 ds_write_b128 v15, v[176:179] offset:0
 ds_write_b128 v15, v[180:183] offset:256
 ds_write_b128 v15, v[184:187] offset:512
 v_and_b32 v22, 3, v3
 v_cmp_eq_u32 vcc, 1, v22
 v_cndmask_b32 v40, v40, v41, vcc
 v_cndmask_b32 v44, v44, v45, vcc
 v_cmp_eq_u32 vcc, 2, v22
 v_cndmask_b32 v40, v40, v42, vcc
 v_cndmask_b32 v44, v44, v46, vcc
 v_cmp_eq_u32 vcc, 3, v22
 v_cndmask_b32 v40, v40, v43, vcc
 v_cndmask_b32 v44, v44, v47, vcc
 v_lshrrev_b32 v22, 2, v3
 v_lshl_add_u32 v22, v22, 4, v3
 v_lshlrev_b32 v22, 2, v22
 ds_bpermute_b32 v34, v22, v40
 ds_bpermute_b32 v38, v22, v44
tr 228,53,41984
tr 230,53,42496
mg 72,v,236,a,60,72
mg 76,v,236,a,124,76
tr 232,54,29696
tr 234,54,30208
wl 15
mg 80,v,208,a,56,80
mg 84,v,208,a,120,84
wl 4
 s_barrier
 s_mov_b32 s48, 989855744
 s_mov_b32 s52, 925353388
 v_mul_f32 v32, s48, v32
 v_mul_f32 v34, s48, v34
 v_fma_f32 v34, -v32, v32, v34
 v_max_f32 v34, 0, v34
 v_add_f32 v34, s52, v34
 v_rsq_f32 v10, v34
 v_sub_f32 v11, 0, v32
 v_mul_f32 v36, s48, v36
 v_mul_f32 v38, s48, v38
 v_fma_f32 v38, -v36, v36, v38
 v_max_f32 v38, 0, v38
 v_add_f32 v38, s52, v38
 v_rsq_f32 v12, v38
 v_sub_f32 v13, 0, v36
 v_lshlrev_b32 v26, 4, v2
 v_add_u32 v26, 151552, v26
 v_lshlrev_b32 v27, 2, v3
 v_add_u32 v27, 151552, v27
 v_lshlrev_b32 v22, 4, v2
 v_add_u32 v23, 0, v22
 ds_bpermute_b32 v240, v23, v10
 ds_bpermute_b32 v244, v23, v11
 ds_bpermute_b32 v248, v23, v12
 ds_bpermute_b32 v252, v23, v13
 v_add_u32 v23, 4, v22
 ds_bpermute_b32 v241, v23, v10
 ds_bpermute_b32 v245, v23, v11
 ds_bpermute_b32 v249, v23, v12
 ds_bpermute_b32 v253, v23, v13
 v_add_u32 v23, 8, v22
 ds_bpermute_b32 v242, v23, v10
 ds_bpermute_b32 v246, v23, v11
 ds_bpermute_b32 v250, v23, v12
 ds_bpermute_b32 v254, v23, v13
 v_add_u32 v23, 12, v22
 ds_bpermute_b32 v243, v23, v10
 ds_bpermute_b32 v247, v23, v11
 ds_bpermute_b32 v251, v23, v12
 ds_bpermute_b32 v255, v23, v13
 s_lshl_b32 s52, s24, 6
 v_add_u32 v196, s52, v26
rq 192,196,0
 s_lshl_b32 s52, s24, 6
 v_add_u32 v204, s52, v27
 ds_read_b32 v200, v204 offset:256
 v_and_b32 v16, 1, v2
 v_lshl_add_u32 v16, v16, 4, v3
 v_add_u32 v14, s45, v16
 v_lshlrev_b32 v14, 5, v14
 v_lshrrev_b32 v17, 1, v2
 v_lshl_add_u32 v14, v17, 4, v14
 s_lshl_b32 s48, s45, 5
 v_add_u32 v15, s48, v4
 s_lshl_b32 s48, s44, 12
tr 236,54,41984
tr 238,54,42496
mg 80,v,212,a,60,80
mg 84,v,212,a,124,84
 s_lshl_b32 s54, s24, 16
 s_add_u32 s54, s54, s48
 s_lshl_b32 s52, s24, 4
 s_add_u32 s52, s52, s44
 s_cmp_lt_u32 s52, 512
 s_cselect_b32 s52, 1052289595, 1.0
 v_mul_f32 v22, s52, v10
 v_mul_f32 v24, s52, v12
wl 3
 v_pk_fma_f32 v[64:65], v[192:193], v[10:11], v[64:65] op_sel:[0,1,0] op_sel_hi:[1,1,1]
 v_pk_fma_f32 v[66:67], v[194:195], v[10:11], v[66:67] op_sel:[0,1,0] op_sel_hi:[1,1,1]
 v_pk_mul_f32 v[64:65], v[64:65], v[22:23] op_sel:[0,0] op_sel_hi:[1,0]
 v_pk_mul_f32 v[66:67], v[66:67], v[22:23] op_sel:[0,0] op_sel_hi:[1,0]
pk 64,64,65
pk 65,66,67
 v_pk_fma_f32 v[68:69], v[192:193], v[12:13], v[68:69] op_sel:[0,1,0] op_sel_hi:[1,1,1]
 v_pk_fma_f32 v[70:71], v[194:195], v[12:13], v[70:71] op_sel:[0,1,0] op_sel_hi:[1,1,1]
 v_pk_mul_f32 v[68:69], v[68:69], v[24:25] op_sel:[0,0] op_sel_hi:[1,0]
 v_pk_mul_f32 v[70:71], v[70:71], v[24:25] op_sel:[0,0] op_sel_hi:[1,0]
pk 66,68,69
pk 67,70,71
 s_lshl_b32 s52, s24, 6
 v_add_u32 v196, s52, v27
 ds_read_b32 v192, v196 offset:512
 v_permlane16_swap_b32 v64, v66
 v_permlane16_swap_b32 v65, v67
 buffer_store_dwordx4 v[64:67], v14, s[16:19], s54 offen sc1
tr 208,55,29696
tr 210,55,30208
wl 15
mg 88,v,216,a,56,88
mg 92,v,216,a,120,92
 s_lshl_b32 s54, s24, 16
 s_add_u32 s54, s54, s48
 s_add_u32 s54, s54, 262144
wl 5
 v_pk_fma_f32 v[96:97], v[200:201], v[244:245], v[96:97] op_sel:[0,0,0] op_sel_hi:[0,1,1]
 v_pk_fma_f32 v[98:99], v[200:201], v[246:247], v[98:99] op_sel:[0,0,0] op_sel_hi:[0,1,1]
 v_pk_mul_f32 v[96:97], v[96:97], v[240:241]
 v_pk_mul_f32 v[98:99], v[98:99], v[242:243]
pk 96,96,97
pk 97,98,99
 v_pk_fma_f32 v[100:101], v[200:201], v[252:253], v[100:101] op_sel:[0,0,0] op_sel_hi:[0,1,1]
 v_pk_fma_f32 v[102:103], v[200:201], v[254:255], v[102:103] op_sel:[0,0,0] op_sel_hi:[0,1,1]
 v_pk_mul_f32 v[100:101], v[100:101], v[248:249]
 v_pk_mul_f32 v[102:103], v[102:103], v[250:251]
pk 98,100,101
pk 99,102,103
 s_lshl_b32 s52, s25, 6
 v_add_u32 v204, s52, v26
rq 200,204,0
 v_permlane32_swap_b32 v96, v98
 v_permlane32_swap_b32 v97, v99
 buffer_store_dwordx4 v[96:99], v15, s[16:19], s54 offen sc1
tr 212,55,41984
tr 214,55,42496
mg 88,v,220,a,60,88
mg 92,v,220,a,124,92
 s_lshl_b32 s54, s24, 16
 s_add_u32 s54, s54, s48
 s_add_u32 s54, s54, 524288
wl 5
 v_pk_fma_f32 v[128:129], v[192:193], v[244:245], v[128:129] op_sel:[0,0,0] op_sel_hi:[0,1,1]
 v_pk_fma_f32 v[130:131], v[192:193], v[246:247], v[130:131] op_sel:[0,0,0] op_sel_hi:[0,1,1]
 v_pk_mul_f32 v[128:129], v[128:129], v[240:241]
 v_pk_mul_f32 v[130:131], v[130:131], v[242:243]
pk 128,128,129
pk 129,130,131
 v_pk_fma_f32 v[132:133], v[192:193], v[252:253], v[132:133] op_sel:[0,0,0] op_sel_hi:[0,1,1]
 v_pk_fma_f32 v[134:135], v[192:193], v[254:255], v[134:135] op_sel:[0,0,0] op_sel_hi:[0,1,1]
 v_pk_mul_f32 v[132:133], v[132:133], v[248:249]
 v_pk_mul_f32 v[134:135], v[134:135], v[250:251]
pk 130,132,133
pk 131,134,135
 s_lshl_b32 s52, s26, 6
 v_add_u32 v196, s52, v26
rq 192,196,0
 v_permlane32_swap_b32 v128, v130
 v_permlane32_swap_b32 v129, v131
 buffer_store_dwordx4 v[128:131], v15, s[16:19], s54 offen sc1
tr 216,53,30720
tr 218,53,31232
wl 15
mg 104,a,56,v,224,104
mg 108,a,120,v,224,108
 s_lshl_b32 s54, s25, 16
 s_add_u32 s54, s54, s48
 s_lshl_b32 s52, s25, 4
 s_add_u32 s52, s52, s44
 s_cmp_lt_u32 s52, 512
 s_cselect_b32 s52, 1052289595, 1.0
 v_mul_f32 v22, s52, v10
 v_mul_f32 v24, s52, v12
wl 5
 v_pk_fma_f32 v[72:73], v[200:201], v[10:11], v[72:73] op_sel:[0,1,0] op_sel_hi:[1,1,1]
 v_pk_fma_f32 v[74:75], v[202:203], v[10:11], v[74:75] op_sel:[0,1,0] op_sel_hi:[1,1,1]
 v_pk_mul_f32 v[72:73], v[72:73], v[22:23] op_sel:[0,0] op_sel_hi:[1,0]
 v_pk_mul_f32 v[74:75], v[74:75], v[22:23] op_sel:[0,0] op_sel_hi:[1,0]
pk 72,72,73
pk 73,74,75
 v_pk_fma_f32 v[76:77], v[200:201], v[12:13], v[76:77] op_sel:[0,1,0] op_sel_hi:[1,1,1]
 v_pk_fma_f32 v[78:79], v[202:203], v[12:13], v[78:79] op_sel:[0,1,0] op_sel_hi:[1,1,1]
 v_pk_mul_f32 v[76:77], v[76:77], v[24:25] op_sel:[0,0] op_sel_hi:[1,0]
 v_pk_mul_f32 v[78:79], v[78:79], v[24:25] op_sel:[0,0] op_sel_hi:[1,0]
pk 74,76,77
pk 75,78,79
 s_lshl_b32 s52, s27, 6
 v_add_u32 v204, s52, v26
rq 200,204,0
 v_permlane16_swap_b32 v72, v74
 v_permlane16_swap_b32 v73, v75
 buffer_store_dwordx4 v[72:75], v14, s[16:19], s54 offen sc1
tr 220,53,43008
tr 222,53,43520
mg 104,a,60,v,228,104
mg 108,a,124,v,228,108
 s_lshl_b32 s54, s26, 16
 s_add_u32 s54, s54, s48
 s_lshl_b32 s52, s26, 4
 s_add_u32 s52, s52, s44
 s_cmp_lt_u32 s52, 512
 s_cselect_b32 s52, 1052289595, 1.0
 v_mul_f32 v22, s52, v10
 v_mul_f32 v24, s52, v12
wl 5
 v_pk_fma_f32 v[80:81], v[192:193], v[10:11], v[80:81] op_sel:[0,1,0] op_sel_hi:[1,1,1]
 v_pk_fma_f32 v[82:83], v[194:195], v[10:11], v[82:83] op_sel:[0,1,0] op_sel_hi:[1,1,1]
 v_pk_mul_f32 v[80:81], v[80:81], v[22:23] op_sel:[0,0] op_sel_hi:[1,0]
 v_pk_mul_f32 v[82:83], v[82:83], v[22:23] op_sel:[0,0] op_sel_hi:[1,0]
pk 80,80,81
pk 81,82,83
 v_pk_fma_f32 v[84:85], v[192:193], v[12:13], v[84:85] op_sel:[0,1,0] op_sel_hi:[1,1,1]
 v_pk_fma_f32 v[86:87], v[194:195], v[12:13], v[86:87] op_sel:[0,1,0] op_sel_hi:[1,1,1]
 v_pk_mul_f32 v[84:85], v[84:85], v[24:25] op_sel:[0,0] op_sel_hi:[1,0]
 v_pk_mul_f32 v[86:87], v[86:87], v[24:25] op_sel:[0,0] op_sel_hi:[1,0]
pk 82,84,85
pk 83,86,87
 s_lshl_b32 s52, s25, 6
 v_add_u32 v196, s52, v27
 ds_read_b32 v192, v196 offset:256
 v_permlane16_swap_b32 v80, v82
 v_permlane16_swap_b32 v81, v83
 buffer_store_dwordx4 v[80:83], v14, s[16:19], s54 offen sc1
tr 224,54,30720
tr 226,54,31232
wl 15
mg 112,a,56,v,232,112
mg 116,a,120,v,232,116
 s_lshl_b32 s54, s27, 16
 s_add_u32 s54, s54, s48
 s_lshl_b32 s52, s27, 4
 s_add_u32 s52, s52, s44
 s_cmp_lt_u32 s52, 512
 s_cselect_b32 s52, 1052289595, 1.0
 v_mul_f32 v22, s52, v10
 v_mul_f32 v24, s52, v12
wl 5
 v_pk_fma_f32 v[88:89], v[200:201], v[10:11], v[88:89] op_sel:[0,1,0] op_sel_hi:[1,1,1]
 v_pk_fma_f32 v[90:91], v[202:203], v[10:11], v[90:91] op_sel:[0,1,0] op_sel_hi:[1,1,1]
 v_pk_mul_f32 v[88:89], v[88:89], v[22:23] op_sel:[0,0] op_sel_hi:[1,0]
 v_pk_mul_f32 v[90:91], v[90:91], v[22:23] op_sel:[0,0] op_sel_hi:[1,0]
pk 88,88,89
pk 89,90,91
 v_pk_fma_f32 v[92:93], v[200:201], v[12:13], v[92:93] op_sel:[0,1,0] op_sel_hi:[1,1,1]
 v_pk_fma_f32 v[94:95], v[202:203], v[12:13], v[94:95] op_sel:[0,1,0] op_sel_hi:[1,1,1]
 v_pk_mul_f32 v[92:93], v[92:93], v[24:25] op_sel:[0,0] op_sel_hi:[1,0]
 v_pk_mul_f32 v[94:95], v[94:95], v[24:25] op_sel:[0,0] op_sel_hi:[1,0]
pk 90,92,93
pk 91,94,95
 s_lshl_b32 s52, s26, 6
 v_add_u32 v204, s52, v27
 ds_read_b32 v200, v204 offset:256
 v_permlane16_swap_b32 v88, v90
 v_permlane16_swap_b32 v89, v91
 buffer_store_dwordx4 v[88:91], v14, s[16:19], s54 offen sc1
tr 228,54,43008
tr 230,54,43520
mg 112,a,60,v,236,112
mg 116,a,124,v,236,116
 s_lshl_b32 s54, s25, 16
 s_add_u32 s54, s54, s48
 s_add_u32 s54, s54, 262144
wl 5
 v_pk_fma_f32 v[104:105], v[192:193], v[244:245], v[104:105] op_sel:[0,0,0] op_sel_hi:[0,1,1]
 v_pk_fma_f32 v[106:107], v[192:193], v[246:247], v[106:107] op_sel:[0,0,0] op_sel_hi:[0,1,1]
 v_pk_mul_f32 v[104:105], v[104:105], v[240:241]
 v_pk_mul_f32 v[106:107], v[106:107], v[242:243]
pk 104,104,105
pk 105,106,107
 v_pk_fma_f32 v[108:109], v[192:193], v[252:253], v[108:109] op_sel:[0,0,0] op_sel_hi:[0,1,1]
 v_pk_fma_f32 v[110:111], v[192:193], v[254:255], v[110:111] op_sel:[0,0,0] op_sel_hi:[0,1,1]
 v_pk_mul_f32 v[108:109], v[108:109], v[248:249]
 v_pk_mul_f32 v[110:111], v[110:111], v[250:251]
pk 106,108,109
pk 107,110,111
 s_lshl_b32 s52, s27, 6
 v_add_u32 v196, s52, v27
 ds_read_b32 v192, v196 offset:256
 v_permlane32_swap_b32 v104, v106
 v_permlane32_swap_b32 v105, v107
 buffer_store_dwordx4 v[104:107], v15, s[16:19], s54 offen sc1
tr 232,55,30720
tr 234,55,31232
wl 15
mg 120,a,56,v,208,120
mg 124,a,120,v,208,124
tr 236,55,43008
tr 238,55,43520
mg 120,a,60,v,212,120
mg 124,a,124,v,212,124
 s_lshl_b32 s54, s26, 16
 s_add_u32 s54, s54, s48
 s_add_u32 s54, s54, 262144
wl 7
 v_pk_fma_f32 v[112:113], v[200:201], v[244:245], v[112:113] op_sel:[0,0,0] op_sel_hi:[0,1,1]
 v_pk_fma_f32 v[114:115], v[200:201], v[246:247], v[114:115] op_sel:[0,0,0] op_sel_hi:[0,1,1]
 v_pk_mul_f32 v[112:113], v[112:113], v[240:241]
 v_pk_mul_f32 v[114:115], v[114:115], v[242:243]
pk 112,112,113
pk 113,114,115
 v_pk_fma_f32 v[116:117], v[200:201], v[252:253], v[116:117] op_sel:[0,0,0] op_sel_hi:[0,1,1]
 v_pk_fma_f32 v[118:119], v[200:201], v[254:255], v[118:119] op_sel:[0,0,0] op_sel_hi:[0,1,1]
 v_pk_mul_f32 v[116:117], v[116:117], v[248:249]
 v_pk_mul_f32 v[118:119], v[118:119], v[250:251]
pk 114,116,117
pk 115,118,119
 s_lshl_b32 s52, s25, 6
 v_add_u32 v204, s52, v27
 ds_read_b32 v200, v204 offset:512
 v_permlane32_swap_b32 v112, v114
 v_permlane32_swap_b32 v113, v115
 buffer_store_dwordx4 v[112:115], v15, s[16:19], s54 offen sc1
wl 12
mg 136,a,56,v,216,136
mg 140,a,120,v,216,140
mg 136,a,60,v,220,136
mg 140,a,124,v,220,140
 s_lshl_b32 s54, s27, 16
 s_add_u32 s54, s54, s48
 s_add_u32 s54, s54, 262144
wl 5
 v_pk_fma_f32 v[120:121], v[192:193], v[244:245], v[120:121] op_sel:[0,0,0] op_sel_hi:[0,1,1]
 v_pk_fma_f32 v[122:123], v[192:193], v[246:247], v[122:123] op_sel:[0,0,0] op_sel_hi:[0,1,1]
 v_pk_mul_f32 v[120:121], v[120:121], v[240:241]
 v_pk_mul_f32 v[122:123], v[122:123], v[242:243]
pk 120,120,121
pk 121,122,123
 v_pk_fma_f32 v[124:125], v[192:193], v[252:253], v[124:125] op_sel:[0,0,0] op_sel_hi:[0,1,1]
 v_pk_fma_f32 v[126:127], v[192:193], v[254:255], v[126:127] op_sel:[0,0,0] op_sel_hi:[0,1,1]
 v_pk_mul_f32 v[124:125], v[124:125], v[248:249]
 v_pk_mul_f32 v[126:127], v[126:127], v[250:251]
pk 122,124,125
pk 123,126,127
 s_lshl_b32 s52, s26, 6
 v_add_u32 v196, s52, v27
 ds_read_b32 v192, v196 offset:512
 v_permlane32_swap_b32 v120, v122
 v_permlane32_swap_b32 v121, v123
 buffer_store_dwordx4 v[120:123], v15, s[16:19], s54 offen sc1
wl 7
mg 144,a,56,v,224,144
mg 148,a,120,v,224,148
mg 144,a,60,v,228,144
mg 148,a,124,v,228,148
 s_lshl_b32 s54, s25, 16
 s_add_u32 s54, s54, s48
 s_add_u32 s54, s54, 524288
wl 1
 v_pk_fma_f32 v[136:137], v[200:201], v[244:245], v[136:137] op_sel:[0,0,0] op_sel_hi:[0,1,1]
 v_pk_fma_f32 v[138:139], v[200:201], v[246:247], v[138:139] op_sel:[0,0,0] op_sel_hi:[0,1,1]
 v_pk_mul_f32 v[136:137], v[136:137], v[240:241]
 v_pk_mul_f32 v[138:139], v[138:139], v[242:243]
pk 136,136,137
pk 137,138,139
 v_pk_fma_f32 v[140:141], v[200:201], v[252:253], v[140:141] op_sel:[0,0,0] op_sel_hi:[0,1,1]
 v_pk_fma_f32 v[142:143], v[200:201], v[254:255], v[142:143] op_sel:[0,0,0] op_sel_hi:[0,1,1]
 v_pk_mul_f32 v[140:141], v[140:141], v[248:249]
 v_pk_mul_f32 v[142:143], v[142:143], v[250:251]
pk 138,140,141
pk 139,142,143
 s_lshl_b32 s52, s27, 6
 v_add_u32 v204, s52, v27
 ds_read_b32 v200, v204 offset:512
 v_permlane32_swap_b32 v136, v138
 v_permlane32_swap_b32 v137, v139
 buffer_store_dwordx4 v[136:139], v15, s[16:19], s54 offen sc1
wl 3
mg 152,a,56,v,232,152
mg 156,a,120,v,232,156
mg 152,a,60,v,236,152
mg 156,a,124,v,236,156
 s_lshl_b32 s54, s26, 16
 s_add_u32 s54, s54, s48
 s_add_u32 s54, s54, 524288
wl 1
 v_pk_fma_f32 v[144:145], v[192:193], v[244:245], v[144:145] op_sel:[0,0,0] op_sel_hi:[0,1,1]
 v_pk_fma_f32 v[146:147], v[192:193], v[246:247], v[146:147] op_sel:[0,0,0] op_sel_hi:[0,1,1]
 v_pk_mul_f32 v[144:145], v[144:145], v[240:241]
 v_pk_mul_f32 v[146:147], v[146:147], v[242:243]
pk 144,144,145
pk 145,146,147
 v_pk_fma_f32 v[148:149], v[192:193], v[252:253], v[148:149] op_sel:[0,0,0] op_sel_hi:[0,1,1]
 v_pk_fma_f32 v[150:151], v[192:193], v[254:255], v[150:151] op_sel:[0,0,0] op_sel_hi:[0,1,1]
 v_pk_mul_f32 v[148:149], v[148:149], v[248:249]
 v_pk_mul_f32 v[150:151], v[150:151], v[250:251]
pk 146,148,149
pk 147,150,151
 s_nop 1
 v_permlane32_swap_b32 v144, v146
 v_permlane32_swap_b32 v145, v147
 buffer_store_dwordx4 v[144:147], v15, s[16:19], s54 offen sc1
 s_nop 7
 s_lshl_b32 s54, s27, 16
 s_add_u32 s54, s54, s48
 s_add_u32 s54, s54, 524288
wl 0
 v_pk_fma_f32 v[152:153], v[200:201], v[244:245], v[152:153] op_sel:[0,0,0] op_sel_hi:[0,1,1]
 v_pk_fma_f32 v[154:155], v[200:201], v[246:247], v[154:155] op_sel:[0,0,0] op_sel_hi:[0,1,1]
 v_pk_mul_f32 v[152:153], v[152:153], v[240:241]
 v_pk_mul_f32 v[154:155], v[154:155], v[242:243]
pk 152,152,153
pk 153,154,155
 v_pk_fma_f32 v[156:157], v[200:201], v[252:253], v[156:157] op_sel:[0,0,0] op_sel_hi:[0,1,1]
 v_pk_fma_f32 v[158:159], v[200:201], v[254:255], v[158:159] op_sel:[0,0,0] op_sel_hi:[0,1,1]
 v_pk_mul_f32 v[156:157], v[156:157], v[248:249]
 v_pk_mul_f32 v[158:159], v[158:159], v[250:251]
pk 154,156,157
pk 155,158,159
 s_nop 1
 v_permlane32_swap_b32 v152, v154
 v_permlane32_swap_b32 v153, v155
 buffer_store_dwordx4 v[152:155], v15, s[16:19], s54 offen sc1
 s_endpgm
K1_VV:
 s_lshl_b32 s47, s3, 14
 s_lshl_b32 s50, s45, 10
 v_lshrrev_b32 v14, 5, v1
 v_and_b32 v15, 31, v1
 v_xor_b32 v15, v15, v14
 v_lshlrev_b32 v15, 4, v15
 v_lshl_add_u32 v5, v14, 10, v15
 v_xor_b32 v14, 0, v5
 s_add_u32 m0, s47, 0
 s_nop 0
 buffer_load_dwordx4 v14, s[8:11], s50 offen lds
 s_add_u32 s50, s50, 2048
 v_xor_b32 v15, 32, v5
 s_add_u32 m0, s47, 1024
 s_nop 0
 buffer_load_dwordx4 v15, s[8:11], s50 offen lds
 s_add_u32 s50, s50, 2048
 v_xor_b32 v14, 64, v5
 s_add_u32 m0, s47, 2048
 s_nop 0
 buffer_load_dwordx4 v14, s[8:11], s50 offen lds
 s_add_u32 s50, s50, 2048
 v_xor_b32 v15, 96, v5
 s_add_u32 m0, s47, 3072
 s_nop 0
 buffer_load_dwordx4 v15, s[8:11], s50 offen lds
 s_add_u32 s50, s50, 2048
 v_xor_b32 v14, 128, v5
 s_add_u32 m0, s47, 4096
 s_nop 0
 buffer_load_dwordx4 v14, s[8:11], s50 offen lds
 s_add_u32 s50, s50, 2048
 v_xor_b32 v15, 160, v5
 s_add_u32 m0, s47, 5120
 s_nop 0
 buffer_load_dwordx4 v15, s[8:11], s50 offen lds
 s_add_u32 s50, s50, 2048
 v_xor_b32 v14, 192, v5
 s_add_u32 m0, s47, 6144
 s_nop 0
 buffer_load_dwordx4 v14, s[8:11], s50 offen lds
 s_add_u32 s50, s50, 2048
 v_xor_b32 v15, 224, v5
 s_add_u32 m0, s47, 7168
 s_nop 0
 buffer_load_dwordx4 v15, s[8:11], s50 offen lds
 s_add_u32 s50, s50, 2048
 v_xor_b32 v14, 0, v5
 s_add_u32 m0, s47, 8192
 s_nop 0
 buffer_load_dwordx4 v14, s[8:11], s50 offen lds
 s_add_u32 s50, s50, 2048
 v_xor_b32 v15, 32, v5
 s_add_u32 m0, s47, 9216
 s_nop 0
 buffer_load_dwordx4 v15, s[8:11], s50 offen lds
 s_add_u32 s50, s50, 2048
 v_xor_b32 v14, 64, v5
 s_add_u32 m0, s47, 10240
 s_nop 0
 buffer_load_dwordx4 v14, s[8:11], s50 offen lds
 s_add_u32 s50, s50, 2048
 v_xor_b32 v15, 96, v5
 s_add_u32 m0, s47, 11264
 s_nop 0
 buffer_load_dwordx4 v15, s[8:11], s50 offen lds
 s_add_u32 s50, s50, 2048
 v_xor_b32 v14, 128, v5
 s_add_u32 m0, s47, 12288
 s_nop 0
 buffer_load_dwordx4 v14, s[8:11], s50 offen lds
 s_add_u32 s50, s50, 2048
 v_xor_b32 v15, 160, v5
 s_add_u32 m0, s47, 13312
 s_nop 0
 buffer_load_dwordx4 v15, s[8:11], s50 offen lds
 s_add_u32 s50, s50, 2048
 v_xor_b32 v14, 192, v5
 s_add_u32 m0, s47, 14336
 s_nop 0
 buffer_load_dwordx4 v14, s[8:11], s50 offen lds
 s_add_u32 s50, s50, 2048
 v_xor_b32 v15, 224, v5
 s_add_u32 m0, s47, 15360
 s_nop 0
 buffer_load_dwordx4 v15, s[8:11], s50 offen lds
 s_add_u32 s50, s50, 2048
 s_sub_u32 s50, s50, 32256
 s_mov_b32 s48, 3072
 v_lshrrev_b32 v14, 3, v1
 v_mul_lo_u32 v15, v14, s48
 v_and_b32 v16, 7, v1
 v_and_b32 v17, 2, v14
 v_xor_b32 v16, v16, v17
 v_lshl_add_u32 v6, v16, 4, v15
 v_xor_b32 v16, 4, v16
 v_lshl_add_u32 v7, v16, 4, v15
 v_add_u32 v7, 24576, v7
 s_mul_i32 s46, s3, 49152
 s_lshl_b32 s48, s44, 1
 s_add_u32 s46, s46, s48
 s_mul_i32 s54, s3, 6144
 s_lshl_b32 s56, s3, 10
 s_add_u32 m0, s54, 65536
 s_nop 0
 buffer_load_dwordx4 v6, s[12:15], s46 offen offset:0 lds
 s_add_u32 m0, s54, 66432
 s_nop 0
 buffer_load_dwordx4 v6, s[12:15], s46 offen offset:128 lds
 s_add_u32 m0, s54, 67328
 s_nop 0
 buffer_load_dwordx4 v6, s[12:15], s46 offen offset:256 lds
 s_add_u32 m0, s54, 68608
 s_nop 0
 buffer_load_dwordx4 v7, s[12:15], s46 offen offset:0 lds
 s_add_u32 m0, s54, 69504
 s_nop 0
 buffer_load_dwordx4 v7, s[12:15], s46 offen offset:128 lds
 s_add_u32 m0, s54, 70400
 s_nop 0
 buffer_load_dwordx4 v7, s[12:15], s46 offen offset:256 lds
 s_add_u32 s46, s46, 196608
 v_lshlrev_b32 v14, 9, v3
 v_add_u32 v14, s47, v14
 v_or_b32 v15, 0, v2
 v_xor_b32 v15, v15, v3
 v_lshl_add_u32 v28, v15, 4, v14
 v_or_b32 v15, 4, v2
 v_xor_b32 v15, v15, v3
 v_lshl_add_u32 v29, v15, 4, v14
 v_or_b32 v15, 8, v2
 v_xor_b32 v15, v15, v3
 v_lshl_add_u32 v30, v15, 4, v14
 v_or_b32 v15, 12, v2
 v_xor_b32 v15, v15, v3
 v_lshl_add_u32 v31, v15, 4, v14
 v_bfe_u32 v14, v1, 2, 2
 v_and_b32 v15, 1, v1
 v_lshlrev_b32 v15, 3, v15
 v_bfe_u32 v16, v1, 1, 1
 v_lshl_add_u32 v15, v16, 4, v15
 v_lshrrev_b32 v16, 1, v14
 v_and_b32 v17, 1, v2
 v_lshl_add_u32 v16, v17, 1, v16
 s_movk_i32 s48, 3072
 v_mul_lo_u32 v18, v2, s48
 v_lshl_add_u32 v18, v14, 7, v18
 v_add_u32 v18, v18, v15
 s_xor_b32 s24, s3, 0
 s_xor_b32 s25, s3, 1
 s_xor_b32 s26, s3, 2
 s_xor_b32 s27, s3, 3
 v_xor_b32 v19, s24, v16
 v_lshl_add_u32 v19, v19, 5, v18
 v_add_u32 v52, 65536, v19
 v_add_u32 v56, 122880, v19
 v_xor_b32 v19, s25, v16
 v_lshl_add_u32 v19, v19, 5, v18
 v_add_u32 v53, 65536, v19
 v_add_u32 v57, 122880, v19
 v_xor_b32 v19, s26, v16
 v_lshl_add_u32 v19, v19, 5, v18
 v_add_u32 v54, 65536, v19
 v_add_u32 v58, 122880, v19
 v_xor_b32 v19, s27, v16
 v_lshl_add_u32 v19, v19, 5, v18
 v_add_u32 v55, 65536, v19
 v_add_u32 v59, 122880, v19
 v_mov_b32 v48, s49
 v_mov_b32 v49, s49
 v_mov_b32 v50, s49
 v_mov_b32 v51, s49
 s_waitcnt vmcnt(6)
 ds_read_b128 a[0:3], v28 offset:0
 ds_read_b128 a[4:7], v29 offset:0
 ds_read_b128 a[8:11], v30 offset:0
 ds_read_b128 a[12:15], v31 offset:0
 ds_read_b128 a[16:19], v28 offset:256
 ds_read_b128 a[20:23], v29 offset:256
 ds_read_b128 a[24:27], v30 offset:256
 ds_read_b128 a[28:31], v31 offset:256
 ds_read_b128 a[64:67], v28 offset:8192
 ds_read_b128 a[68:71], v29 offset:8192
 ds_read_b128 a[72:75], v30 offset:8192
 ds_read_b128 a[76:79], v31 offset:8192
 ds_read_b128 a[80:83], v28 offset:8448
 ds_read_b128 a[84:87], v29 offset:8448
 ds_read_b128 a[88:91], v30 offset:8448
 ds_read_b128 a[92:95], v31 offset:8448
 s_add_u32 m0, s54, 94208
 s_nop 0
 buffer_load_dwordx4 v6, s[12:15], s46 offen offset:0 lds
 s_add_u32 m0, s54, 95104
 s_nop 0
 buffer_load_dwordx4 v6, s[12:15], s46 offen offset:128 lds
 s_add_u32 m0, s54, 96000
 s_nop 0
 buffer_load_dwordx4 v6, s[12:15], s46 offen offset:256 lds
 s_add_u32 m0, s54, 97280
 s_nop 0
 buffer_load_dwordx4 v7, s[12:15], s46 offen offset:0 lds
 s_add_u32 m0, s54, 98176
 s_nop 0
 buffer_load_dwordx4 v7, s[12:15], s46 offen offset:128 lds
 s_add_u32 m0, s54, 99072
 s_nop 0
 buffer_load_dwordx4 v7, s[12:15], s46 offen offset:256 lds
 s_add_u32 s46, s46, 196608
 s_waitcnt vmcnt(6) lgkmcnt(0)
 s_barrier
tr 208,52,0
tr 210,52,512
tr 212,53,0
tr 214,53,512
tr 216,54,0
tr 218,54,512
tr 220,55,0
tr 222,55,512
tr 224,52,1024
tr 226,52,1536
tr 228,53,1024
tr 230,53,1536
tr 232,54,1024
tr 234,54,1536
wl 10
 v_mfma_f32_16x16x32_bf16 v[64:67], a[0:3], v[208:211], 0
 s_add_u32 m0, s54, 122880
 s_nop 0
 buffer_load_dwordx4 v6, s[12:15], s46 offen offset:0 lds
 v_mfma_f32_16x16x32_bf16 v[68:71], a[64:67], v[208:211], 0
 s_add_u32 m0, s54, 123776
 s_nop 0
 buffer_load_dwordx4 v6, s[12:15], s46 offen offset:128 lds
 v_mfma_f32_16x16x32_bf16 v[176:179], v[208:211], v[48:51], 0
tr 236,55,1024
tr 238,55,1536
 v_mfma_f32_16x16x32_bf16 v[72:75], a[0:3], v[212:215], 0
 s_add_u32 m0, s54, 124672
 s_nop 0
 buffer_load_dwordx4 v6, s[12:15], s46 offen offset:256 lds
 v_mfma_f32_16x16x32_bf16 v[76:79], a[64:67], v[212:215], 0
 s_add_u32 m0, s54, 125952
 s_nop 0
 buffer_load_dwordx4 v7, s[12:15], s46 offen offset:0 lds
 v_mfma_f32_16x16x32_bf16 v[32:35], v[48:51], a[0:3], 0
tr 208,52,2048
tr 210,52,2560
wl 10
 v_mfma_f32_16x16x32_bf16 v[80:83], a[0:3], v[216:219], 0
 s_add_u32 m0, s54, 126848
 s_nop 0
 buffer_load_dwordx4 v7, s[12:15], s46 offen offset:128 lds
 v_mfma_f32_16x16x32_bf16 v[84:87], a[64:67], v[216:219], 0
 s_add_u32 m0, s54, 127744
 s_nop 0
 buffer_load_dwordx4 v7, s[12:15], s46 offen offset:256 lds
 s_add_u32 s46, s46, 196608
tr 212,53,2048
tr 214,53,2560
 v_mfma_f32_16x16x32_bf16 v[88:91], a[0:3], v[220:223], 0
 v_xor_b32 v14, 0, v5
 s_add_u32 m0, s47, 0
 s_nop 0
 buffer_load_dwordx4 v14, s[8:11], s50 offen lds
 s_add_u32 s50, s50, 2048
 v_mfma_f32_16x16x32_bf16 v[92:95], a[64:67], v[220:223], 0
 v_xor_b32 v15, 32, v5
 s_add_u32 m0, s47, 1024
 s_nop 0
 buffer_load_dwordx4 v15, s[8:11], s50 offen lds
 s_add_u32 s50, s50, 2048
tr 216,54,2048
tr 218,54,2560
wl 10
 v_mfma_f32_16x16x32_bf16 v[96:99], a[0:3], v[224:227], 0
 v_xor_b32 v14, 64, v5
 s_add_u32 m0, s47, 2048
 s_nop 0
 buffer_load_dwordx4 v14, s[8:11], s50 offen lds
 s_add_u32 s50, s50, 2048
 v_mfma_f32_16x16x32_bf16 v[100:103], a[64:67], v[224:227], 0
 v_mfma_f32_16x16x32_bf16 v[36:39], v[48:51], a[64:67], 0
 v_mfma_f32_16x16x32_bf16 v[180:183], v[224:227], v[48:51], 0
tr 220,55,2048
tr 222,55,2560
 v_mfma_f32_16x16x32_bf16 v[104:107], a[0:3], v[228:231], 0
 v_xor_b32 v15, 96, v5
 s_add_u32 m0, s47, 3072
 s_nop 0
 buffer_load_dwordx4 v15, s[8:11], s50 offen lds
 s_add_u32 s50, s50, 2048
 v_mfma_f32_16x16x32_bf16 v[108:111], a[64:67], v[228:231], 0
tr 224,52,12288
tr 226,52,12800
wl 10
 v_mfma_f32_16x16x32_bf16 v[112:115], a[0:3], v[232:235], 0
 v_xor_b32 v14, 128, v5
 s_add_u32 m0, s47, 4096
 s_nop 0
 buffer_load_dwordx4 v14, s[8:11], s50 offen lds
 s_add_u32 s50, s50, 2048
 v_mfma_f32_16x16x32_bf16 v[116:119], a[64:67], v[232:235], 0
tr 228,53,12288
tr 230,53,12800
 v_mfma_f32_16x16x32_bf16 v[120:123], a[0:3], v[236:239], 0
 v_xor_b32 v15, 160, v5
 s_add_u32 m0, s47, 5120
 s_nop 0
 buffer_load_dwordx4 v15, s[8:11], s50 offen lds
 s_add_u32 s50, s50, 2048
 v_mfma_f32_16x16x32_bf16 v[124:127], a[64:67], v[236:239], 0
 v_mfma_f32_16x16x32_bf16 v[40:43], a[0:3], a[0:3], 0
tr 232,54,12288
tr 234,54,12800
wl 10
 v_mfma_f32_16x16x32_bf16 v[128:131], a[0:3], v[208:211], 0
 v_xor_b32 v14, 192, v5
 s_add_u32 m0, s47, 6144
 s_nop 0
 buffer_load_dwordx4 v14, s[8:11], s50 offen lds
 s_add_u32 s50, s50, 2048
 v_mfma_f32_16x16x32_bf16 v[132:135], a[64:67], v[208:211], 0
 v_mfma_f32_16x16x32_bf16 v[184:187], v[208:211], v[48:51], 0
tr 236,55,12288
tr 238,55,12800
 v_mfma_f32_16x16x32_bf16 v[136:139], a[0:3], v[212:215], 0
 v_xor_b32 v15, 224, v5
 s_add_u32 m0, s47, 7168
 s_nop 0
 buffer_load_dwordx4 v15, s[8:11], s50 offen lds
 s_add_u32 s50, s50, 2048
 v_mfma_f32_16x16x32_bf16 v[140:143], a[64:67], v[212:215], 0
tr 208,52,13312
tr 210,52,13824
wl 10
 v_mfma_f32_16x16x32_bf16 v[144:147], a[0:3], v[216:219], 0
 v_xor_b32 v14, 0, v5
 s_add_u32 m0, s47, 8192
 s_nop 0
 buffer_load_dwordx4 v14, s[8:11], s50 offen lds
 s_add_u32 s50, s50, 2048
 v_mfma_f32_16x16x32_bf16 v[148:151], a[64:67], v[216:219], 0
 v_mfma_f32_16x16x32_bf16 v[44:47], a[64:67], a[64:67], 0
tr 212,53,13312
tr 214,53,13824
 v_mfma_f32_16x16x32_bf16 v[152:155], a[0:3], v[220:223], 0
 v_xor_b32 v15, 32, v5
 s_add_u32 m0, s47, 9216
 s_nop 0
 buffer_load_dwordx4 v15, s[8:11], s50 offen lds
 s_add_u32 s50, s50, 2048
 v_mfma_f32_16x16x32_bf16 v[156:159], a[64:67], v[220:223], 0
tr 216,54,13312
tr 218,54,13824
wl 10
mg 64,a,4,v,224,64
 v_xor_b32 v14, 64, v5
 s_add_u32 m0, s47, 10240
 s_nop 0
 buffer_load_dwordx4 v14, s[8:11], s50 offen lds
 s_add_u32 s50, s50, 2048
mg 68,a,68,v,224,68
mg 176,v,224,v,48,176
tr 220,55,13312
tr 222,55,13824
mg 72,a,4,v,228,72
 v_xor_b32 v15, 96, v5
 s_add_u32 m0, s47, 11264
 s_nop 0
 buffer_load_dwordx4 v15, s[8:11], s50 offen lds
 s_add_u32 s50, s50, 2048
mg 76,a,68,v,228,76
mg 32,v,48,a,4,32
tr 224,52,14336
tr 226,52,14848
wl 10
mg 80,a,4,v,232,80
 v_xor_b32 v14, 128, v5
 s_add_u32 m0, s47, 12288
 s_nop 0
 buffer_load_dwordx4 v14, s[8:11], s50 offen lds
 s_add_u32 s50, s50, 2048
mg 84,a,68,v,232,84
tr 228,53,14336
tr 230,53,14848
mg 88,a,4,v,236,88
 v_xor_b32 v15, 160, v5
 s_add_u32 m0, s47, 13312
 s_nop 0
 buffer_load_dwordx4 v15, s[8:11], s50 offen lds
 s_add_u32 s50, s50, 2048
mg 92,a,68,v,236,92
tr 232,54,14336
tr 234,54,14848
wl 10
mg 96,a,4,v,208,96
 v_xor_b32 v14, 192, v5
 s_add_u32 m0, s47, 14336
 s_nop 0
 buffer_load_dwordx4 v14, s[8:11], s50 offen lds
 s_add_u32 s50, s50, 2048
mg 100,a,68,v,208,100
mg 36,v,48,a,68,36
mg 180,v,208,v,48,180
tr 236,55,14336
tr 238,55,14848
mg 104,a,4,v,212,104
 v_xor_b32 v15, 224, v5
 s_add_u32 m0, s47, 15360
 s_nop 0
 buffer_load_dwordx4 v15, s[8:11], s50 offen lds
 s_add_u32 s50, s50, 2048
 s_sub_u32 s50, s50, 32256
mg 108,a,68,v,212,108
 s_waitcnt vmcnt(22) lgkmcnt(0)
 s_barrier
 s_add_u32 m0, s54, 65536
 s_nop 0
 buffer_load_dwordx4 v6, s[12:15], s46 offen offset:0 lds
 s_add_u32 m0, s54, 66432
 s_nop 0
 buffer_load_dwordx4 v6, s[12:15], s46 offen offset:128 lds
 s_add_u32 m0, s54, 67328
 s_nop 0
 buffer_load_dwordx4 v6, s[12:15], s46 offen offset:256 lds
 s_add_u32 m0, s54, 68608
 s_nop 0
 buffer_load_dwordx4 v7, s[12:15], s46 offen offset:0 lds
 s_add_u32 m0, s54, 69504
 s_nop 0
 buffer_load_dwordx4 v7, s[12:15], s46 offen offset:128 lds
 s_add_u32 m0, s54, 70400
 s_nop 0
 buffer_load_dwordx4 v7, s[12:15], s46 offen offset:256 lds
 s_add_u32 s46, s46, 196608
tr 208,52,28672
tr 210,52,29184
wl 10
mg 112,a,4,v,216,112
mg 116,a,68,v,216,116
tr 212,53,28672
tr 214,53,29184
mg 120,a,4,v,220,120
mg 124,a,68,v,220,124
mg 40,a,4,a,4,40
tr 216,54,28672
tr 218,54,29184
wl 10
mg 128,a,4,v,224,128
mg 132,a,68,v,224,132
mg 184,v,224,v,48,184
tr 220,55,28672
tr 222,55,29184
mg 136,a,4,v,228,136
mg 140,a,68,v,228,140
tr 224,52,29696
tr 226,52,30208
wl 10
mg 144,a,4,v,232,144
mg 148,a,68,v,232,148
mg 44,a,68,a,68,44
tr 228,53,29696
tr 230,53,30208
mg 152,a,4,v,236,152
mg 156,a,68,v,236,156
tr 232,54,29696
tr 234,54,30208
wl 10
mg 64,a,8,v,208,64
mg 68,a,72,v,208,68
mg 176,v,208,v,48,176
tr 236,55,29696
tr 238,55,30208
mg 72,a,8,v,212,72
mg 76,a,72,v,212,76
mg 32,v,48,a,8,32
tr 208,52,30720
tr 210,52,31232
wl 10
mg 80,a,8,v,216,80
mg 84,a,72,v,216,84
tr 212,53,30720
tr 214,53,31232
mg 88,a,8,v,220,88
mg 92,a,72,v,220,92
tr 216,54,30720
tr 218,54,31232
wl 10
mg 96,a,8,v,224,96
mg 100,a,72,v,224,100
mg 36,v,48,a,72,36
mg 180,v,224,v,48,180
tr 220,55,30720
tr 222,55,31232
mg 104,a,8,v,228,104
mg 108,a,72,v,228,108
tr 224,52,40960
tr 226,52,41472
wl 10
mg 112,a,8,v,232,112
mg 116,a,72,v,232,116
tr 228,53,40960
tr 230,53,41472
mg 120,a,8,v,236,120
mg 124,a,72,v,236,124
mg 40,a,8,a,8,40
tr 232,54,40960
tr 234,54,41472
wl 10
mg 128,a,8,v,208,128
mg 132,a,72,v,208,132
mg 184,v,208,v,48,184
tr 236,55,40960
tr 238,55,41472
mg 136,a,8,v,212,136
mg 140,a,72,v,212,140
tr 208,52,41984
tr 210,52,42496
wl 10
mg 144,a,8,v,216,144
mg 148,a,72,v,216,148
mg 44,a,72,a,72,44
tr 212,53,41984
tr 214,53,42496
mg 152,a,8,v,220,152
mg 156,a,72,v,220,156
tr 216,54,41984
tr 218,54,42496
wl 10
mg 64,a,12,v,224,64
mg 68,a,76,v,224,68
mg 176,v,224,v,48,176
tr 220,55,41984
tr 222,55,42496
mg 72,a,12,v,228,72
mg 76,a,76,v,228,76
mg 32,v,48,a,12,32
tr 224,52,43008
tr 226,52,43520
wl 10
mg 80,a,12,v,232,80
mg 84,a,76,v,232,84
tr 228,53,43008
tr 230,53,43520
mg 88,a,12,v,236,88
mg 92,a,76,v,236,92
tr 232,54,43008
tr 234,54,43520
wl 10
mg 96,a,12,v,208,96
mg 100,a,76,v,208,100
mg 36,v,48,a,76,36
mg 180,v,208,v,48,180
tr 236,55,43008
tr 238,55,43520
mg 104,a,12,v,212,104
mg 108,a,76,v,212,108
 s_waitcnt vmcnt(22) lgkmcnt(0)
 s_barrier
 s_add_u32 m0, s54, 94208
 s_nop 0
 buffer_load_dwordx4 v6, s[12:15], s46 offen offset:0 lds
 s_add_u32 m0, s54, 95104
 s_nop 0
 buffer_load_dwordx4 v6, s[12:15], s46 offen offset:128 lds
 s_add_u32 m0, s54, 96000
 s_nop 0
 buffer_load_dwordx4 v6, s[12:15], s46 offen offset:256 lds
 s_add_u32 m0, s54, 97280
 s_nop 0
 buffer_load_dwordx4 v7, s[12:15], s46 offen offset:0 lds
 s_add_u32 m0, s54, 98176
 s_nop 0
 buffer_load_dwordx4 v7, s[12:15], s46 offen offset:128 lds
 s_add_u32 m0, s54, 99072
 s_nop 0
 buffer_load_dwordx4 v7, s[12:15], s46 offen offset:256 lds
 s_add_u32 s46, s46, 196608
tr 208,56,0
tr 210,56,512
wl 10
mg 112,a,12,v,216,112
mg 116,a,76,v,216,116
tr 212,57,0
tr 214,57,512
mg 120,a,12,v,220,120
mg 124,a,76,v,220,124
mg 40,a,12,a,12,40
tr 216,58,0
tr 218,58,512
wl 10
mg 128,a,12,v,224,128
mg 132,a,76,v,224,132
mg 184,v,224,v,48,184
tr 220,59,0
tr 222,59,512
mg 136,a,12,v,228,136
mg 140,a,76,v,228,140
tr 224,56,1024
tr 226,56,1536
wl 10
mg 144,a,12,v,232,144
mg 148,a,76,v,232,148
mg 44,a,76,a,76,44
tr 228,57,1024
tr 230,57,1536
mg 152,a,12,v,236,152
mg 156,a,76,v,236,156
tr 232,58,1024
tr 234,58,1536
wl 10
mg 64,a,16,v,208,64
mg 68,a,80,v,208,68
mg 176,v,208,v,48,176
tr 236,59,1024
tr 238,59,1536
mg 72,a,16,v,212,72
mg 76,a,80,v,212,76
mg 32,v,48,a,16,32
tr 208,56,2048
tr 210,56,2560
wl 10
mg 80,a,16,v,216,80
mg 84,a,80,v,216,84
tr 212,57,2048
tr 214,57,2560
mg 88,a,16,v,220,88
mg 92,a,80,v,220,92
tr 216,58,2048
tr 218,58,2560
wl 10
mg 96,a,16,v,224,96
mg 100,a,80,v,224,100
mg 36,v,48,a,80,36
mg 180,v,224,v,48,180
tr 220,59,2048
tr 222,59,2560
mg 104,a,16,v,228,104
mg 108,a,80,v,228,108
tr 224,56,12288
tr 226,56,12800
wl 10
mg 112,a,16,v,232,112
mg 116,a,80,v,232,116
tr 228,57,12288
tr 230,57,12800
mg 120,a,16,v,236,120
mg 124,a,80,v,236,124
mg 40,a,16,a,16,40
tr 232,58,12288
tr 234,58,12800
wl 10
mg 128,a,16,v,208,128
mg 132,a,80,v,208,132
mg 184,v,208,v,48,184
tr 236,59,12288
tr 238,59,12800
mg 136,a,16,v,212,136
mg 140,a,80,v,212,140
tr 208,56,13312
tr 210,56,13824
wl 10
mg 144,a,16,v,216,144
mg 148,a,80,v,216,148
mg 44,a,80,a,80,44
tr 212,57,13312
tr 214,57,13824
mg 152,a,16,v,220,152
mg 156,a,80,v,220,156
tr 216,58,13312
tr 218,58,13824
wl 10
mg 64,a,20,v,224,64
mg 68,a,84,v,224,68
mg 176,v,224,v,48,176
tr 220,59,13312
tr 222,59,13824
mg 72,a,20,v,228,72
mg 76,a,84,v,228,76
mg 32,v,48,a,20,32
tr 224,56,14336
tr 226,56,14848
wl 10
mg 80,a,20,v,232,80
mg 84,a,84,v,232,84
tr 228,57,14336
tr 230,57,14848
mg 88,a,20,v,236,88
mg 92,a,84,v,236,92
tr 232,58,14336
tr 234,58,14848
wl 10
mg 96,a,20,v,208,96
mg 100,a,84,v,208,100
mg 36,v,48,a,84,36
mg 180,v,208,v,48,180
tr 236,59,14336
tr 238,59,14848
mg 104,a,20,v,212,104
mg 108,a,84,v,212,108
 s_waitcnt vmcnt(6) lgkmcnt(0)
 s_barrier
 s_add_u32 m0, s54, 122880
 s_nop 0
 buffer_load_dwordx4 v6, s[12:15], s46 offen offset:0 lds
 s_add_u32 m0, s54, 123776
 s_nop 0
 buffer_load_dwordx4 v6, s[12:15], s46 offen offset:128 lds
 s_add_u32 m0, s54, 124672
 s_nop 0
 buffer_load_dwordx4 v6, s[12:15], s46 offen offset:256 lds
 s_add_u32 m0, s54, 125952
 s_nop 0
 buffer_load_dwordx4 v7, s[12:15], s46 offen offset:0 lds
 s_add_u32 m0, s54, 126848
 s_nop 0
 buffer_load_dwordx4 v7, s[12:15], s46 offen offset:128 lds
 s_add_u32 m0, s54, 127744
 s_nop 0
 buffer_load_dwordx4 v7, s[12:15], s46 offen offset:256 lds
 s_add_u32 s46, s46, 196608
 ds_read_b128 a[32:35], v28 offset:0
 ds_read_b128 a[36:39], v29 offset:0
 ds_read_b128 a[40:43], v30 offset:0
 ds_read_b128 a[44:47], v31 offset:0
 ds_read_b128 a[48:51], v28 offset:256
 ds_read_b128 a[52:55], v29 offset:256
 ds_read_b128 a[56:59], v30 offset:256
 ds_read_b128 a[60:63], v31 offset:256
 ds_read_b128 a[96:99], v28 offset:8192
 ds_read_b128 a[100:103], v29 offset:8192
 ds_read_b128 a[104:107], v30 offset:8192
 ds_read_b128 a[108:111], v31 offset:8192
 ds_read_b128 a[112:115], v28 offset:8448
 ds_read_b128 a[116:119], v29 offset:8448
 ds_read_b128 a[120:123], v30 offset:8448
 ds_read_b128 a[124:127], v31 offset:8448
tr 208,52,0
tr 210,52,512
wl 10
mg 112,a,20,v,216,112
mg 116,a,84,v,216,116
tr 212,53,0
tr 214,53,512
mg 120,a,20,v,220,120
mg 124,a,84,v,220,124
mg 40,a,20,a,20,40
tr 216,54,0
tr 218,54,512
wl 10
mg 128,a,20,v,224,128
mg 132,a,84,v,224,132
mg 184,v,224,v,48,184
tr 220,55,0
tr 222,55,512
mg 136,a,20,v,228,136
mg 140,a,84,v,228,140
tr 224,52,1024
tr 226,52,1536
wl 10
mg 144,a,20,v,232,144
mg 148,a,84,v,232,148
mg 44,a,84,a,84,44
tr 228,53,1024
tr 230,53,1536
mg 152,a,20,v,236,152
mg 156,a,84,v,236,156
tr 232,54,1024
tr 234,54,1536
wl 10
mg 64,a,24,v,208,64
mg 68,a,88,v,208,68
mg 176,v,208,v,48,176
tr 236,55,1024
tr 238,55,1536
mg 72,a,24,v,212,72
mg 76,a,88,v,212,76
mg 32,v,48,a,24,32
tr 208,52,2048
tr 210,52,2560
wl 10
mg 80,a,24,v,216,80
mg 84,a,88,v,216,84
tr 212,53,2048
tr 214,53,2560
mg 88,a,24,v,220,88
mg 92,a,88,v,220,92
tr 216,54,2048
tr 218,54,2560
wl 10
mg 96,a,24,v,224,96
mg 100,a,88,v,224,100
mg 36,v,48,a,88,36
mg 180,v,224,v,48,180
tr 220,55,2048
tr 222,55,2560
mg 104,a,24,v,228,104
mg 108,a,88,v,228,108
tr 224,52,12288
tr 226,52,12800
wl 10
mg 112,a,24,v,232,112
mg 116,a,88,v,232,116
tr 228,53,12288
tr 230,53,12800
mg 120,a,24,v,236,120
mg 124,a,88,v,236,124
mg 40,a,24,a,24,40
tr 232,54,12288
tr 234,54,12800
wl 10
mg 128,a,24,v,208,128
mg 132,a,88,v,208,132
mg 184,v,208,v,48,184
tr 236,55,12288
tr 238,55,12800
mg 136,a,24,v,212,136
mg 140,a,88,v,212,140
tr 208,52,13312
tr 210,52,13824
wl 10
mg 144,a,24,v,216,144
mg 148,a,88,v,216,148
mg 44,a,88,a,88,44
tr 212,53,13312
tr 214,53,13824
mg 152,a,24,v,220,152
mg 156,a,88,v,220,156
tr 216,54,13312
tr 218,54,13824
wl 10
mg 64,a,28,v,224,64
mg 68,a,92,v,224,68
mg 176,v,224,v,48,176
tr 220,55,13312
tr 222,55,13824
mg 72,a,28,v,228,72
mg 76,a,92,v,228,76
mg 32,v,48,a,28,32
tr 224,52,14336
tr 226,52,14848
wl 10
mg 80,a,28,v,232,80
mg 84,a,92,v,232,84
tr 228,53,14336
tr 230,53,14848
mg 88,a,28,v,236,88
mg 92,a,92,v,236,92
tr 232,54,14336
tr 234,54,14848
wl 10
mg 96,a,28,v,208,96
mg 100,a,92,v,208,100
mg 36,v,48,a,92,36
mg 180,v,208,v,48,180
tr 236,55,14336
tr 238,55,14848
mg 104,a,28,v,212,104
mg 108,a,92,v,212,108
 s_waitcnt vmcnt(6) lgkmcnt(0)
 s_barrier
 s_cmp_ge_u32 s51, 576
 s_cbranch_scc1 K1_VV_nojob0
 v_lshrrev_b32 v22, 3, v1
 v_and_b32 v23, 7, v1
 v_and_b32 v24, 2, v22
 v_xor_b32 v23, v23, v24
 v_lshlrev_b32 v22, 10, v22
 v_lshl_add_u32 v24, v23, 4, v22
 v_xor_b32 v23, 4, v23
 v_lshl_add_u32 v25, v23, 4, v22
 s_add_u32 m0, s47, 0
 s_nop 0
 buffer_load_dwordx4 v24, s[20:23], s57 offen lds
 s_add_u32 s57, s57, 8192
 s_add_u32 m0, s47, 1024
 s_nop 0
 buffer_load_dwordx4 v25, s[20:23], s57 offen lds
 s_add_u32 s57, s57, 8192
 s_add_u32 m0, s47, 2048
 s_nop 0
 buffer_load_dwordx4 v24, s[20:23], s57 offen lds
 s_add_u32 s57, s57, 8192
 s_add_u32 m0, s47, 3072
 s_nop 0
 buffer_load_dwordx4 v25, s[20:23], s57 offen lds
 s_add_u32 s57, s57, 8192
K1_VV_nojob0:
 s_add_u32 m0, s54, 65536
 s_nop 0
 buffer_load_dwordx4 v6, s[12:15], s46 offen offset:0 lds
 s_add_u32 m0, s54, 66432
 s_nop 0
 buffer_load_dwordx4 v6, s[12:15], s46 offen offset:128 lds
 s_add_u32 m0, s54, 67328
 s_nop 0
 buffer_load_dwordx4 v6, s[12:15], s46 offen offset:256 lds
 s_add_u32 m0, s54, 68608
 s_nop 0
 buffer_load_dwordx4 v7, s[12:15], s46 offen offset:0 lds
 s_add_u32 m0, s54, 69504
 s_nop 0
 buffer_load_dwordx4 v7, s[12:15], s46 offen offset:128 lds
 s_add_u32 m0, s54, 70400
 s_nop 0
 buffer_load_dwordx4 v7, s[12:15], s46 offen offset:256 lds
 s_add_u32 s46, s46, 196608
tr 208,52,28672
tr 210,52,29184
wl 10
mg 112,a,28,v,216,112
mg 116,a,92,v,216,116
tr 212,53,28672
tr 214,53,29184
mg 120,a,28,v,220,120
mg 124,a,92,v,220,124
mg 40,a,28,a,28,40
tr 216,54,28672
tr 218,54,29184
wl 10
mg 128,a,28,v,224,128
mg 132,a,92,v,224,132
mg 184,v,224,v,48,184
tr 220,55,28672
tr 222,55,29184
mg 136,a,28,v,228,136
mg 140,a,92,v,228,140
tr 224,52,29696
tr 226,52,30208
wl 10
mg 144,a,28,v,232,144
mg 148,a,92,v,232,148
mg 44,a,92,a,92,44
tr 228,53,29696
tr 230,53,30208
mg 152,a,28,v,236,152
mg 156,a,92,v,236,156
tr 232,54,29696
tr 234,54,30208
wl 10
mg 64,a,32,v,208,64
mg 68,a,96,v,208,68
mg 176,v,208,v,48,176
tr 236,55,29696
tr 238,55,30208
mg 72,a,32,v,212,72
mg 76,a,96,v,212,76
mg 32,v,48,a,32,32
tr 208,52,30720
tr 210,52,31232
wl 10
mg 80,a,32,v,216,80
mg 84,a,96,v,216,84
tr 212,53,30720
tr 214,53,31232
mg 88,a,32,v,220,88
mg 92,a,96,v,220,92
tr 216,54,30720
tr 218,54,31232
wl 10
mg 96,a,32,v,224,96
mg 100,a,96,v,224,100
mg 36,v,48,a,96,36
mg 180,v,224,v,48,180
tr 220,55,30720
tr 222,55,31232
mg 104,a,32,v,228,104
mg 108,a,96,v,228,108
tr 224,52,40960
tr 226,52,41472
wl 10
mg 112,a,32,v,232,112
mg 116,a,96,v,232,116
tr 228,53,40960
tr 230,53,41472
mg 120,a,32,v,236,120
mg 124,a,96,v,236,124
mg 40,a,32,a,32,40
tr 232,54,40960
tr 234,54,41472
wl 10
mg 128,a,32,v,208,128
mg 132,a,96,v,208,132
mg 184,v,208,v,48,184
tr 236,55,40960
tr 238,55,41472
mg 136,a,32,v,212,136
mg 140,a,96,v,212,140
tr 208,52,41984
tr 210,52,42496
wl 10
mg 144,a,32,v,216,144
mg 148,a,96,v,216,148
mg 44,a,96,a,96,44
tr 212,53,41984
tr 214,53,42496
mg 152,a,32,v,220,152
mg 156,a,96,v,220,156
tr 216,54,41984
tr 218,54,42496
wl 10
mg 64,a,36,v,224,64
mg 68,a,100,v,224,68
mg 176,v,224,v,48,176
tr 220,55,41984
tr 222,55,42496
mg 72,a,36,v,228,72
mg 76,a,100,v,228,76
mg 32,v,48,a,36,32
tr 224,52,43008
tr 226,52,43520
wl 10
mg 80,a,36,v,232,80
mg 84,a,100,v,232,84
tr 228,53,43008
tr 230,53,43520
mg 88,a,36,v,236,88
mg 92,a,100,v,236,92
tr 232,54,43008
tr 234,54,43520
wl 10
mg 96,a,36,v,208,96
mg 100,a,100,v,208,100
mg 36,v,48,a,100,36
mg 180,v,208,v,48,180
tr 236,55,43008
tr 238,55,43520
mg 104,a,36,v,212,104
mg 108,a,100,v,212,108
 s_waitcnt vmcnt(6) lgkmcnt(0)
 s_barrier
 s_add_u32 m0, s54, 94208
 s_nop 0
 buffer_load_dwordx4 v6, s[12:15], s46 offen offset:0 lds
 s_add_u32 m0, s54, 95104
 s_nop 0
 buffer_load_dwordx4 v6, s[12:15], s46 offen offset:128 lds
 s_add_u32 m0, s54, 96000
 s_nop 0
 buffer_load_dwordx4 v6, s[12:15], s46 offen offset:256 lds
 s_add_u32 m0, s54, 97280
 s_nop 0
 buffer_load_dwordx4 v7, s[12:15], s46 offen offset:0 lds
 s_add_u32 m0, s54, 98176
 s_nop 0
 buffer_load_dwordx4 v7, s[12:15], s46 offen offset:128 lds
 s_add_u32 m0, s54, 99072
 s_nop 0
 buffer_load_dwordx4 v7, s[12:15], s46 offen offset:256 lds
 s_add_u32 s46, s46, 196608
 s_cmp_ge_u32 s51, 576
 s_cbranch_scc1 K1_VV_nojob
 s_sub_u32 s48, s47, 65536
 v_lshlrev_b32 v14, 11, v2
 v_sub_u32 v14, s48, v14
 v_add_u32 v16, v14, v52
 v_add_u32 v17, v14, v53
 v_add_u32 v18, v14, v54
 v_add_u32 v19, v14, v55
tr 192,16,0
tr 194,16,512
tr 196,17,0
tr 198,17,512
tr 200,18,0
tr 202,18,512
tr 204,19,0
tr 206,19,512
 s_and_b32 s48, s51, 7
 s_mul_i32 s48, s48, 288
 s_lshr_b32 s52, s51, 3
 s_add_u32 s48, s48, s52
 s_lshl_b32 s48, s48, 10
 s_add_u32 s48, s48, 20971520
wl 0
 s_mul_i32 s52, s24, 73728
 s_add_u32 s52, s52, s48
 buffer_store_dwordx4 v[192:195], v4, s[16:19], s52 offen sc1
 s_mul_i32 s52, s25, 73728
 s_add_u32 s52, s52, s48
 buffer_store_dwordx4 v[196:199], v4, s[16:19], s52 offen sc1
 s_mul_i32 s52, s26, 73728
 s_add_u32 s52, s52, s48
 buffer_store_dwordx4 v[200:203], v4, s[16:19], s52 offen sc1
 s_mul_i32 s52, s27, 73728
 s_add_u32 s52, s52, s48
 buffer_store_dwordx4 v[204:207], v4, s[16:19], s52 offen sc1
K1_VV_nojob:
tr 208,56,0
tr 210,56,512
wl 10
mg 112,a,36,v,216,112
mg 116,a,100,v,216,116
tr 212,57,0
tr 214,57,512
mg 120,a,36,v,220,120
mg 124,a,100,v,220,124
mg 40,a,36,a,36,40
tr 216,58,0
tr 218,58,512
wl 10
mg 128,a,36,v,224,128
mg 132,a,100,v,224,132
mg 184,v,224,v,48,184
tr 220,59,0
tr 222,59,512
mg 136,a,36,v,228,136
mg 140,a,100,v,228,140
tr 224,56,1024
tr 226,56,1536
wl 10
mg 144,a,36,v,232,144
mg 148,a,100,v,232,148
mg 44,a,100,a,100,44
tr 228,57,1024
tr 230,57,1536
mg 152,a,36,v,236,152
mg 156,a,100,v,236,156
tr 232,58,1024
tr 234,58,1536
wl 10
mg 64,a,40,v,208,64
mg 68,a,104,v,208,68
mg 176,v,208,v,48,176
tr 236,59,1024
tr 238,59,1536
mg 72,a,40,v,212,72
mg 76,a,104,v,212,76
mg 32,v,48,a,40,32
tr 208,56,2048
tr 210,56,2560
wl 10
mg 80,a,40,v,216,80
mg 84,a,104,v,216,84
tr 212,57,2048
tr 214,57,2560
mg 88,a,40,v,220,88
mg 92,a,104,v,220,92
tr 216,58,2048
tr 218,58,2560
wl 10
mg 96,a,40,v,224,96
mg 100,a,104,v,224,100
mg 36,v,48,a,104,36
mg 180,v,224,v,48,180
tr 220,59,2048
tr 222,59,2560
mg 104,a,40,v,228,104
mg 108,a,104,v,228,108
tr 224,56,12288
tr 226,56,12800
wl 10
mg 112,a,40,v,232,112
mg 116,a,104,v,232,116
tr 228,57,12288
tr 230,57,12800
mg 120,a,40,v,236,120
mg 124,a,104,v,236,124
mg 40,a,40,a,40,40
tr 232,58,12288
tr 234,58,12800
wl 10
mg 128,a,40,v,208,128
mg 132,a,104,v,208,132
mg 184,v,208,v,48,184
tr 236,59,12288
tr 238,59,12800
mg 136,a,40,v,212,136
mg 140,a,104,v,212,140
tr 208,56,13312
tr 210,56,13824
wl 10
mg 144,a,40,v,216,144
mg 148,a,104,v,216,148
mg 44,a,104,a,104,44
tr 212,57,13312
tr 214,57,13824
mg 152,a,40,v,220,152
mg 156,a,104,v,220,156
tr 216,58,13312
tr 218,58,13824
wl 10
mg 64,a,44,v,224,64
mg 68,a,108,v,224,68
mg 176,v,224,v,48,176
tr 220,59,13312
tr 222,59,13824
mg 72,a,44,v,228,72
mg 76,a,108,v,228,76
mg 32,v,48,a,44,32
tr 224,56,14336
tr 226,56,14848
wl 10
mg 80,a,44,v,232,80
mg 84,a,108,v,232,84
tr 228,57,14336
tr 230,57,14848
mg 88,a,44,v,236,88
mg 92,a,108,v,236,92
tr 232,58,14336
tr 234,58,14848
wl 10
mg 96,a,44,v,208,96
mg 100,a,108,v,208,100
mg 36,v,48,a,108,36
mg 180,v,208,v,48,180
tr 236,59,14336
tr 238,59,14848
mg 104,a,44,v,212,104
mg 108,a,108,v,212,108
 s_waitcnt vmcnt(6) lgkmcnt(0)
 s_barrier
tr 208,52,0
tr 210,52,512
wl 10
mg 112,a,44,v,216,112
mg 116,a,108,v,216,116
tr 212,53,0
tr 214,53,512
mg 120,a,44,v,220,120
mg 124,a,108,v,220,124
mg 40,a,44,a,44,40
tr 216,54,0
tr 218,54,512
wl 10
mg 128,a,44,v,224,128
mg 132,a,108,v,224,132
mg 184,v,224,v,48,184
tr 220,55,0
tr 222,55,512
mg 136,a,44,v,228,136
mg 140,a,108,v,228,140
tr 224,52,1024
tr 226,52,1536
wl 10
mg 144,a,44,v,232,144
mg 148,a,108,v,232,148
mg 44,a,108,a,108,44
tr 228,53,1024
tr 230,53,1536
mg 152,a,44,v,236,152
mg 156,a,108,v,236,156
tr 232,54,1024
tr 234,54,1536
wl 10
mg 64,a,48,v,208,64
mg 68,a,112,v,208,68
mg 176,v,208,v,48,176
tr 236,55,1024
tr 238,55,1536
mg 72,a,48,v,212,72
mg 76,a,112,v,212,76
mg 32,v,48,a,48,32
tr 208,52,2048
tr 210,52,2560
wl 10
mg 80,a,48,v,216,80
mg 84,a,112,v,216,84
tr 212,53,2048
tr 214,53,2560
mg 88,a,48,v,220,88
mg 92,a,112,v,220,92
tr 216,54,2048
tr 218,54,2560
wl 10
mg 96,a,48,v,224,96
mg 100,a,112,v,224,100
mg 36,v,48,a,112,36
mg 180,v,224,v,48,180
tr 220,55,2048
tr 222,55,2560
mg 104,a,48,v,228,104
mg 108,a,112,v,228,108
tr 224,52,12288
tr 226,52,12800
wl 10
mg 112,a,48,v,232,112
mg 116,a,112,v,232,116
tr 228,53,12288
tr 230,53,12800
mg 120,a,48,v,236,120
mg 124,a,112,v,236,124
mg 40,a,48,a,48,40
tr 232,54,12288
tr 234,54,12800
wl 10
mg 128,a,48,v,208,128
mg 132,a,112,v,208,132
mg 184,v,208,v,48,184
tr 236,55,12288
tr 238,55,12800
mg 136,a,48,v,212,136
mg 140,a,112,v,212,140
tr 208,52,13312
tr 210,52,13824
wl 10
mg 144,a,48,v,216,144
mg 148,a,112,v,216,148
mg 44,a,112,a,112,44
tr 212,53,13312
tr 214,53,13824
mg 152,a,48,v,220,152
mg 156,a,112,v,220,156
tr 216,54,13312
tr 218,54,13824
wl 10
mg 64,a,52,v,224,64
mg 68,a,116,v,224,68
mg 176,v,224,v,48,176
tr 220,55,13312
tr 222,55,13824
mg 72,a,52,v,228,72
mg 76,a,116,v,228,76
mg 32,v,48,a,52,32
tr 224,52,14336
tr 226,52,14848
wl 10
mg 80,a,52,v,232,80
mg 84,a,116,v,232,84
tr 228,53,14336
tr 230,53,14848
mg 88,a,52,v,236,88
mg 92,a,116,v,236,92
tr 232,54,14336
tr 234,54,14848
wl 10
mg 96,a,52,v,208,96
mg 100,a,116,v,208,100
mg 36,v,48,a,116,36
mg 180,v,208,v,48,180
tr 236,55,14336
tr 238,55,14848
mg 104,a,52,v,212,104
mg 108,a,116,v,212,108
 s_waitcnt vmcnt(0) lgkmcnt(0)
 s_barrier
tr 208,52,28672
tr 210,52,29184
wl 10
mg 112,a,52,v,216,112
mg 116,a,116,v,216,116
tr 212,52,29696
tr 214,52,30208
mg 120,a,52,v,220,120
mg 124,a,116,v,220,124
mg 40,a,52,a,52,40
tr 216,52,30720
tr 218,52,31232
wl 10
mg 128,a,52,v,224,128
mg 132,a,116,v,224,132
mg 184,v,224,v,48,184
tr 220,52,40960
tr 222,52,41472
mg 136,a,52,v,228,136
mg 140,a,116,v,228,140
tr 224,52,41984
tr 226,52,42496
wl 10
mg 144,a,52,v,232,144
mg 148,a,116,v,232,148
mg 44,a,116,a,116,44
tr 228,52,43008
tr 230,52,43520
mg 152,a,52,v,236,152
mg 156,a,116,v,236,156
tr 232,53,28672
tr 234,53,29184
wl 10
mg 64,a,56,v,208,64
mg 68,a,120,v,208,68
mg 32,v,48,a,56,32
mg 44,a,120,a,120,44
mg 176,v,208,v,48,176
tr 236,53,40960
tr 238,53,41472
mg 96,a,56,v,212,96
mg 100,a,120,v,212,100
mg 36,v,48,a,120,36
mg 180,v,212,v,48,180
tr 208,54,28672
tr 210,54,29184
wl 10
mg 128,a,56,v,216,128
mg 132,a,120,v,216,132
mg 40,a,56,a,56,40
mg 184,v,216,v,48,184
tr 212,54,40960
tr 214,54,41472
mg 64,a,60,v,220,64
mg 68,a,124,v,220,68
mg 32,v,48,a,60,32
mg 44,a,124,a,124,44
mg 176,v,220,v,48,176
tr 216,55,28672
tr 218,55,29184
wl 10
mg 96,a,60,v,224,96
mg 100,a,124,v,224,100
mg 36,v,48,a,124,36
mg 180,v,224,v,48,180
tr 220,55,40960
tr 222,55,41472
mg 128,a,60,v,228,128
mg 132,a,124,v,228,132
mg 40,a,60,a,60,40
mg 184,v,228,v,48,184
tr 224,53,29696
tr 226,53,30208
wl 10
mg 72,a,56,v,232,72
mg 76,a,120,v,232,76
 s_lshl_b32 s48, s3, 6
 s_add_u32 s48, s48, 151552
 v_lshlrev_b32 v14, 4, v2
 v_add_u32 v15, s48, v14
 s_and_b32 s48, s3, 1
 s_lshl_b32 s48, s48, 6
 s_add_u32 s48, s48, 151552
 v_add_u32 v14, s48, v14
 s_nop 7
 ds_write_b128 v15, v[176:179] offset:0
 ds_write_b128 v15, v[180:183] offset:256
 ds_write_b128 v15, v[184:187] offset:512
 v_and_b32 v22, 3, v3
 v_cmp_eq_u32 vcc, 1, v22
 v_cndmask_b32 v40, v40, v41, vcc
 v_cndmask_b32 v44, v44, v45, vcc
 v_cmp_eq_u32 vcc, 2, v22
 v_cndmask_b32 v40, v40, v42, vcc
 v_cndmask_b32 v44, v44, v46, vcc
 v_cmp_eq_u32 vcc, 3, v22
 v_cndmask_b32 v40, v40, v43, vcc
 v_cndmask_b32 v44, v44, v47, vcc
 v_lshrrev_b32 v22, 2, v3
 v_lshl_add_u32 v22, v22, 4, v3
 v_lshlrev_b32 v22, 2, v22
 ds_bpermute_b32 v34, v22, v40
 ds_bpermute_b32 v38, v22, v44
tr 228,53,41984
tr 230,53,42496
mg 72,a,60,v,236,72
mg 76,a,124,v,236,76
tr 232,54,29696
tr 234,54,30208
wl 15
mg 80,a,56,v,208,80
mg 84,a,120,v,208,84
wl 4
 s_barrier
 s_mov_b32 s48, 989855744
 s_mov_b32 s52, 925353388
 v_mul_f32 v32, s48, v32
 v_mul_f32 v34, s48, v34
 v_fma_f32 v34, -v32, v32, v34
 v_max_f32 v34, 0, v34
 v_add_f32 v34, s52, v34
 v_rsq_f32 v10, v34
 v_sub_f32 v11, 0, v32
 v_mul_f32 v36, s48, v36
 v_mul_f32 v38, s48, v38
 v_fma_f32 v38, -v36, v36, v38
 v_max_f32 v38, 0, v38
 v_add_f32 v38, s52, v38
 v_rsq_f32 v12, v38
 v_sub_f32 v13, 0, v36
 v_lshlrev_b32 v26, 4, v2
 v_add_u32 v26, 151552, v26
 v_lshlrev_b32 v27, 2, v3
 v_add_u32 v27, 151552, v27
 v_lshlrev_b32 v22, 4, v2
 v_add_u32 v23, 0, v22
 ds_bpermute_b32 v240, v23, v10
 ds_bpermute_b32 v244, v23, v11
 ds_bpermute_b32 v248, v23, v12
 ds_bpermute_b32 v252, v23, v13
 v_add_u32 v23, 4, v22
 ds_bpermute_b32 v241, v23, v10
 ds_bpermute_b32 v245, v23, v11
 ds_bpermute_b32 v249, v23, v12
 ds_bpermute_b32 v253, v23, v13
 v_add_u32 v23, 8, v22
 ds_bpermute_b32 v242, v23, v10
 ds_bpermute_b32 v246, v23, v11
 ds_bpermute_b32 v250, v23, v12
 ds_bpermute_b32 v254, v23, v13
 v_add_u32 v23, 12, v22
 ds_bpermute_b32 v243, v23, v10
 ds_bpermute_b32 v247, v23, v11
 ds_bpermute_b32 v251, v23, v12
 ds_bpermute_b32 v255, v23, v13
 s_lshl_b32 s52, s24, 6
 v_add_u32 v196, s52, v27
 ds_read_b32 v192, v196 offset:0
 s_lshl_b32 s52, s24, 6
 v_add_u32 v204, s52, v27
 ds_read_b32 v200, v204 offset:256
 v_and_b32 v16, 1, v2
 v_lshl_add_u32 v16, v16, 4, v3
 v_add_u32 v14, s45, v16
 v_lshlrev_b32 v14, 5, v14
 v_lshrrev_b32 v17, 1, v2
 v_lshl_add_u32 v14, v17, 4, v14
 s_lshl_b32 s48, s45, 5
 v_add_u32 v15, s48, v4
 s_lshl_b32 s48, s44, 12
tr 236,54,41984
tr 238,54,42496
mg 80,a,60,v,212,80
mg 84,a,124,v,212,84
 s_lshl_b32 s54, s24, 16
 s_add_u32 s54, s54, s48
wl 3
 v_pk_fma_f32 v[64:65], v[192:193], v[244:245], v[64:65] op_sel:[0,0,0] op_sel_hi:[0,1,1]
 v_pk_fma_f32 v[66:67], v[192:193], v[246:247], v[66:67] op_sel:[0,0,0] op_sel_hi:[0,1,1]
 v_pk_mul_f32 v[64:65], v[64:65], v[240:241]
 v_pk_mul_f32 v[66:67], v[66:67], v[242:243]
pk 64,64,65
pk 65,66,67
 v_pk_fma_f32 v[68:69], v[192:193], v[252:253], v[68:69] op_sel:[0,0,0] op_sel_hi:[0,1,1]
 v_pk_fma_f32 v[70:71], v[192:193], v[254:255], v[70:71] op_sel:[0,0,0] op_sel_hi:[0,1,1]
 v_pk_mul_f32 v[68:69], v[68:69], v[248:249]
 v_pk_mul_f32 v[70:71], v[70:71], v[250:251]
pk 66,68,69
pk 67,70,71
 s_lshl_b32 s52, s24, 6
 v_add_u32 v196, s52, v27
 ds_read_b32 v192, v196 offset:512
 v_permlane32_swap_b32 v64, v66
 v_permlane32_swap_b32 v65, v67
 buffer_store_dwordx4 v[64:67], v15, s[16:19], s54 offen sc1
tr 208,55,29696
tr 210,55,30208
wl 15
mg 88,a,56,v,216,88
mg 92,a,120,v,216,92
 s_lshl_b32 s54, s24, 16
 s_add_u32 s54, s54, s48
 s_add_u32 s54, s54, 262144
wl 5
 v_pk_fma_f32 v[96:97], v[200:201], v[244:245], v[96:97] op_sel:[0,0,0] op_sel_hi:[0,1,1]
 v_pk_fma_f32 v[98:99], v[200:201], v[246:247], v[98:99] op_sel:[0,0,0] op_sel_hi:[0,1,1]
 v_pk_mul_f32 v[96:97], v[96:97], v[240:241]
 v_pk_mul_f32 v[98:99], v[98:99], v[242:243]
pk 96,96,97
pk 97,98,99
 v_pk_fma_f32 v[100:101], v[200:201], v[252:253], v[100:101] op_sel:[0,0,0] op_sel_hi:[0,1,1]
 v_pk_fma_f32 v[102:103], v[200:201], v[254:255], v[102:103] op_sel:[0,0,0] op_sel_hi:[0,1,1]
 v_pk_mul_f32 v[100:101], v[100:101], v[248:249]
 v_pk_mul_f32 v[102:103], v[102:103], v[250:251]
pk 98,100,101
pk 99,102,103
 s_lshl_b32 s52, s25, 6
 v_add_u32 v204, s52, v27
 ds_read_b32 v200, v204 offset:0
 v_permlane32_swap_b32 v96, v98
 v_permlane32_swap_b32 v97, v99
 buffer_store_dwordx4 v[96:99], v15, s[16:19], s54 offen sc1
tr 212,55,41984
tr 214,55,42496
mg 88,a,60,v,220,88
mg 92,a,124,v,220,92
 s_lshl_b32 s54, s24, 16
 s_add_u32 s54, s54, s48
 s_add_u32 s54, s54, 524288
wl 5
 v_pk_fma_f32 v[128:129], v[192:193], v[244:245], v[128:129] op_sel:[0,0,0] op_sel_hi:[0,1,1]
 v_pk_fma_f32 v[130:131], v[192:193], v[246:247], v[130:131] op_sel:[0,0,0] op_sel_hi:[0,1,1]
 v_pk_mul_f32 v[128:129], v[128:129], v[240:241]
 v_pk_mul_f32 v[130:131], v[130:131], v[242:243]
pk 128,128,129
pk 129,130,131
 v_pk_fma_f32 v[132:133], v[192:193], v[252:253], v[132:133] op_sel:[0,0,0] op_sel_hi:[0,1,1]
 v_pk_fma_f32 v[134:135], v[192:193], v[254:255], v[134:135] op_sel:[0,0,0] op_sel_hi:[0,1,1]
 v_pk_mul_f32 v[132:133], v[132:133], v[248:249]
 v_pk_mul_f32 v[134:135], v[134:135], v[250:251]
pk 130,132,133
pk 131,134,135
 s_lshl_b32 s52, s26, 6
 v_add_u32 v196, s52, v27
 ds_read_b32 v192, v196 offset:0
 v_permlane32_swap_b32 v128, v130
 v_permlane32_swap_b32 v129, v131
 buffer_store_dwordx4 v[128:131], v15, s[16:19], s54 offen sc1
tr 216,53,30720
tr 218,53,31232
wl 15
mg 104,a,56,v,224,104
mg 108,a,120,v,224,108
 s_lshl_b32 s54, s25, 16
 s_add_u32 s54, s54, s48
wl 5
 v_pk_fma_f32 v[72:73], v[200:201], v[244:245], v[72:73] op_sel:[0,0,0] op_sel_hi:[0,1,1]
 v_pk_fma_f32 v[74:75], v[200:201], v[246:247], v[74:75] op_sel:[0,0,0] op_sel_hi:[0,1,1]
 v_pk_mul_f32 v[72:73], v[72:73], v[240:241]
 v_pk_mul_f32 v[74:75], v[74:75], v[242:243]
pk 72,72,73
pk 73,74,75
 v_pk_fma_f32 v[76:77], v[200:201], v[252:253], v[76:77] op_sel:[0,0,0] op_sel_hi:[0,1,1]
 v_pk_fma_f32 v[78:79], v[200:201], v[254:255], v[78:79] op_sel:[0,0,0] op_sel_hi:[0,1,1]
 v_pk_mul_f32 v[76:77], v[76:77], v[248:249]
 v_pk_mul_f32 v[78:79], v[78:79], v[250:251]
pk 74,76,77
pk 75,78,79
 s_lshl_b32 s52, s27, 6
 v_add_u32 v204, s52, v27
 ds_read_b32 v200, v204 offset:0
 v_permlane32_swap_b32 v72, v74
 v_permlane32_swap_b32 v73, v75
 buffer_store_dwordx4 v[72:75], v15, s[16:19], s54 offen sc1
tr 220,53,43008
tr 222,53,43520
mg 104,a,60,v,228,104
mg 108,a,124,v,228,108
 s_lshl_b32 s54, s26, 16
 s_add_u32 s54, s54, s48
wl 5
 v_pk_fma_f32 v[80:81], v[192:193], v[244:245], v[80:81] op_sel:[0,0,0] op_sel_hi:[0,1,1]
 v_pk_fma_f32 v[82:83], v[192:193], v[246:247], v[82:83] op_sel:[0,0,0] op_sel_hi:[0,1,1]
 v_pk_mul_f32 v[80:81], v[80:81], v[240:241]
 v_pk_mul_f32 v[82:83], v[82:83], v[242:243]
pk 80,80,81
pk 81,82,83
 v_pk_fma_f32 v[84:85], v[192:193], v[252:253], v[84:85] op_sel:[0,0,0] op_sel_hi:[0,1,1]
 v_pk_fma_f32 v[86:87], v[192:193], v[254:255], v[86:87] op_sel:[0,0,0] op_sel_hi:[0,1,1]
 v_pk_mul_f32 v[84:85], v[84:85], v[248:249]
 v_pk_mul_f32 v[86:87], v[86:87], v[250:251]
pk 82,84,85
pk 83,86,87
 s_lshl_b32 s52, s25, 6
 v_add_u32 v196, s52, v27
 ds_read_b32 v192, v196 offset:256
 v_permlane32_swap_b32 v80, v82
 v_permlane32_swap_b32 v81, v83
 buffer_store_dwordx4 v[80:83], v15, s[16:19], s54 offen sc1
tr 224,54,30720
tr 226,54,31232
wl 15
mg 112,a,56,v,232,112
mg 116,a,120,v,232,116
 s_lshl_b32 s54, s27, 16
 s_add_u32 s54, s54, s48
wl 5
 v_pk_fma_f32 v[88:89], v[200:201], v[244:245], v[88:89] op_sel:[0,0,0] op_sel_hi:[0,1,1]
 v_pk_fma_f32 v[90:91], v[200:201], v[246:247], v[90:91] op_sel:[0,0,0] op_sel_hi:[0,1,1]
 v_pk_mul_f32 v[88:89], v[88:89], v[240:241]
 v_pk_mul_f32 v[90:91], v[90:91], v[242:243]
pk 88,88,89
pk 89,90,91
 v_pk_fma_f32 v[92:93], v[200:201], v[252:253], v[92:93] op_sel:[0,0,0] op_sel_hi:[0,1,1]
 v_pk_fma_f32 v[94:95], v[200:201], v[254:255], v[94:95] op_sel:[0,0,0] op_sel_hi:[0,1,1]
 v_pk_mul_f32 v[92:93], v[92:93], v[248:249]
 v_pk_mul_f32 v[94:95], v[94:95], v[250:251]
pk 90,92,93
pk 91,94,95
 s_lshl_b32 s52, s26, 6
 v_add_u32 v204, s52, v27
 ds_read_b32 v200, v204 offset:256
 v_permlane32_swap_b32 v88, v90
 v_permlane32_swap_b32 v89, v91
 buffer_store_dwordx4 v[88:91], v15, s[16:19], s54 offen sc1
tr 228,54,43008
tr 230,54,43520
mg 112,a,60,v,236,112
mg 116,a,124,v,236,116
 s_lshl_b32 s54, s25, 16
 s_add_u32 s54, s54, s48
 s_add_u32 s54, s54, 262144
wl 5
 v_pk_fma_f32 v[104:105], v[192:193], v[244:245], v[104:105] op_sel:[0,0,0] op_sel_hi:[0,1,1]
 v_pk_fma_f32 v[106:107], v[192:193], v[246:247], v[106:107] op_sel:[0,0,0] op_sel_hi:[0,1,1]
 v_pk_mul_f32 v[104:105], v[104:105], v[240:241]
 v_pk_mul_f32 v[106:107], v[106:107], v[242:243]
pk 104,104,105
pk 105,106,107
 v_pk_fma_f32 v[108:109], v[192:193], v[252:253], v[108:109] op_sel:[0,0,0] op_sel_hi:[0,1,1]
 v_pk_fma_f32 v[110:111], v[192:193], v[254:255], v[110:111] op_sel:[0,0,0] op_sel_hi:[0,1,1]
 v_pk_mul_f32 v[108:109], v[108:109], v[248:249]
 v_pk_mul_f32 v[110:111], v[110:111], v[250:251]
pk 106,108,109
pk 107,110,111
 s_lshl_b32 s52, s27, 6
 v_add_u32 v196, s52, v27
 ds_read_b32 v192, v196 offset:256
 v_permlane32_swap_b32 v104, v106
 v_permlane32_swap_b32 v105, v107
 buffer_store_dwordx4 v[104:107], v15, s[16:19], s54 offen sc1
tr 232,55,30720
tr 234,55,31232
wl 15
mg 120,a,56,v,208,120
mg 124,a,120,v,208,124
tr 236,55,43008
tr 238,55,43520
mg 120,a,60,v,212,120
mg 124,a,124,v,212,124
 s_lshl_b32 s54, s26, 16
 s_add_u32 s54, s54, s48
 s_add_u32 s54, s54, 262144
wl 7
 v_pk_fma_f32 v[112:113], v[200:201], v[244:245], v[112:113] op_sel:[0,0,0] op_sel_hi:[0,1,1]
 v_pk_fma_f32 v[114:115], v[200:201], v[246:247], v[114:115] op_sel:[0,0,0] op_sel_hi:[0,1,1]
 v_pk_mul_f32 v[112:113], v[112:113], v[240:241]
 v_pk_mul_f32 v[114:115], v[114:115], v[242:243]
pk 112,112,113
pk 113,114,115
 v_pk_fma_f32 v[116:117], v[200:201], v[252:253], v[116:117] op_sel:[0,0,0] op_sel_hi:[0,1,1]
 v_pk_fma_f32 v[118:119], v[200:201], v[254:255], v[118:119] op_sel:[0,0,0] op_sel_hi:[0,1,1]
 v_pk_mul_f32 v[116:117], v[116:117], v[248:249]
 v_pk_mul_f32 v[118:119], v[118:119], v[250:251]
pk 114,116,117
pk 115,118,119
 s_lshl_b32 s52, s25, 6
 v_add_u32 v204, s52, v27
 ds_read_b32 v200, v204 offset:512
 v_permlane32_swap_b32 v112, v114
 v_permlane32_swap_b32 v113, v115
 buffer_store_dwordx4 v[112:115], v15, s[16:19], s54 offen sc1
wl 12
mg 136,a,56,v,216,136
mg 140,a,120,v,216,140
mg 136,a,60,v,220,136
mg 140,a,124,v,220,140
 s_lshl_b32 s54, s27, 16
 s_add_u32 s54, s54, s48
 s_add_u32 s54, s54, 262144
wl 5
 v_pk_fma_f32 v[120:121], v[192:193], v[244:245], v[120:121] op_sel:[0,0,0] op_sel_hi:[0,1,1]
 v_pk_fma_f32 v[122:123], v[192:193], v[246:247], v[122:123] op_sel:[0,0,0] op_sel_hi:[0,1,1]
 v_pk_mul_f32 v[120:121], v[120:121], v[240:241]
 v_pk_mul_f32 v[122:123], v[122:123], v[242:243]
pk 120,120,121
pk 121,122,123
 v_pk_fma_f32 v[124:125], v[192:193], v[252:253], v[124:125] op_sel:[0,0,0] op_sel_hi:[0,1,1]
 v_pk_fma_f32 v[126:127], v[192:193], v[254:255], v[126:127] op_sel:[0,0,0] op_sel_hi:[0,1,1]
 v_pk_mul_f32 v[124:125], v[124:125], v[248:249]
 v_pk_mul_f32 v[126:127], v[126:127], v[250:251]
pk 122,124,125
pk 123,126,127
 s_lshl_b32 s52, s26, 6
 v_add_u32 v196, s52, v27
 ds_read_b32 v192, v196 offset:512
 v_permlane32_swap_b32 v120, v122
 v_permlane32_swap_b32 v121, v123
 buffer_store_dwordx4 v[120:123], v15, s[16:19], s54 offen sc1
wl 7
mg 144,a,56,v,224,144
mg 148,a,120,v,224,148
mg 144,a,60,v,228,144
mg 148,a,124,v,228,148
 s_lshl_b32 s54, s25, 16
 s_add_u32 s54, s54, s48
 s_add_u32 s54, s54, 524288
wl 1
 v_pk_fma_f32 v[136:137], v[200:201], v[244:245], v[136:137] op_sel:[0,0,0] op_sel_hi:[0,1,1]
 v_pk_fma_f32 v[138:139], v[200:201], v[246:247], v[138:139] op_sel:[0,0,0] op_sel_hi:[0,1,1]
 v_pk_mul_f32 v[136:137], v[136:137], v[240:241]
 v_pk_mul_f32 v[138:139], v[138:139], v[242:243]
pk 136,136,137
pk 137,138,139
 v_pk_fma_f32 v[140:141], v[200:201], v[252:253], v[140:141] op_sel:[0,0,0] op_sel_hi:[0,1,1]
 v_pk_fma_f32 v[142:143], v[200:201], v[254:255], v[142:143] op_sel:[0,0,0] op_sel_hi:[0,1,1]
 v_pk_mul_f32 v[140:141], v[140:141], v[248:249]
 v_pk_mul_f32 v[142:143], v[142:143], v[250:251]
pk 138,140,141
pk 139,142,143
 s_lshl_b32 s52, s27, 6
 v_add_u32 v204, s52, v27
 ds_read_b32 v200, v204 offset:512
 v_permlane32_swap_b32 v136, v138
 v_permlane32_swap_b32 v137, v139
 buffer_store_dwordx4 v[136:139], v15, s[16:19], s54 offen sc1
wl 3
mg 152,a,56,v,232,152
mg 156,a,120,v,232,156
mg 152,a,60,v,236,152
mg 156,a,124,v,236,156
 s_lshl_b32 s54, s26, 16
 s_add_u32 s54, s54, s48
 s_add_u32 s54, s54, 524288
wl 1
 v_pk_fma_f32 v[144:145], v[192:193], v[244:245], v[144:145] op_sel:[0,0,0] op_sel_hi:[0,1,1]
 v_pk_fma_f32 v[146:147], v[192:193], v[246:247], v[146:147] op_sel:[0,0,0] op_sel_hi:[0,1,1]
 v_pk_mul_f32 v[144:145], v[144:145], v[240:241]
 v_pk_mul_f32 v[146:147], v[146:147], v[242:243]
pk 144,144,145
pk 145,146,147
 v_pk_fma_f32 v[148:149], v[192:193], v[252:253], v[148:149] op_sel:[0,0,0] op_sel_hi:[0,1,1]
 v_pk_fma_f32 v[150:151], v[192:193], v[254:255], v[150:151] op_sel:[0,0,0] op_sel_hi:[0,1,1]
 v_pk_mul_f32 v[148:149], v[148:149], v[248:249]
 v_pk_mul_f32 v[150:151], v[150:151], v[250:251]
pk 146,148,149
pk 147,150,151
 s_nop 1
 v_permlane32_swap_b32 v144, v146
 v_permlane32_swap_b32 v145, v147
 buffer_store_dwordx4 v[144:147], v15, s[16:19], s54 offen sc1
 s_nop 7
 s_lshl_b32 s54, s27, 16
 s_add_u32 s54, s54, s48
 s_add_u32 s54, s54, 524288
wl 0
 v_pk_fma_f32 v[152:153], v[200:201], v[244:245], v[152:153] op_sel:[0,0,0] op_sel_hi:[0,1,1]
 v_pk_fma_f32 v[154:155], v[200:201], v[246:247], v[154:155] op_sel:[0,0,0] op_sel_hi:[0,1,1]
 v_pk_mul_f32 v[152:153], v[152:153], v[240:241]
 v_pk_mul_f32 v[154:155], v[154:155], v[242:243]
pk 152,152,153
pk 153,154,155
 v_pk_fma_f32 v[156:157], v[200:201], v[252:253], v[156:157] op_sel:[0,0,0] op_sel_hi:[0,1,1]
 v_pk_fma_f32 v[158:159], v[200:201], v[254:255], v[158:159] op_sel:[0,0,0] op_sel_hi:[0,1,1]
 v_pk_mul_f32 v[156:157], v[156:157], v[248:249]
 v_pk_mul_f32 v[158:159], v[158:159], v[250:251]
pk 154,156,157
pk 155,158,159
 s_nop 1
 v_permlane32_swap_b32 v152, v154
 v_permlane32_swap_b32 v153, v155
 buffer_store_dwordx4 v[152:155], v15, s[16:19], s54 offen sc1
 s_endpgm
K1_HH:
 s_lshl_b32 s47, s3, 14
 s_lshl_b32 s50, s45, 10
 v_lshrrev_b32 v14, 5, v1
 v_and_b32 v15, 31, v1
 v_xor_b32 v15, v15, v14
 v_lshlrev_b32 v15, 4, v15
 v_lshl_add_u32 v5, v14, 10, v15
 v_xor_b32 v14, 0, v5
 s_add_u32 m0, s47, 0
 s_nop 0
 buffer_load_dwordx4 v14, s[8:11], s50 offen lds
 s_add_u32 s50, s50, 2048
 v_xor_b32 v15, 32, v5
 s_add_u32 m0, s47, 1024
 s_nop 0
 buffer_load_dwordx4 v15, s[8:11], s50 offen lds
 s_add_u32 s50, s50, 2048
 v_xor_b32 v14, 64, v5
 s_add_u32 m0, s47, 2048
 s_nop 0
 buffer_load_dwordx4 v14, s[8:11], s50 offen lds
 s_add_u32 s50, s50, 2048
 v_xor_b32 v15, 96, v5
 s_add_u32 m0, s47, 3072
 s_nop 0
 buffer_load_dwordx4 v15, s[8:11], s50 offen lds
 s_add_u32 s50, s50, 2048
 v_xor_b32 v14, 128, v5
 s_add_u32 m0, s47, 4096
 s_nop 0
 buffer_load_dwordx4 v14, s[8:11], s50 offen lds
 s_add_u32 s50, s50, 2048
 v_xor_b32 v15, 160, v5
 s_add_u32 m0, s47, 5120
 s_nop 0
 buffer_load_dwordx4 v15, s[8:11], s50 offen lds
 s_add_u32 s50, s50, 2048
 v_xor_b32 v14, 192, v5
 s_add_u32 m0, s47, 6144
 s_nop 0
 buffer_load_dwordx4 v14, s[8:11], s50 offen lds
 s_add_u32 s50, s50, 2048
 v_xor_b32 v15, 224, v5
 s_add_u32 m0, s47, 7168
 s_nop 0
 buffer_load_dwordx4 v15, s[8:11], s50 offen lds
 s_add_u32 s50, s50, 2048
 v_xor_b32 v14, 0, v5
 s_add_u32 m0, s47, 8192
 s_nop 0
 buffer_load_dwordx4 v14, s[8:11], s50 offen lds
 s_add_u32 s50, s50, 2048
 v_xor_b32 v15, 32, v5
 s_add_u32 m0, s47, 9216
 s_nop 0
 buffer_load_dwordx4 v15, s[8:11], s50 offen lds
 s_add_u32 s50, s50, 2048
 v_xor_b32 v14, 64, v5
 s_add_u32 m0, s47, 10240
 s_nop 0
 buffer_load_dwordx4 v14, s[8:11], s50 offen lds
 s_add_u32 s50, s50, 2048
 v_xor_b32 v15, 96, v5
 s_add_u32 m0, s47, 11264
 s_nop 0
 buffer_load_dwordx4 v15, s[8:11], s50 offen lds
 s_add_u32 s50, s50, 2048
 v_xor_b32 v14, 128, v5
 s_add_u32 m0, s47, 12288
 s_nop 0
 buffer_load_dwordx4 v14, s[8:11], s50 offen lds
 s_add_u32 s50, s50, 2048
 v_xor_b32 v15, 160, v5
 s_add_u32 m0, s47, 13312
 s_nop 0
 buffer_load_dwordx4 v15, s[8:11], s50 offen lds
 s_add_u32 s50, s50, 2048
 v_xor_b32 v14, 192, v5
 s_add_u32 m0, s47, 14336
 s_nop 0
 buffer_load_dwordx4 v14, s[8:11], s50 offen lds
 s_add_u32 s50, s50, 2048
 v_xor_b32 v15, 224, v5
 s_add_u32 m0, s47, 15360
 s_nop 0
 buffer_load_dwordx4 v15, s[8:11], s50 offen lds
 s_add_u32 s50, s50, 2048
 s_sub_u32 s50, s50, 32256
 s_mov_b32 s48, 3584
 v_lshrrev_b32 v14, 3, v1
 v_mul_lo_u32 v15, v14, s48
 v_and_b32 v16, 7, v1
 v_and_b32 v17, 2, v14
 v_xor_b32 v16, v16, v17
 v_lshl_add_u32 v6, v16, 4, v15
 v_xor_b32 v16, 4, v16
 v_lshl_add_u32 v7, v16, 4, v15
 v_add_u32 v7, 28672, v7
 v_lshrrev_b32 v14, 2, v1
 v_mul_lo_u32 v15, v14, s48
 v_and_b32 v16, 3, v1
 v_lshrrev_b32 v17, 5, v1
 v_lshlrev_b32 v17, 1, v17
 v_xor_b32 v16, v16, v17
 v_lshl_add_u32 v8, v16, 4, v15
 s_mul_i32 s46, s3, 57344
 s_lshl_b32 s48, s55, 1
 s_add_u32 s53, s46, s48
 s_lshl_b32 s48, s44, 1
 s_add_u32 s46, s46, s48
 s_mul_i32 s54, s3, 6144
 s_lshl_b32 s56, s3, 10
 s_add_u32 m0, s54, 65536
 s_nop 0
 buffer_load_dwordx4 v6, s[12:15], s46 offen offset:0 lds
 s_add_u32 m0, s54, 66432
 s_nop 0
 buffer_load_dwordx4 v6, s[12:15], s46 offen offset:128 lds
 s_add_u32 m0, s54, 67328
 s_nop 0
 buffer_load_dwordx4 v6, s[12:15], s46 offen offset:256 lds
 s_add_u32 m0, s54, 68608
 s_nop 0
 buffer_load_dwordx4 v7, s[12:15], s46 offen offset:0 lds
 s_add_u32 m0, s54, 69504
 s_nop 0
 buffer_load_dwordx4 v7, s[12:15], s46 offen offset:128 lds
 s_add_u32 m0, s54, 70400
 s_nop 0
 buffer_load_dwordx4 v7, s[12:15], s46 offen offset:256 lds
 s_add_u32 s46, s46, 229376
 s_add_u32 m0, s56, 90112
 s_nop 0
 buffer_load_dwordx4 v8, s[12:15], s53 offen lds
 s_add_u32 s53, s53, 229376
 v_lshlrev_b32 v14, 9, v3
 v_add_u32 v14, s47, v14
 v_or_b32 v15, 0, v2
 v_xor_b32 v15, v15, v3
 v_lshl_add_u32 v28, v15, 4, v14
 v_or_b32 v15, 4, v2
 v_xor_b32 v15, v15, v3
 v_lshl_add_u32 v29, v15, 4, v14
 v_or_b32 v15, 8, v2
 v_xor_b32 v15, v15, v3
 v_lshl_add_u32 v30, v15, 4, v14
 v_or_b32 v15, 12, v2
 v_xor_b32 v15, v15, v3
 v_lshl_add_u32 v31, v15, 4, v14
 v_bfe_u32 v14, v1, 2, 2
 v_and_b32 v15, 1, v1
 v_lshlrev_b32 v15, 3, v15
 v_bfe_u32 v16, v1, 1, 1
 v_lshl_add_u32 v15, v16, 4, v15
 v_lshrrev_b32 v16, 1, v14
 v_and_b32 v17, 1, v2
 v_lshl_add_u32 v16, v17, 1, v16
 s_movk_i32 s48, 3072
 v_mul_lo_u32 v18, v2, s48
 v_lshl_add_u32 v18, v14, 7, v18
 v_add_u32 v18, v18, v15
 s_xor_b32 s24, s3, 0
 s_xor_b32 s25, s3, 1
 s_xor_b32 s26, s3, 2
 s_xor_b32 s27, s3, 3
 v_xor_b32 v19, s24, v16
 v_lshl_add_u32 v19, v19, 5, v18
 v_add_u32 v52, 65536, v19
 v_add_u32 v56, 122880, v19
 v_xor_b32 v19, s25, v16
 v_lshl_add_u32 v19, v19, 5, v18
 v_add_u32 v53, 65536, v19
 v_add_u32 v57, 122880, v19
 v_xor_b32 v19, s26, v16
 v_lshl_add_u32 v19, v19, 5, v18
 v_add_u32 v54, 65536, v19
 v_add_u32 v58, 122880, v19
 v_xor_b32 v19, s27, v16
 v_lshl_add_u32 v19, v19, 5, v18
 v_add_u32 v55, 65536, v19
 v_add_u32 v59, 122880, v19
 v_lshrrev_b32 v18, 1, v2
 v_lshlrev_b32 v18, 10, v18
 v_lshl_add_u32 v18, v17, 9, v18
 v_lshl_add_u32 v18, v14, 6, v18
 v_add_u32 v18, v18, v15
 s_and_b32 s48, s24, 1
 v_xor_b32 v19, s48, v17
 v_lshl_add_u32 v19, v19, 5, v18
 v_add_u32 v60, 65536, v19
 v_add_u32 v62, 122880, v19
 s_and_b32 s48, s25, 1
 v_xor_b32 v19, s48, v17
 v_lshl_add_u32 v19, v19, 5, v18
 v_add_u32 v61, 65536, v19
 v_add_u32 v63, 122880, v19
 v_mov_b32 v48, s49
 v_mov_b32 v49, s49
 v_mov_b32 v50, s49
 v_mov_b32 v51, s49
 s_waitcnt vmcnt(7)
 ds_read_b128 a[0:3], v28 offset:0
 ds_read_b128 a[4:7], v29 offset:0
 ds_read_b128 a[8:11], v30 offset:0
 ds_read_b128 a[12:15], v31 offset:0
 ds_read_b128 a[16:19], v28 offset:256
 ds_read_b128 a[20:23], v29 offset:256
 ds_read_b128 a[24:27], v30 offset:256
 ds_read_b128 a[28:31], v31 offset:256
 ds_read_b128 a[64:67], v28 offset:8192
 ds_read_b128 a[68:71], v29 offset:8192
 ds_read_b128 a[72:75], v30 offset:8192
 ds_read_b128 a[76:79], v31 offset:8192
 ds_read_b128 a[80:83], v28 offset:8448
 ds_read_b128 a[84:87], v29 offset:8448
 ds_read_b128 a[88:91], v30 offset:8448
 ds_read_b128 a[92:95], v31 offset:8448
 s_add_u32 m0, s54, 94208
 s_nop 0
 buffer_load_dwordx4 v6, s[12:15], s46 offen offset:0 lds
 s_add_u32 m0, s54, 95104
 s_nop 0
 buffer_load_dwordx4 v6, s[12:15], s46 offen offset:128 lds
 s_add_u32 m0, s54, 96000
 s_nop 0
 buffer_load_dwordx4 v6, s[12:15], s46 offen offset:256 lds
 s_add_u32 m0, s54, 97280
 s_nop 0
 buffer_load_dwordx4 v7, s[12:15], s46 offen offset:0 lds
 s_add_u32 m0, s54, 98176
 s_nop 0
 buffer_load_dwordx4 v7, s[12:15], s46 offen offset:128 lds
 s_add_u32 m0, s54, 99072
 s_nop 0
 buffer_load_dwordx4 v7, s[12:15], s46 offen offset:256 lds
 s_add_u32 s46, s46, 229376
 s_add_u32 m0, s56, 118784
 s_nop 0
 buffer_load_dwordx4 v8, s[12:15], s53 offen lds
 s_add_u32 s53, s53, 229376
 s_waitcnt vmcnt(7) lgkmcnt(0)
 s_barrier
tr 208,52,0
tr 210,52,512
tr 212,53,0
tr 214,53,512
tr 216,54,0
tr 218,54,512
tr 220,55,0
tr 222,55,512
tr 224,52,1024
tr 226,52,1536
tr 228,53,1024
tr 230,53,1536
tr 232,54,1024
tr 234,54,1536
wl 10
 v_mfma_f32_16x16x32_bf16 v[64:67], v[208:211], a[0:3], 0
 s_add_u32 m0, s54, 122880
 s_nop 0
 buffer_load_dwordx4 v6, s[12:15], s46 offen offset:0 lds
 v_mfma_f32_16x16x32_bf16 v[68:71], v[208:211], a[64:67], 0
 s_add_u32 m0, s54, 123776
 s_nop 0
 buffer_load_dwordx4 v6, s[12:15], s46 offen offset:128 lds
 v_mfma_f32_16x16x32_bf16 v[176:179], v[208:211], v[48:51], 0
tr 236,55,1024
tr 238,55,1536
 v_mfma_f32_16x16x32_bf16 v[72:75], v[212:215], a[0:3], 0
 s_add_u32 m0, s54, 124672
 s_nop 0
 buffer_load_dwordx4 v6, s[12:15], s46 offen offset:256 lds
 v_mfma_f32_16x16x32_bf16 v[76:79], v[212:215], a[64:67], 0
 v_mfma_f32_16x16x32_bf16 v[32:35], v[48:51], a[0:3], 0
tr 208,52,2048
tr 210,52,2560
wl 10
 v_mfma_f32_16x16x32_bf16 v[80:83], v[216:219], a[0:3], 0
 s_add_u32 m0, s54, 125952
 s_nop 0
 buffer_load_dwordx4 v7, s[12:15], s46 offen offset:0 lds
 v_mfma_f32_16x16x32_bf16 v[84:87], v[216:219], a[64:67], 0
tr 212,53,2048
tr 214,53,2560
 v_mfma_f32_16x16x32_bf16 v[88:91], v[220:223], a[0:3], 0
 s_add_u32 m0, s54, 126848
 s_nop 0
 buffer_load_dwordx4 v7, s[12:15], s46 offen offset:128 lds
 v_mfma_f32_16x16x32_bf16 v[92:95], v[220:223], a[64:67], 0
tr 216,54,2048
tr 218,54,2560
wl 10
 v_mfma_f32_16x16x32_bf16 v[96:99], v[224:227], a[0:3], 0
 s_add_u32 m0, s54, 127744
 s_nop 0
 buffer_load_dwordx4 v7, s[12:15], s46 offen offset:256 lds
 s_add_u32 s46, s46, 229376
 v_mfma_f32_16x16x32_bf16 v[100:103], v[224:227], a[64:67], 0
 v_mfma_f32_16x16x32_bf16 v[36:39], v[48:51], a[64:67], 0
 v_mfma_f32_16x16x32_bf16 v[180:183], v[224:227], v[48:51], 0
tr 220,55,2048
tr 222,55,2560
 v_mfma_f32_16x16x32_bf16 v[104:107], v[228:231], a[0:3], 0
 s_add_u32 m0, s56, 147456
 s_nop 0
 buffer_load_dwordx4 v8, s[12:15], s53 offen lds
 s_add_u32 s53, s53, 229376
 v_mfma_f32_16x16x32_bf16 v[108:111], v[228:231], a[64:67], 0
tr 224,60,24576
tr 226,60,24832
wl 10
 v_mfma_f32_16x16x32_bf16 v[112:115], v[232:235], a[0:3], 0
 v_xor_b32 v14, 0, v5
 s_add_u32 m0, s47, 0
 s_nop 0
 buffer_load_dwordx4 v14, s[8:11], s50 offen lds
 s_add_u32 s50, s50, 2048
 v_mfma_f32_16x16x32_bf16 v[116:119], v[232:235], a[64:67], 0
tr 228,61,24576
tr 230,61,24832
 v_mfma_f32_16x16x32_bf16 v[120:123], v[236:239], a[0:3], 0
 v_xor_b32 v15, 32, v5
 s_add_u32 m0, s47, 1024
 s_nop 0
 buffer_load_dwordx4 v15, s[8:11], s50 offen lds
 s_add_u32 s50, s50, 2048
 v_mfma_f32_16x16x32_bf16 v[124:127], v[236:239], a[64:67], 0
 v_mfma_f32_16x16x32_bf16 v[40:43], a[0:3], a[0:3], 0
tr 232,52,12288
tr 234,52,12800
wl 10
 v_mfma_f32_16x16x32_bf16 v[128:131], v[208:211], a[0:3], 0
 v_xor_b32 v14, 64, v5
 s_add_u32 m0, s47, 2048
 s_nop 0
 buffer_load_dwordx4 v14, s[8:11], s50 offen lds
 s_add_u32 s50, s50, 2048
 v_mfma_f32_16x16x32_bf16 v[132:135], v[208:211], a[64:67], 0
 v_mfma_f32_16x16x32_bf16 v[184:187], v[208:211], v[48:51], 0
tr 236,53,12288
tr 238,53,12800
 v_mfma_f32_16x16x32_bf16 v[136:139], v[212:215], a[0:3], 0
 v_xor_b32 v15, 96, v5
 s_add_u32 m0, s47, 3072
 s_nop 0
 buffer_load_dwordx4 v15, s[8:11], s50 offen lds
 s_add_u32 s50, s50, 2048
 v_mfma_f32_16x16x32_bf16 v[140:143], v[212:215], a[64:67], 0
tr 208,54,12288
tr 210,54,12800
wl 10
 v_mfma_f32_16x16x32_bf16 v[144:147], v[216:219], a[0:3], 0
 v_xor_b32 v14, 128, v5
 s_add_u32 m0, s47, 4096
 s_nop 0
 buffer_load_dwordx4 v14, s[8:11], s50 offen lds
 s_add_u32 s50, s50, 2048
 v_mfma_f32_16x16x32_bf16 v[148:151], v[216:219], a[64:67], 0
 v_mfma_f32_16x16x32_bf16 v[44:47], a[64:67], a[64:67], 0
tr 212,55,12288
tr 214,55,12800
 v_mfma_f32_16x16x32_bf16 v[152:155], v[220:223], a[0:3], 0
 v_xor_b32 v15, 160, v5
 s_add_u32 m0, s47, 5120
 s_nop 0
 buffer_load_dwordx4 v15, s[8:11], s50 offen lds
 s_add_u32 s50, s50, 2048
 v_mfma_f32_16x16x32_bf16 v[156:159], v[220:223], a[64:67], 0
tr 216,52,13312
tr 218,52,13824
wl 10
 v_mfma_f32_16x16x32_bf16 v[160:163], v[224:227], a[0:3], 0
 v_xor_b32 v14, 192, v5
 s_add_u32 m0, s47, 6144
 s_nop 0
 buffer_load_dwordx4 v14, s[8:11], s50 offen lds
 s_add_u32 s50, s50, 2048
 v_mfma_f32_16x16x32_bf16 v[164:167], v[224:227], a[64:67], 0
 v_mfma_f32_16x16x32_bf16 v[188:191], v[224:227], v[48:51], 0
tr 220,53,13312
tr 222,53,13824
 v_mfma_f32_16x16x32_bf16 v[168:171], v[228:231], a[0:3], 0
 v_xor_b32 v15, 224, v5
 s_add_u32 m0, s47, 7168
 s_nop 0
 buffer_load_dwordx4 v15, s[8:11], s50 offen lds
 s_add_u32 s50, s50, 2048
 v_mfma_f32_16x16x32_bf16 v[172:175], v[228:231], a[64:67], 0
tr 224,54,13312
tr 226,54,13824
wl 10
mg 64,v,232,a,4,64
 v_xor_b32 v14, 0, v5
 s_add_u32 m0, s47, 8192
 s_nop 0
 buffer_load_dwordx4 v14, s[8:11], s50 offen lds
 s_add_u32 s50, s50, 2048
mg 68,v,232,a,68,68
mg 176,v,232,v,48,176
tr 228,55,13312
tr 230,55,13824
mg 72,v,236,a,4,72
 v_xor_b32 v15, 32, v5
 s_add_u32 m0, s47, 9216
 s_nop 0
 buffer_load_dwordx4 v15, s[8:11], s50 offen lds
 s_add_u32 s50, s50, 2048
mg 76,v,236,a,68,76
mg 32,v,48,a,4,32
tr 232,52,14336
tr 234,52,14848
wl 10
mg 80,v,208,a,4,80
 v_xor_b32 v14, 64, v5
 s_add_u32 m0, s47, 10240
 s_nop 0
 buffer_load_dwordx4 v14, s[8:11], s50 offen lds
 s_add_u32 s50, s50, 2048
mg 84,v,208,a,68,84
tr 236,53,14336
tr 238,53,14848
mg 88,v,212,a,4,88
 v_xor_b32 v15, 96, v5
 s_add_u32 m0, s47, 11264
 s_nop 0
 buffer_load_dwordx4 v15, s[8:11], s50 offen lds
 s_add_u32 s50, s50, 2048
mg 92,v,212,a,68,92
tr 208,54,14336
tr 210,54,14848
wl 10
mg 96,v,216,a,4,96
 v_xor_b32 v14, 128, v5
 s_add_u32 m0, s47, 12288
 s_nop 0
 buffer_load_dwordx4 v14, s[8:11], s50 offen lds
 s_add_u32 s50, s50, 2048
mg 100,v,216,a,68,100
mg 36,v,48,a,68,36
mg 180,v,216,v,48,180
tr 212,55,14336
tr 214,55,14848
mg 104,v,220,a,4,104
 v_xor_b32 v15, 160, v5
 s_add_u32 m0, s47, 13312
 s_nop 0
 buffer_load_dwordx4 v15, s[8:11], s50 offen lds
 s_add_u32 s50, s50, 2048
mg 108,v,220,a,68,108
tr 216,60,26624
tr 218,60,26880
wl 10
mg 112,v,224,a,4,112
 v_xor_b32 v14, 192, v5
 s_add_u32 m0, s47, 14336
 s_nop 0
 buffer_load_dwordx4 v14, s[8:11], s50 offen lds
 s_add_u32 s50, s50, 2048
mg 116,v,224,a,68,116
tr 220,61,26624
tr 222,61,26880
mg 120,v,228,a,4,120
 v_xor_b32 v15, 224, v5
 s_add_u32 m0, s47, 15360
 s_nop 0
 buffer_load_dwordx4 v15, s[8:11], s50 offen lds
 s_add_u32 s50, s50, 2048
 s_sub_u32 s50, s50, 32256
mg 124,v,228,a,68,124
mg 40,a,4,a,4,40
 s_waitcnt vmcnt(23) lgkmcnt(0)
 s_barrier
 s_add_u32 m0, s54, 65536
 s_nop 0
 buffer_load_dwordx4 v6, s[12:15], s46 offen offset:0 lds
 s_add_u32 m0, s54, 66432
 s_nop 0
 buffer_load_dwordx4 v6, s[12:15], s46 offen offset:128 lds
 s_add_u32 m0, s54, 67328
 s_nop 0
 buffer_load_dwordx4 v6, s[12:15], s46 offen offset:256 lds
 s_add_u32 m0, s54, 68608
 s_nop 0
 buffer_load_dwordx4 v7, s[12:15], s46 offen offset:0 lds
 s_add_u32 m0, s54, 69504
 s_nop 0
 buffer_load_dwordx4 v7, s[12:15], s46 offen offset:128 lds
 s_add_u32 m0, s54, 70400
 s_nop 0
 buffer_load_dwordx4 v7, s[12:15], s46 offen offset:256 lds
 s_add_u32 s46, s46, 229376
 s_add_u32 m0, s56, 90112
 s_nop 0
 buffer_load_dwordx4 v8, s[12:15], s53 offen lds
 s_add_u32 s53, s53, 229376
tr 224,52,28672
tr 226,52,29184
wl 10
mg 128,v,232,a,4,128
mg 132,v,232,a,68,132
mg 184,v,232,v,48,184
tr 228,53,28672
tr 230,53,29184
mg 136,v,236,a,4,136
mg 140,v,236,a,68,140
tr 232,54,28672
tr 234,54,29184
wl 10
mg 144,v,208,a,4,144
mg 148,v,208,a,68,148
mg 44,a,68,a,68,44
tr 236,55,28672
tr 238,55,29184
mg 152,v,212,a,4,152
mg 156,v,212,a,68,156
tr 208,52,29696
tr 210,52,30208
wl 10
mg 160,v,216,a,4,160
mg 164,v,216,a,68,164
mg 188,v,216,v,48,188
tr 212,53,29696
tr 214,53,30208
mg 168,v,220,a,4,168
mg 172,v,220,a,68,172
tr 216,54,29696
tr 218,54,30208
wl 10
mg 64,v,224,a,8,64
mg 68,v,224,a,72,68
mg 176,v,224,v,48,176
tr 220,55,29696
tr 222,55,30208
mg 72,v,228,a,8,72
mg 76,v,228,a,72,76
mg 32,v,48,a,8,32
tr 224,52,30720
tr 226,52,31232
wl 10
mg 80,v,232,a,8,80
mg 84,v,232,a,72,84
tr 228,53,30720
tr 230,53,31232
mg 88,v,236,a,8,88
mg 92,v,236,a,72,92
tr 232,54,30720
tr 234,54,31232
wl 10
mg 96,v,208,a,8,96
mg 100,v,208,a,72,100
mg 36,v,48,a,72,36
mg 180,v,208,v,48,180
tr 236,55,30720
tr 238,55,31232
mg 104,v,212,a,8,104
mg 108,v,212,a,72,108
tr 208,60,53248
tr 210,60,53504
wl 10
mg 112,v,216,a,8,112
mg 116,v,216,a,72,116
tr 212,61,53248
tr 214,61,53504
mg 120,v,220,a,8,120
mg 124,v,220,a,72,124
mg 40,a,8,a,8,40
tr 216,52,40960
tr 218,52,41472
wl 10
mg 128,v,224,a,8,128
mg 132,v,224,a,72,132
mg 184,v,224,v,48,184
tr 220,53,40960
tr 222,53,41472
mg 136,v,228,a,8,136
mg 140,v,228,a,72,140
tr 224,54,40960
tr 226,54,41472
wl 10
mg 144,v,232,a,8,144
mg 148,v,232,a,72,148
mg 44,a,72,a,72,44
tr 228,55,40960
tr 230,55,41472
mg 152,v,236,a,8,152
mg 156,v,236,a,72,156
tr 232,52,41984
tr 234,52,42496
wl 10
mg 160,v,208,a,8,160
mg 164,v,208,a,72,164
mg 188,v,208,v,48,188
tr 236,53,41984
tr 238,53,42496
mg 168,v,212,a,8,168
mg 172,v,212,a,72,172
tr 208,54,41984
tr 210,54,42496
wl 10
mg 64,v,216,a,12,64
mg 68,v,216,a,76,68
mg 176,v,216,v,48,176
tr 212,55,41984
tr 214,55,42496
mg 72,v,220,a,12,72
mg 76,v,220,a,76,76
mg 32,v,48,a,12,32
tr 216,52,43008
tr 218,52,43520
wl 10
mg 80,v,224,a,12,80
mg 84,v,224,a,76,84
tr 220,53,43008
tr 222,53,43520
mg 88,v,228,a,12,88
mg 92,v,228,a,76,92
tr 224,54,43008
tr 226,54,43520
wl 10
mg 96,v,232,a,12,96
mg 100,v,232,a,76,100
mg 36,v,48,a,76,36
mg 180,v,232,v,48,180
tr 228,55,43008
tr 230,55,43520
mg 104,v,236,a,12,104
mg 108,v,236,a,76,108
tr 232,60,55296
tr 234,60,55552
wl 10
mg 112,v,208,a,12,112
mg 116,v,208,a,76,116
tr 236,61,55296
tr 238,61,55552
mg 120,v,212,a,12,120
mg 124,v,212,a,76,124
mg 40,a,12,a,12,40
 s_waitcnt vmcnt(23) lgkmcnt(0)
 s_barrier
 s_add_u32 m0, s54, 94208
 s_nop 0
 buffer_load_dwordx4 v6, s[12:15], s46 offen offset:0 lds
 s_add_u32 m0, s54, 95104
 s_nop 0
 buffer_load_dwordx4 v6, s[12:15], s46 offen offset:128 lds
 s_add_u32 m0, s54, 96000
 s_nop 0
 buffer_load_dwordx4 v6, s[12:15], s46 offen offset:256 lds
 s_add_u32 m0, s54, 97280
 s_nop 0
 buffer_load_dwordx4 v7, s[12:15], s46 offen offset:0 lds
 s_add_u32 m0, s54, 98176
 s_nop 0
 buffer_load_dwordx4 v7, s[12:15], s46 offen offset:128 lds
 s_add_u32 m0, s54, 99072
 s_nop 0
 buffer_load_dwordx4 v7, s[12:15], s46 offen offset:256 lds
 s_add_u32 s46, s46, 229376
 s_add_u32 m0, s56, 118784
 s_nop 0
 buffer_load_dwordx4 v8, s[12:15], s53 offen lds
 s_add_u32 s53, s53, 229376
tr 208,56,0
tr 210,56,512
wl 10
mg 128,v,216,a,12,128
mg 132,v,216,a,76,132
mg 184,v,216,v,48,184
tr 212,57,0
tr 214,57,512
mg 136,v,220,a,12,136
mg 140,v,220,a,76,140
tr 216,58,0
tr 218,58,512
wl 10
mg 144,v,224,a,12,144
mg 148,v,224,a,76,148
mg 44,a,76,a,76,44
tr 220,59,0
tr 222,59,512
mg 152,v,228,a,12,152
mg 156,v,228,a,76,156
tr 224,56,1024
tr 226,56,1536
wl 10
mg 160,v,232,a,12,160
mg 164,v,232,a,76,164
mg 188,v,232,v,48,188
tr 228,57,1024
tr 230,57,1536
mg 168,v,236,a,12,168
mg 172,v,236,a,76,172
tr 232,58,1024
tr 234,58,1536
wl 10
mg 64,v,208,a,16,64
mg 68,v,208,a,80,68
mg 176,v,208,v,48,176
tr 236,59,1024
tr 238,59,1536
mg 72,v,212,a,16,72
mg 76,v,212,a,80,76
mg 32,v,48,a,16,32
tr 208,56,2048
tr 210,56,2560
wl 10
mg 80,v,216,a,16,80
mg 84,v,216,a,80,84
tr 212,57,2048
tr 214,57,2560
mg 88,v,220,a,16,88
mg 92,v,220,a,80,92
tr 216,58,2048
tr 218,58,2560
wl 10
mg 96,v,224,a,16,96
mg 100,v,224,a,80,100
mg 36,v,48,a,80,36
mg 180,v,224,v,48,180
tr 220,59,2048
tr 222,59,2560
mg 104,v,228,a,16,104
mg 108,v,228,a,80,108
tr 224,62,24576
tr 226,62,24832
wl 10
mg 112,v,232,a,16,112
mg 116,v,232,a,80,116
tr 228,63,24576
tr 230,63,24832
mg 120,v,236,a,16,120
mg 124,v,236,a,80,124
mg 40,a,16,a,16,40
tr 232,56,12288
tr 234,56,12800
wl 10
mg 128,v,208,a,16,128
mg 132,v,208,a,80,132
mg 184,v,208,v,48,184
tr 236,57,12288
tr 238,57,12800
mg 136,v,212,a,16,136
mg 140,v,212,a,80,140
tr 208,58,12288
tr 210,58,12800
wl 10
mg 144,v,216,a,16,144
mg 148,v,216,a,80,148
mg 44,a,80,a,80,44
tr 212,59,12288
tr 214,59,12800
mg 152,v,220,a,16,152
mg 156,v,220,a,80,156
tr 216,56,13312
tr 218,56,13824
wl 10
mg 160,v,224,a,16,160
mg 164,v,224,a,80,164
mg 188,v,224,v,48,188
tr 220,57,13312
tr 222,57,13824
mg 168,v,228,a,16,168
mg 172,v,228,a,80,172
tr 224,58,13312
tr 226,58,13824
wl 10
mg 64,v,232,a,20,64
mg 68,v,232,a,84,68
mg 176,v,232,v,48,176
tr 228,59,13312
tr 230,59,13824
mg 72,v,236,a,20,72
mg 76,v,236,a,84,76
mg 32,v,48,a,20,32
tr 232,56,14336
tr 234,56,14848
wl 10
mg 80,v,208,a,20,80
mg 84,v,208,a,84,84
tr 236,57,14336
tr 238,57,14848
mg 88,v,212,a,20,88
mg 92,v,212,a,84,92
tr 208,58,14336
tr 210,58,14848
wl 10
mg 96,v,216,a,20,96
mg 100,v,216,a,84,100
mg 36,v,48,a,84,36
mg 180,v,216,v,48,180
tr 212,59,14336
tr 214,59,14848
mg 104,v,220,a,20,104
mg 108,v,220,a,84,108
tr 216,62,26624
tr 218,62,26880
wl 10
mg 112,v,224,a,20,112
mg 116,v,224,a,84,116
tr 220,63,26624
tr 222,63,26880
mg 120,v,228,a,20,120
mg 124,v,228,a,84,124
mg 40,a,20,a,20,40
 s_waitcnt vmcnt(7) lgkmcnt(0)
 s_barrier
 s_add_u32 m0, s54, 122880
 s_nop 0
 buffer_load_dwordx4 v6, s[12:15], s46 offen offset:0 lds
 s_add_u32 m0, s54, 123776
 s_nop 0
 buffer_load_dwordx4 v6, s[12:15], s46 offen offset:128 lds
 s_add_u32 m0, s54, 124672
 s_nop 0
 buffer_load_dwordx4 v6, s[12:15], s46 offen offset:256 lds
 s_add_u32 m0, s54, 125952
 s_nop 0
 buffer_load_dwordx4 v7, s[12:15], s46 offen offset:0 lds
 s_add_u32 m0, s54, 126848
 s_nop 0
 buffer_load_dwordx4 v7, s[12:15], s46 offen offset:128 lds
 s_add_u32 m0, s54, 127744
 s_nop 0
 buffer_load_dwordx4 v7, s[12:15], s46 offen offset:256 lds
 s_add_u32 s46, s46, 229376
 s_add_u32 m0, s56, 147456
 s_nop 0
 buffer_load_dwordx4 v8, s[12:15], s53 offen lds
 s_add_u32 s53, s53, 229376
 ds_read_b128 a[32:35], v28 offset:0
 ds_read_b128 a[36:39], v29 offset:0
 ds_read_b128 a[40:43], v30 offset:0
 ds_read_b128 a[44:47], v31 offset:0
 ds_read_b128 a[48:51], v28 offset:256
 ds_read_b128 a[52:55], v29 offset:256
 ds_read_b128 a[56:59], v30 offset:256
 ds_read_b128 a[60:63], v31 offset:256
 ds_read_b128 a[96:99], v28 offset:8192
 ds_read_b128 a[100:103], v29 offset:8192
 ds_read_b128 a[104:107], v30 offset:8192
 ds_read_b128 a[108:111], v31 offset:8192
 ds_read_b128 a[112:115], v28 offset:8448
 ds_read_b128 a[116:119], v29 offset:8448
 ds_read_b128 a[120:123], v30 offset:8448
 ds_read_b128 a[124:127], v31 offset:8448
tr 224,52,0
tr 226,52,512
wl 10
mg 128,v,232,a,20,128
mg 132,v,232,a,84,132
mg 184,v,232,v,48,184
tr 228,53,0
tr 230,53,512
mg 136,v,236,a,20,136
mg 140,v,236,a,84,140
tr 232,54,0
tr 234,54,512
wl 10
mg 144,v,208,a,20,144
mg 148,v,208,a,84,148
mg 44,a,84,a,84,44
tr 236,55,0
tr 238,55,512
mg 152,v,212,a,20,152
mg 156,v,212,a,84,156
tr 208,52,1024
tr 210,52,1536
wl 10
mg 160,v,216,a,20,160
mg 164,v,216,a,84,164
mg 188,v,216,v,48,188
tr 212,53,1024
tr 214,53,1536
mg 168,v,220,a,20,168
mg 172,v,220,a,84,172
tr 216,54,1024
tr 218,54,1536
wl 10
mg 64,v,224,a,24,64
mg 68,v,224,a,88,68
mg 176,v,224,v,48,176
tr 220,55,1024
tr 222,55,1536
mg 72,v,228,a,24,72
mg 76,v,228,a,88,76
mg 32,v,48,a,24,32
tr 224,52,2048
tr 226,52,2560
wl 10
mg 80,v,232,a,24,80
mg 84,v,232,a,88,84
tr 228,53,2048
tr 230,53,2560
mg 88,v,236,a,24,88
mg 92,v,236,a,88,92
tr 232,54,2048
tr 234,54,2560
wl 10
mg 96,v,208,a,24,96
mg 100,v,208,a,88,100
mg 36,v,48,a,88,36
mg 180,v,208,v,48,180
tr 236,55,2048
tr 238,55,2560
mg 104,v,212,a,24,104
mg 108,v,212,a,88,108
tr 208,60,24576
tr 210,60,24832
wl 10
mg 112,v,216,a,24,112
mg 116,v,216,a,88,116
tr 212,61,24576
tr 214,61,24832
mg 120,v,220,a,24,120
mg 124,v,220,a,88,124
mg 40,a,24,a,24,40
tr 216,52,12288
tr 218,52,12800
wl 10
mg 128,v,224,a,24,128
mg 132,v,224,a,88,132
mg 184,v,224,v,48,184
tr 220,53,12288
tr 222,53,12800
mg 136,v,228,a,24,136
mg 140,v,228,a,88,140
tr 224,54,12288
tr 226,54,12800
wl 10
mg 144,v,232,a,24,144
mg 148,v,232,a,88,148
mg 44,a,88,a,88,44
tr 228,55,12288
tr 230,55,12800
mg 152,v,236,a,24,152
mg 156,v,236,a,88,156
tr 232,52,13312
tr 234,52,13824
wl 10
mg 160,v,208,a,24,160
mg 164,v,208,a,88,164
mg 188,v,208,v,48,188
tr 236,53,13312
tr 238,53,13824
mg 168,v,212,a,24,168
mg 172,v,212,a,88,172
tr 208,54,13312
tr 210,54,13824
wl 10
mg 64,v,216,a,28,64
mg 68,v,216,a,92,68
mg 176,v,216,v,48,176
tr 212,55,13312
tr 214,55,13824
mg 72,v,220,a,28,72
mg 76,v,220,a,92,76
mg 32,v,48,a,28,32
tr 216,52,14336
tr 218,52,14848
wl 10
mg 80,v,224,a,28,80
mg 84,v,224,a,92,84
tr 220,53,14336
tr 222,53,14848
mg 88,v,228,a,28,88
mg 92,v,228,a,92,92
tr 224,54,14336
tr 226,54,14848
wl 10
mg 96,v,232,a,28,96
mg 100,v,232,a,92,100
mg 36,v,48,a,92,36
mg 180,v,232,v,48,180
tr 228,55,14336
tr 230,55,14848
mg 104,v,236,a,28,104
mg 108,v,236,a,92,108
tr 232,60,26624
tr 234,60,26880
wl 10
mg 112,v,208,a,28,112
mg 116,v,208,a,92,116
tr 236,61,26624
tr 238,61,26880
mg 120,v,212,a,28,120
mg 124,v,212,a,92,124
mg 40,a,28,a,28,40
 s_waitcnt vmcnt(7) lgkmcnt(0)
 s_barrier
 s_cmp_ge_u32 s51, 576
 s_cbranch_scc1 K1_HH_nojob0
 v_lshrrev_b32 v22, 3, v1
 v_and_b32 v23, 7, v1
 v_and_b32 v24, 2, v22
 v_xor_b32 v23, v23, v24
 v_lshlrev_b32 v22, 10, v22
 v_lshl_add_u32 v24, v23, 4, v22
 v_xor_b32 v23, 4, v23
 v_lshl_add_u32 v25, v23, 4, v22
 s_add_u32 m0, s47, 0
 s_nop 0
 buffer_load_dwordx4 v24, s[20:23], s57 offen lds
 s_add_u32 s57, s57, 8192
 s_add_u32 m0, s47, 1024
 s_nop 0
 buffer_load_dwordx4 v25, s[20:23], s57 offen lds
 s_add_u32 s57, s57, 8192
 s_add_u32 m0, s47, 2048
 s_nop 0
 buffer_load_dwordx4 v24, s[20:23], s57 offen lds
 s_add_u32 s57, s57, 8192
 s_add_u32 m0, s47, 3072
 s_nop 0
 buffer_load_dwordx4 v25, s[20:23], s57 offen lds
 s_add_u32 s57, s57, 8192
K1_HH_nojob0:
 s_add_u32 m0, s54, 65536
 s_nop 0
 buffer_load_dwordx4 v6, s[12:15], s46 offen offset:0 lds
 s_add_u32 m0, s54, 66432
 s_nop 0
 buffer_load_dwordx4 v6, s[12:15], s46 offen offset:128 lds
 s_add_u32 m0, s54, 67328
 s_nop 0
 buffer_load_dwordx4 v6, s[12:15], s46 offen offset:256 lds
 s_add_u32 m0, s54, 68608
 s_nop 0
 buffer_load_dwordx4 v7, s[12:15], s46 offen offset:0 lds
 s_add_u32 m0, s54, 69504
 s_nop 0
 buffer_load_dwordx4 v7, s[12:15], s46 offen offset:128 lds
 s_add_u32 m0, s54, 70400
 s_nop 0
 buffer_load_dwordx4 v7, s[12:15], s46 offen offset:256 lds
 s_add_u32 s46, s46, 229376
 s_add_u32 m0, s56, 90112
 s_nop 0
 buffer_load_dwordx4 v8, s[12:15], s53 offen lds
 s_add_u32 s53, s53, 229376
tr 208,52,28672
tr 210,52,29184
wl 10
mg 128,v,216,a,28,128
mg 132,v,216,a,92,132
mg 184,v,216,v,48,184
tr 212,53,28672
tr 214,53,29184
mg 136,v,220,a,28,136
mg 140,v,220,a,92,140
tr 216,54,28672
tr 218,54,29184
wl 10
mg 144,v,224,a,28,144
mg 148,v,224,a,92,148
mg 44,a,92,a,92,44
tr 220,55,28672
tr 222,55,29184
mg 152,v,228,a,28,152
mg 156,v,228,a,92,156
tr 224,52,29696
tr 226,52,30208
wl 10
mg 160,v,232,a,28,160
mg 164,v,232,a,92,164
mg 188,v,232,v,48,188
tr 228,53,29696
tr 230,53,30208
mg 168,v,236,a,28,168
mg 172,v,236,a,92,172
tr 232,54,29696
tr 234,54,30208
wl 10
mg 64,v,208,a,32,64
mg 68,v,208,a,96,68
mg 176,v,208,v,48,176
tr 236,55,29696
tr 238,55,30208
mg 72,v,212,a,32,72
mg 76,v,212,a,96,76
mg 32,v,48,a,32,32
tr 208,52,30720
tr 210,52,31232
wl 10
mg 80,v,216,a,32,80
mg 84,v,216,a,96,84
tr 212,53,30720
tr 214,53,31232
mg 88,v,220,a,32,88
mg 92,v,220,a,96,92
tr 216,54,30720
tr 218,54,31232
wl 10
mg 96,v,224,a,32,96
mg 100,v,224,a,96,100
mg 36,v,48,a,96,36
mg 180,v,224,v,48,180
tr 220,55,30720
tr 222,55,31232
mg 104,v,228,a,32,104
mg 108,v,228,a,96,108
tr 224,60,53248
tr 226,60,53504
wl 10
mg 112,v,232,a,32,112
mg 116,v,232,a,96,116
tr 228,61,53248
tr 230,61,53504
mg 120,v,236,a,32,120
mg 124,v,236,a,96,124
mg 40,a,32,a,32,40
tr 232,52,40960
tr 234,52,41472
wl 10
mg 128,v,208,a,32,128
mg 132,v,208,a,96,132
mg 184,v,208,v,48,184
tr 236,53,40960
tr 238,53,41472
mg 136,v,212,a,32,136
mg 140,v,212,a,96,140
tr 208,54,40960
tr 210,54,41472
wl 10
mg 144,v,216,a,32,144
mg 148,v,216,a,96,148
mg 44,a,96,a,96,44
tr 212,55,40960
tr 214,55,41472
mg 152,v,220,a,32,152
mg 156,v,220,a,96,156
tr 216,52,41984
tr 218,52,42496
wl 10
mg 160,v,224,a,32,160
mg 164,v,224,a,96,164
mg 188,v,224,v,48,188
tr 220,53,41984
tr 222,53,42496
mg 168,v,228,a,32,168
mg 172,v,228,a,96,172
tr 224,54,41984
tr 226,54,42496
wl 10
mg 64,v,232,a,36,64
mg 68,v,232,a,100,68
mg 176,v,232,v,48,176
tr 228,55,41984
tr 230,55,42496
mg 72,v,236,a,36,72
mg 76,v,236,a,100,76
mg 32,v,48,a,36,32
tr 232,52,43008
tr 234,52,43520
wl 10
mg 80,v,208,a,36,80
mg 84,v,208,a,100,84
tr 236,53,43008
tr 238,53,43520
mg 88,v,212,a,36,88
mg 92,v,212,a,100,92
tr 208,54,43008
tr 210,54,43520
wl 10
mg 96,v,216,a,36,96
mg 100,v,216,a,100,100
mg 36,v,48,a,100,36
mg 180,v,216,v,48,180
tr 212,55,43008
tr 214,55,43520
mg 104,v,220,a,36,104
mg 108,v,220,a,100,108
tr 216,60,55296
tr 218,60,55552
wl 10
mg 112,v,224,a,36,112
mg 116,v,224,a,100,116
tr 220,61,55296
tr 222,61,55552
mg 120,v,228,a,36,120
mg 124,v,228,a,100,124
mg 40,a,36,a,36,40
 s_waitcnt vmcnt(7) lgkmcnt(0)
 s_barrier
 s_add_u32 m0, s54, 94208
 s_nop 0
 buffer_load_dwordx4 v6, s[12:15], s46 offen offset:0 lds
 s_add_u32 m0, s54, 95104
 s_nop 0
 buffer_load_dwordx4 v6, s[12:15], s46 offen offset:128 lds
 s_add_u32 m0, s54, 96000
 s_nop 0
 buffer_load_dwordx4 v6, s[12:15], s46 offen offset:256 lds
 s_add_u32 m0, s54, 97280
 s_nop 0
 buffer_load_dwordx4 v7, s[12:15], s46 offen offset:0 lds
 s_add_u32 m0, s54, 98176
 s_nop 0
 buffer_load_dwordx4 v7, s[12:15], s46 offen offset:128 lds
 s_add_u32 m0, s54, 99072
 s_nop 0
 buffer_load_dwordx4 v7, s[12:15], s46 offen offset:256 lds
 s_add_u32 s46, s46, 229376
 s_add_u32 m0, s56, 118784
 s_nop 0
 buffer_load_dwordx4 v8, s[12:15], s53 offen lds
 s_add_u32 s53, s53, 229376
 s_cmp_ge_u32 s51, 576
 s_cbranch_scc1 K1_HH_nojob
 s_sub_u32 s48, s47, 65536
 v_lshlrev_b32 v14, 11, v2
 v_sub_u32 v14, s48, v14
 v_add_u32 v16, v14, v52
 v_add_u32 v17, v14, v53
 v_add_u32 v18, v14, v54
 v_add_u32 v19, v14, v55
tr 192,16,0
tr 194,16,512
tr 196,17,0
tr 198,17,512
tr 200,18,0
tr 202,18,512
tr 204,19,0
tr 206,19,512
 s_and_b32 s48, s51, 7
 s_mul_i32 s48, s48, 288
 s_lshr_b32 s52, s51, 3
 s_add_u32 s48, s48, s52
 s_lshl_b32 s48, s48, 10
 s_add_u32 s48, s48, 20971520
wl 0
 s_mul_i32 s52, s24, 73728
 s_add_u32 s52, s52, s48
 buffer_store_dwordx4 v[192:195], v4, s[16:19], s52 offen sc1
 s_mul_i32 s52, s25, 73728
 s_add_u32 s52, s52, s48
 buffer_store_dwordx4 v[196:199], v4, s[16:19], s52 offen sc1
 s_mul_i32 s52, s26, 73728
 s_add_u32 s52, s52, s48
 buffer_store_dwordx4 v[200:203], v4, s[16:19], s52 offen sc1
 s_mul_i32 s52, s27, 73728
 s_add_u32 s52, s52, s48
 buffer_store_dwordx4 v[204:207], v4, s[16:19], s52 offen sc1
K1_HH_nojob:
tr 224,56,0
tr 226,56,512
wl 10
mg 128,v,232,a,36,128
mg 132,v,232,a,100,132
mg 184,v,232,v,48,184
tr 228,57,0
tr 230,57,512
mg 136,v,236,a,36,136
mg 140,v,236,a,100,140
tr 232,58,0
tr 234,58,512
wl 10
mg 144,v,208,a,36,144
mg 148,v,208,a,100,148
mg 44,a,100,a,100,44
tr 236,59,0
tr 238,59,512
mg 152,v,212,a,36,152
mg 156,v,212,a,100,156
tr 208,56,1024
tr 210,56,1536
wl 10
mg 160,v,216,a,36,160
mg 164,v,216,a,100,164
mg 188,v,216,v,48,188
tr 212,57,1024
tr 214,57,1536
mg 168,v,220,a,36,168
mg 172,v,220,a,100,172
tr 216,58,1024
tr 218,58,1536
wl 10
mg 64,v,224,a,40,64
mg 68,v,224,a,104,68
mg 176,v,224,v,48,176
tr 220,59,1024
tr 222,59,1536
mg 72,v,228,a,40,72
mg 76,v,228,a,104,76
mg 32,v,48,a,40,32
tr 224,56,2048
tr 226,56,2560
wl 10
mg 80,v,232,a,40,80
mg 84,v,232,a,104,84
tr 228,57,2048
tr 230,57,2560
mg 88,v,236,a,40,88
mg 92,v,236,a,104,92
tr 232,58,2048
tr 234,58,2560
wl 10
mg 96,v,208,a,40,96
mg 100,v,208,a,104,100
mg 36,v,48,a,104,36
mg 180,v,208,v,48,180
tr 236,59,2048
tr 238,59,2560
mg 104,v,212,a,40,104
mg 108,v,212,a,104,108
tr 208,62,24576
tr 210,62,24832
wl 10
mg 112,v,216,a,40,112
mg 116,v,216,a,104,116
tr 212,63,24576
tr 214,63,24832
mg 120,v,220,a,40,120
mg 124,v,220,a,104,124
mg 40,a,40,a,40,40
tr 216,56,12288
tr 218,56,12800
wl 10
mg 128,v,224,a,40,128
mg 132,v,224,a,104,132
mg 184,v,224,v,48,184
tr 220,57,12288
tr 222,57,12800
mg 136,v,228,a,40,136
mg 140,v,228,a,104,140
tr 224,58,12288
tr 226,58,12800
wl 10
mg 144,v,232,a,40,144
mg 148,v,232,a,104,148
mg 44,a,104,a,104,44
tr 228,59,12288
tr 230,59,12800
mg 152,v,236,a,40,152
mg 156,v,236,a,104,156
tr 232,56,13312
tr 234,56,13824
wl 10
mg 160,v,208,a,40,160
mg 164,v,208,a,104,164
mg 188,v,208,v,48,188
tr 236,57,13312
tr 238,57,13824
mg 168,v,212,a,40,168
mg 172,v,212,a,104,172
tr 208,58,13312
tr 210,58,13824
wl 10
mg 64,v,216,a,44,64
mg 68,v,216,a,108,68
mg 176,v,216,v,48,176
tr 212,59,13312
tr 214,59,13824
mg 72,v,220,a,44,72
mg 76,v,220,a,108,76
mg 32,v,48,a,44,32
tr 216,56,14336
tr 218,56,14848
wl 10
mg 80,v,224,a,44,80
mg 84,v,224,a,108,84
tr 220,57,14336
tr 222,57,14848
mg 88,v,228,a,44,88
mg 92,v,228,a,108,92
tr 224,58,14336
tr 226,58,14848
wl 10
mg 96,v,232,a,44,96
mg 100,v,232,a,108,100
mg 36,v,48,a,108,36
mg 180,v,232,v,48,180
tr 228,59,14336
tr 230,59,14848
mg 104,v,236,a,44,104
mg 108,v,236,a,108,108
tr 232,62,26624
tr 234,62,26880
wl 10
mg 112,v,208,a,44,112
mg 116,v,208,a,108,116
tr 236,63,26624
tr 238,63,26880
mg 120,v,212,a,44,120
mg 124,v,212,a,108,124
mg 40,a,44,a,44,40
 s_waitcnt vmcnt(7) lgkmcnt(0)
 s_barrier
tr 208,52,0
tr 210,52,512
wl 10
mg 128,v,216,a,44,128
mg 132,v,216,a,108,132
mg 184,v,216,v,48,184
tr 212,53,0
tr 214,53,512
mg 136,v,220,a,44,136
mg 140,v,220,a,108,140
tr 216,54,0
tr 218,54,512
wl 10
mg 144,v,224,a,44,144
mg 148,v,224,a,108,148
mg 44,a,108,a,108,44
tr 220,55,0
tr 222,55,512
mg 152,v,228,a,44,152
mg 156,v,228,a,108,156
tr 224,52,1024
tr 226,52,1536
wl 10
mg 160,v,232,a,44,160
mg 164,v,232,a,108,164
mg 188,v,232,v,48,188
tr 228,53,1024
tr 230,53,1536
mg 168,v,236,a,44,168
mg 172,v,236,a,108,172
tr 232,54,1024
tr 234,54,1536
wl 10
mg 64,v,208,a,48,64
mg 68,v,208,a,112,68
mg 176,v,208,v,48,176
tr 236,55,1024
tr 238,55,1536
mg 72,v,212,a,48,72
mg 76,v,212,a,112,76
mg 32,v,48,a,48,32
tr 208,52,2048
tr 210,52,2560
wl 10
mg 80,v,216,a,48,80
mg 84,v,216,a,112,84
tr 212,53,2048
tr 214,53,2560
mg 88,v,220,a,48,88
mg 92,v,220,a,112,92
tr 216,54,2048
tr 218,54,2560
wl 10
mg 96,v,224,a,48,96
mg 100,v,224,a,112,100
mg 36,v,48,a,112,36
mg 180,v,224,v,48,180
tr 220,55,2048
tr 222,55,2560
mg 104,v,228,a,48,104
mg 108,v,228,a,112,108
tr 224,60,24576
tr 226,60,24832
wl 10
mg 112,v,232,a,48,112
mg 116,v,232,a,112,116
tr 228,61,24576
tr 230,61,24832
mg 120,v,236,a,48,120
mg 124,v,236,a,112,124
mg 40,a,48,a,48,40
tr 232,52,12288
tr 234,52,12800
wl 10
mg 128,v,208,a,48,128
mg 132,v,208,a,112,132
mg 184,v,208,v,48,184
tr 236,53,12288
tr 238,53,12800
mg 136,v,212,a,48,136
mg 140,v,212,a,112,140
tr 208,54,12288
tr 210,54,12800
wl 10
mg 144,v,216,a,48,144
mg 148,v,216,a,112,148
mg 44,a,112,a,112,44
tr 212,55,12288
tr 214,55,12800
mg 152,v,220,a,48,152
mg 156,v,220,a,112,156
tr 216,52,13312
tr 218,52,13824
wl 10
mg 160,v,224,a,48,160
mg 164,v,224,a,112,164
mg 188,v,224,v,48,188
tr 220,53,13312
tr 222,53,13824
mg 168,v,228,a,48,168
mg 172,v,228,a,112,172
tr 224,54,13312
tr 226,54,13824
wl 10
mg 64,v,232,a,52,64
mg 68,v,232,a,116,68
mg 176,v,232,v,48,176
tr 228,55,13312
tr 230,55,13824
mg 72,v,236,a,52,72
mg 76,v,236,a,116,76
mg 32,v,48,a,52,32
tr 232,52,14336
tr 234,52,14848
wl 10
mg 80,v,208,a,52,80
mg 84,v,208,a,116,84
tr 236,53,14336
tr 238,53,14848
mg 88,v,212,a,52,88
mg 92,v,212,a,116,92
tr 208,54,14336
tr 210,54,14848
wl 10
mg 96,v,216,a,52,96
mg 100,v,216,a,116,100
mg 36,v,48,a,116,36
mg 180,v,216,v,48,180
tr 212,55,14336
tr 214,55,14848
mg 104,v,220,a,52,104
mg 108,v,220,a,116,108
tr 216,60,26624
tr 218,60,26880
wl 10
mg 112,v,224,a,52,112
mg 116,v,224,a,116,116
tr 220,61,26624
tr 222,61,26880
mg 120,v,228,a,52,120
mg 124,v,228,a,116,124
mg 40,a,52,a,52,40
 s_waitcnt vmcnt(0) lgkmcnt(0)
 s_barrier
tr 224,52,28672
tr 226,52,29184
wl 10
mg 128,v,232,a,52,128
mg 132,v,232,a,116,132
mg 184,v,232,v,48,184
tr 228,52,29696
tr 230,52,30208
mg 136,v,236,a,52,136
mg 140,v,236,a,116,140
tr 232,52,30720
tr 234,52,31232
wl 10
mg 144,v,208,a,52,144
mg 148,v,208,a,116,148
mg 44,a,116,a,116,44
tr 236,60,53248
tr 238,60,53504
mg 152,v,212,a,52,152
mg 156,v,212,a,116,156
tr 208,52,40960
tr 210,52,41472
wl 10
mg 160,v,216,a,52,160
mg 164,v,216,a,116,164
mg 188,v,216,v,48,188
tr 212,52,41984
tr 214,52,42496
mg 168,v,220,a,52,168
mg 172,v,220,a,116,172
tr 216,52,43008
tr 218,52,43520
wl 10
mg 64,v,224,a,56,64
mg 68,v,224,a,120,68
mg 32,v,48,a,56,32
mg 176,v,224,v,48,176
tr 220,60,55296
tr 222,60,55552
mg 96,v,228,a,56,96
mg 100,v,228,a,120,100
mg 36,v,48,a,120,36
mg 180,v,228,v,48,180
tr 224,53,28672
tr 226,53,29184
wl 10
mg 128,v,232,a,56,128
mg 132,v,232,a,120,132
mg 40,a,56,a,56,40
mg 184,v,232,v,48,184
tr 228,53,40960
tr 230,53,41472
mg 160,v,236,a,56,160
mg 164,v,236,a,120,164
mg 44,a,120,a,120,44
mg 188,v,236,v,48,188
tr 232,54,28672
tr 234,54,29184
wl 10
mg 64,v,208,a,60,64
mg 68,v,208,a,124,68
mg 32,v,48,a,60,32
mg 176,v,208,v,48,176
tr 236,54,40960
tr 238,54,41472
mg 96,v,212,a,60,96
mg 100,v,212,a,124,100
mg 36,v,48,a,124,36
mg 180,v,212,v,48,180
tr 208,55,28672
tr 210,55,29184
wl 10
mg 128,v,216,a,60,128
mg 132,v,216,a,124,132
mg 40,a,60,a,60,40
mg 184,v,216,v,48,184
tr 212,55,40960
tr 214,55,41472
mg 160,v,220,a,60,160
mg 164,v,220,a,124,164
mg 44,a,124,a,124,44
mg 188,v,220,v,48,188
tr 216,53,29696
tr 218,53,30208
wl 10
mg 72,v,224,a,56,72
mg 76,v,224,a,120,76
 s_lshl_b32 s48, s3, 6
 s_add_u32 s48, s48, 151552
 v_lshlrev_b32 v14, 4, v2
 v_add_u32 v15, s48, v14
 s_and_b32 s48, s3, 1
 s_lshl_b32 s48, s48, 6
 s_add_u32 s48, s48, 151552
 v_add_u32 v14, s48, v14
 s_nop 7
 ds_write_b128 v15, v[176:179] offset:0
 ds_write_b128 v15, v[180:183] offset:256
 ds_write_b128 v15, v[184:187] offset:512
 ds_write_b128 v14, v[188:191] offset:768
 v_and_b32 v22, 3, v3
 v_cmp_eq_u32 vcc, 1, v22
 v_cndmask_b32 v40, v40, v41, vcc
 v_cndmask_b32 v44, v44, v45, vcc
 v_cmp_eq_u32 vcc, 2, v22
 v_cndmask_b32 v40, v40, v42, vcc
 v_cndmask_b32 v44, v44, v46, vcc
 v_cmp_eq_u32 vcc, 3, v22
 v_cndmask_b32 v40, v40, v43, vcc
 v_cndmask_b32 v44, v44, v47, vcc
 v_lshrrev_b32 v22, 2, v3
 v_lshl_add_u32 v22, v22, 4, v3
 v_lshlrev_b32 v22, 2, v22
 ds_bpermute_b32 v34, v22, v40
 ds_bpermute_b32 v38, v22, v44
tr 220,53,41984
tr 222,53,42496
mg 72,v,228,a,60,72
mg 76,v,228,a,124,76
tr 224,54,29696
tr 226,54,30208
wl 15
mg 80,v,232,a,56,80
mg 84,v,232,a,120,84
wl 4
 s_barrier
 s_mov_b32 s48, 989855744
 s_mov_b32 s52, 925353388
 v_mul_f32 v32, s48, v32
 v_mul_f32 v34, s48, v34
 v_fma_f32 v34, -v32, v32, v34
 v_max_f32 v34, 0, v34
 v_add_f32 v34, s52, v34
 v_rsq_f32 v10, v34
 v_sub_f32 v11, 0, v32
 v_mul_f32 v36, s48, v36
 v_mul_f32 v38, s48, v38
 v_fma_f32 v38, -v36, v36, v38
 v_max_f32 v38, 0, v38
 v_add_f32 v38, s52, v38
 v_rsq_f32 v12, v38
 v_sub_f32 v13, 0, v36
 v_lshlrev_b32 v26, 4, v2
 v_add_u32 v26, 151552, v26
 v_lshlrev_b32 v27, 2, v3
 v_add_u32 v27, 151552, v27
 s_lshl_b32 s52, s24, 6
 v_add_u32 v196, s52, v26
rq 192,196,0
 s_lshl_b32 s52, s24, 6
 v_add_u32 v204, s52, v26
rq 200,204,256
 v_lshrrev_b32 v14, 1, v2
 v_lshlrev_b32 v14, 8, v14
 v_lshl_add_u32 v14, v3, 4, v14
 v_and_b32 v15, 1, v2
 v_mul_u32_u24 v15, 57344, v15
 v_add_u32 v14, v15, v14
 s_lshr_b32 s53, s45, 4
 s_mul_i32 s53, s53, 56
 s_lshr_b32 s52, s44, 5
 s_add_u32 s48, s53, s52
 s_lshl_b32 s48, s48, 10
 s_add_u32 s48, s48, 6291456
 s_lshr_b32 s52, s55, 5
 s_add_u32 s53, s53, s52
 s_lshl_b32 s53, s53, 10
 s_add_u32 s53, s53, 6291456
tr 228,54,41984
tr 230,54,42496
mg 80,v,236,a,60,80
mg 84,v,236,a,124,84
 s_lshl_b32 s54, s24, 9
 s_add_u32 s54, s54, s48
wl 3
 v_pk_fma_f32 v[64:65], v[192:193], v[10:11], v[64:65] op_sel:[0,1,0] op_sel_hi:[1,1,1]
 v_pk_fma_f32 v[66:67], v[194:195], v[10:11], v[66:67] op_sel:[0,1,0] op_sel_hi:[1,1,1]
 v_pk_mul_f32 v[64:65], v[64:65], v[10:11] op_sel:[0,0] op_sel_hi:[1,0]
 v_pk_mul_f32 v[66:67], v[66:67], v[10:11] op_sel:[0,0] op_sel_hi:[1,0]
pk 64,64,65
pk 65,66,67
 v_pk_max_i16 v64, v64, 0
 v_pk_max_i16 v65, v65, 0
 v_pk_fma_f32 v[68:69], v[192:193], v[12:13], v[68:69] op_sel:[0,1,0] op_sel_hi:[1,1,1]
 v_pk_fma_f32 v[70:71], v[194:195], v[12:13], v[70:71] op_sel:[0,1,0] op_sel_hi:[1,1,1]
 v_pk_mul_f32 v[68:69], v[68:69], v[12:13] op_sel:[0,0] op_sel_hi:[1,0]
 v_pk_mul_f32 v[70:71], v[70:71], v[12:13] op_sel:[0,0] op_sel_hi:[1,0]
pk 66,68,69
pk 67,70,71
 v_pk_max_i16 v66, v66, 0
 v_pk_max_i16 v67, v67, 0
 s_lshl_b32 s52, s24, 6
 v_add_u32 v196, s52, v26
rq 192,196,512
 v_permlane16_swap_b32 v64, v66
 v_permlane16_swap_b32 v65, v67
 buffer_store_dwordx4 v[64:67], v14, s[16:19], s54 offen offset:0 sc1
tr 232,55,29696
tr 234,55,30208
wl 15
mg 88,v,208,a,56,88
mg 92,v,208,a,120,92
 s_lshl_b32 s54, s24, 9
 s_add_u32 s54, s54, s48
wl 5
 v_pk_fma_f32 v[96:97], v[200:201], v[10:11], v[96:97] op_sel:[0,1,0] op_sel_hi:[1,1,1]
 v_pk_fma_f32 v[98:99], v[202:203], v[10:11], v[98:99] op_sel:[0,1,0] op_sel_hi:[1,1,1]
 v_pk_mul_f32 v[96:97], v[96:97], v[10:11] op_sel:[0,0] op_sel_hi:[1,0]
 v_pk_mul_f32 v[98:99], v[98:99], v[10:11] op_sel:[0,0] op_sel_hi:[1,0]
pk 96,96,97
pk 97,98,99
 v_pk_max_i16 v96, v96, 0
 v_pk_max_i16 v97, v97, 0
 v_pk_fma_f32 v[100:101], v[200:201], v[12:13], v[100:101] op_sel:[0,1,0] op_sel_hi:[1,1,1]
 v_pk_fma_f32 v[102:103], v[202:203], v[12:13], v[102:103] op_sel:[0,1,0] op_sel_hi:[1,1,1]
 v_pk_mul_f32 v[100:101], v[100:101], v[12:13] op_sel:[0,0] op_sel_hi:[1,0]
 v_pk_mul_f32 v[102:103], v[102:103], v[12:13] op_sel:[0,0] op_sel_hi:[1,0]
pk 98,100,101
pk 99,102,103
 v_pk_max_i16 v98, v98, 0
 v_pk_max_i16 v99, v99, 0
 s_lshl_b32 s52, s24, 6
 s_and_b32 s52, s52, 64
 v_add_u32 v204, s52, v26
rq 200,204,768
 v_permlane16_swap_b32 v96, v98
 v_permlane16_swap_b32 v97, v99
 buffer_store_dwordx4 v[96:99], v14, s[16:19], s54 offen offset:2048 sc1
tr 236,55,41984
tr 238,55,42496
mg 88,v,212,a,60,88
mg 92,v,212,a,124,92
 s_lshl_b32 s54, s24, 9
 s_add_u32 s54, s54, s48
 s_add_u32 s54, s54, 4096
wl 5
 v_pk_fma_f32 v[128:129], v[192:193], v[10:11], v[128:129] op_sel:[0,1,0] op_sel_hi:[1,1,1]
 v_pk_fma_f32 v[130:131], v[194:195], v[10:11], v[130:131] op_sel:[0,1,0] op_sel_hi:[1,1,1]
 v_pk_mul_f32 v[128:129], v[128:129], v[10:11] op_sel:[0,0] op_sel_hi:[1,0]
 v_pk_mul_f32 v[130:131], v[130:131], v[10:11] op_sel:[0,0] op_sel_hi:[1,0]
pk 128,128,129
pk 129,130,131
 v_pk_max_i16 v128, v128, 0
 v_pk_max_i16 v129, v129, 0
 v_pk_fma_f32 v[132:133], v[192:193], v[12:13], v[132:133] op_sel:[0,1,0] op_sel_hi:[1,1,1]
 v_pk_fma_f32 v[134:135], v[194:195], v[12:13], v[134:135] op_sel:[0,1,0] op_sel_hi:[1,1,1]
 v_pk_mul_f32 v[132:133], v[132:133], v[12:13] op_sel:[0,0] op_sel_hi:[1,0]
 v_pk_mul_f32 v[134:135], v[134:135], v[12:13] op_sel:[0,0] op_sel_hi:[1,0]
pk 130,132,133
pk 131,134,135
 v_pk_max_i16 v130, v130, 0
 v_pk_max_i16 v131, v131, 0
 s_lshl_b32 s52, s25, 6
 v_add_u32 v196, s52, v26
rq 192,196,0
 v_permlane16_swap_b32 v128, v130
 v_permlane16_swap_b32 v129, v131
 buffer_store_dwordx4 v[128:131], v14, s[16:19], s54 offen offset:0 sc1
tr 208,53,30720
tr 210,53,31232
wl 15
mg 104,v,216,a,56,104
mg 108,v,216,a,120,108
 s_lshl_b32 s54, s24, 9
 s_and_b32 s54, s54, 512
 s_add_u32 s54, s54, s53
wl 5
 v_pk_fma_f32 v[160:161], v[200:201], v[10:11], v[160:161] op_sel:[0,1,0] op_sel_hi:[1,1,1]
 v_pk_fma_f32 v[162:163], v[202:203], v[10:11], v[162:163] op_sel:[0,1,0] op_sel_hi:[1,1,1]
 v_pk_mul_f32 v[160:161], v[160:161], v[10:11] op_sel:[0,0] op_sel_hi:[1,0]
 v_pk_mul_f32 v[162:163], v[162:163], v[10:11] op_sel:[0,0] op_sel_hi:[1,0]
pk 160,160,161
pk 161,162,163
 v_pk_max_i16 v160, v160, 0
 v_pk_max_i16 v161, v161, 0
 v_pk_fma_f32 v[164:165], v[200:201], v[12:13], v[164:165] op_sel:[0,1,0] op_sel_hi:[1,1,1]
 v_pk_fma_f32 v[166:167], v[202:203], v[12:13], v[166:167] op_sel:[0,1,0] op_sel_hi:[1,1,1]
 v_pk_mul_f32 v[164:165], v[164:165], v[12:13] op_sel:[0,0] op_sel_hi:[1,0]
 v_pk_mul_f32 v[166:167], v[166:167], v[12:13] op_sel:[0,0] op_sel_hi:[1,0]
pk 162,164,165
pk 163,166,167
 v_pk_max_i16 v162, v162, 0
 v_pk_max_i16 v163, v163, 0
 s_lshl_b32 s52, s26, 6
 v_add_u32 v204, s52, v26
rq 200,204,0
 v_permlane16_swap_b32 v160, v162
 v_permlane16_swap_b32 v161, v163
 buffer_store_dwordx4 v[160:163], v14, s[16:19], s54 offen offset:0 sc1
tr 212,53,43008
tr 214,53,43520
mg 104,v,220,a,60,104
mg 108,v,220,a,124,108
 s_lshl_b32 s54, s25, 9
 s_add_u32 s54, s54, s48
wl 5
 v_pk_fma_f32 v[72:73], v[192:193], v[10:11], v[72:73] op_sel:[0,1,0] op_sel_hi:[1,1,1]
 v_pk_fma_f32 v[74:75], v[194:195], v[10:11], v[74:75] op_sel:[0,1,0] op_sel_hi:[1,1,1]
 v_pk_mul_f32 v[72:73], v[72:73], v[10:11] op_sel:[0,0] op_sel_hi:[1,0]
 v_pk_mul_f32 v[74:75], v[74:75], v[10:11] op_sel:[0,0] op_sel_hi:[1,0]
pk 72,72,73
pk 73,74,75
 v_pk_max_i16 v72, v72, 0
 v_pk_max_i16 v73, v73, 0
 v_pk_fma_f32 v[76:77], v[192:193], v[12:13], v[76:77] op_sel:[0,1,0] op_sel_hi:[1,1,1]
 v_pk_fma_f32 v[78:79], v[194:195], v[12:13], v[78:79] op_sel:[0,1,0] op_sel_hi:[1,1,1]
 v_pk_mul_f32 v[76:77], v[76:77], v[12:13] op_sel:[0,0] op_sel_hi:[1,0]
 v_pk_mul_f32 v[78:79], v[78:79], v[12:13] op_sel:[0,0] op_sel_hi:[1,0]
pk 74,76,77
pk 75,78,79
 v_pk_max_i16 v74, v74, 0
 v_pk_max_i16 v75, v75, 0
 s_lshl_b32 s52, s27, 6
 v_add_u32 v196, s52, v26
rq 192,196,0
 v_permlane16_swap_b32 v72, v74
 v_permlane16_swap_b32 v73, v75
 buffer_store_dwordx4 v[72:75], v14, s[16:19], s54 offen offset:0 sc1
tr 216,54,30720
tr 218,54,31232
wl 15
mg 112,v,224,a,56,112
mg 116,v,224,a,120,116
 s_lshl_b32 s54, s26, 9
 s_add_u32 s54, s54, s48
wl 5
 v_pk_fma_f32 v[80:81], v[200:201], v[10:11], v[80:81] op_sel:[0,1,0] op_sel_hi:[1,1,1]
 v_pk_fma_f32 v[82:83], v[202:203], v[10:11], v[82:83] op_sel:[0,1,0] op_sel_hi:[1,1,1]
 v_pk_mul_f32 v[80:81], v[80:81], v[10:11] op_sel:[0,0] op_sel_hi:[1,0]
 v_pk_mul_f32 v[82:83], v[82:83], v[10:11] op_sel:[0,0] op_sel_hi:[1,0]
pk 80,80,81
pk 81,82,83
 v_pk_max_i16 v80, v80, 0
 v_pk_max_i16 v81, v81, 0
 v_pk_fma_f32 v[84:85], v[200:201], v[12:13], v[84:85] op_sel:[0,1,0] op_sel_hi:[1,1,1]
 v_pk_fma_f32 v[86:87], v[202:203], v[12:13], v[86:87] op_sel:[0,1,0] op_sel_hi:[1,1,1]
 v_pk_mul_f32 v[84:85], v[84:85], v[12:13] op_sel:[0,0] op_sel_hi:[1,0]
 v_pk_mul_f32 v[86:87], v[86:87], v[12:13] op_sel:[0,0] op_sel_hi:[1,0]
pk 82,84,85
pk 83,86,87
 v_pk_max_i16 v82, v82, 0
 v_pk_max_i16 v83, v83, 0
 s_lshl_b32 s52, s25, 6
 v_add_u32 v204, s52, v26
rq 200,204,256
 v_permlane16_swap_b32 v80, v82
 v_permlane16_swap_b32 v81, v83
 buffer_store_dwordx4 v[80:83], v14, s[16:19], s54 offen offset:0 sc1
tr 220,54,43008
tr 222,54,43520
mg 112,v,228,a,60,112
mg 116,v,228,a,124,116
 s_lshl_b32 s54, s27, 9
 s_add_u32 s54, s54, s48
wl 5
 v_pk_fma_f32 v[88:89], v[192:193], v[10:11], v[88:89] op_sel:[0,1,0] op_sel_hi:[1,1,1]
 v_pk_fma_f32 v[90:91], v[194:195], v[10:11], v[90:91] op_sel:[0,1,0] op_sel_hi:[1,1,1]
 v_pk_mul_f32 v[88:89], v[88:89], v[10:11] op_sel:[0,0] op_sel_hi:[1,0]
 v_pk_mul_f32 v[90:91], v[90:91], v[10:11] op_sel:[0,0] op_sel_hi:[1,0]
pk 88,88,89
pk 89,90,91
 v_pk_max_i16 v88, v88, 0
 v_pk_max_i16 v89, v89, 0
 v_pk_fma_f32 v[92:93], v[192:193], v[12:13], v[92:93] op_sel:[0,1,0] op_sel_hi:[1,1,1]
 v_pk_fma_f32 v[94:95], v[194:195], v[12:13], v[94:95] op_sel:[0,1,0] op_sel_hi:[1,1,1]
 v_pk_mul_f32 v[92:93], v[92:93], v[12:13] op_sel:[0,0] op_sel_hi:[1,0]
 v_pk_mul_f32 v[94:95], v[94:95], v[12:13] op_sel:[0,0] op_sel_hi:[1,0]
pk 90,92,93
pk 91,94,95
 v_pk_max_i16 v90, v90, 0
 v_pk_max_i16 v91, v91, 0
 s_lshl_b32 s52, s26, 6
 v_add_u32 v196, s52, v26
rq 192,196,256
 v_permlane16_swap_b32 v88, v90
 v_permlane16_swap_b32 v89, v91
 buffer_store_dwordx4 v[88:91], v14, s[16:19], s54 offen offset:0 sc1
tr 224,55,30720
tr 226,55,31232
wl 15
mg 120,v,232,a,56,120
mg 124,v,232,a,120,124
 s_lshl_b32 s54, s25, 9
 s_add_u32 s54, s54, s48
wl 5
 v_pk_fma_f32 v[104:105], v[200:201], v[10:11], v[104:105] op_sel:[0,1,0] op_sel_hi:[1,1,1]
 v_pk_fma_f32 v[106:107], v[202:203], v[10:11], v[106:107] op_sel:[0,1,0] op_sel_hi:[1,1,1]
 v_pk_mul_f32 v[104:105], v[104:105], v[10:11] op_sel:[0,0] op_sel_hi:[1,0]
 v_pk_mul_f32 v[106:107], v[106:107], v[10:11] op_sel:[0,0] op_sel_hi:[1,0]
pk 104,104,105
pk 105,106,107
 v_pk_max_i16 v104, v104, 0
 v_pk_max_i16 v105, v105, 0
 v_pk_fma_f32 v[108:109], v[200:201], v[12:13], v[108:109] op_sel:[0,1,0] op_sel_hi:[1,1,1]
 v_pk_fma_f32 v[110:111], v[202:203], v[12:13], v[110:111] op_sel:[0,1,0] op_sel_hi:[1,1,1]
 v_pk_mul_f32 v[108:109], v[108:109], v[12:13] op_sel:[0,0] op_sel_hi:[1,0]
 v_pk_mul_f32 v[110:111], v[110:111], v[12:13] op_sel:[0,0] op_sel_hi:[1,0]
pk 106,108,109
pk 107,110,111
 v_pk_max_i16 v106, v106, 0
 v_pk_max_i16 v107, v107, 0
 s_lshl_b32 s52, s27, 6
 v_add_u32 v204, s52, v26
rq 200,204,256
 v_permlane16_swap_b32 v104, v106
 v_permlane16_swap_b32 v105, v107
 buffer_store_dwordx4 v[104:107], v14, s[16:19], s54 offen offset:2048 sc1
tr 228,55,43008
tr 230,55,43520
mg 120,v,236,a,60,120
mg 124,v,236,a,124,124
 s_lshl_b32 s54, s26, 9
 s_add_u32 s54, s54, s48
wl 5
 v_pk_fma_f32 v[112:113], v[192:193], v[10:11], v[112:113] op_sel:[0,1,0] op_sel_hi:[1,1,1]
 v_pk_fma_f32 v[114:115], v[194:195], v[10:11], v[114:115] op_sel:[0,1,0] op_sel_hi:[1,1,1]
 v_pk_mul_f32 v[112:113], v[112:113], v[10:11] op_sel:[0,0] op_sel_hi:[1,0]
 v_pk_mul_f32 v[114:115], v[114:115], v[10:11] op_sel:[0,0] op_sel_hi:[1,0]
pk 112,112,113
pk 113,114,115
 v_pk_max_i16 v112, v112, 0
 v_pk_max_i16 v113, v113, 0
 v_pk_fma_f32 v[116:117], v[192:193], v[12:13], v[116:117] op_sel:[0,1,0] op_sel_hi:[1,1,1]
 v_pk_fma_f32 v[118:119], v[194:195], v[12:13], v[118:119] op_sel:[0,1,0] op_sel_hi:[1,1,1]
 v_pk_mul_f32 v[116:117], v[116:117], v[12:13] op_sel:[0,0] op_sel_hi:[1,0]
 v_pk_mul_f32 v[118:119], v[118:119], v[12:13] op_sel:[0,0] op_sel_hi:[1,0]
pk 114,116,117
pk 115,118,119
 v_pk_max_i16 v114, v114, 0
 v_pk_max_i16 v115, v115, 0
 s_lshl_b32 s52, s25, 6
 v_add_u32 v196, s52, v26
rq 192,196,512
 v_permlane16_swap_b32 v112, v114
 v_permlane16_swap_b32 v113, v115
 buffer_store_dwordx4 v[112:115], v14, s[16:19], s54 offen offset:2048 sc1
tr 232,61,53248
tr 234,61,53504
wl 15
mg 136,v,208,a,56,136
mg 140,v,208,a,120,140
tr 236,61,55296
tr 238,61,55552
mg 136,v,212,a,60,136
mg 140,v,212,a,124,140
 s_lshl_b32 s54, s27, 9
 s_add_u32 s54, s54, s48
wl 7
 v_pk_fma_f32 v[120:121], v[200:201], v[10:11], v[120:121] op_sel:[0,1,0] op_sel_hi:[1,1,1]
 v_pk_fma_f32 v[122:123], v[202:203], v[10:11], v[122:123] op_sel:[0,1,0] op_sel_hi:[1,1,1]
 v_pk_mul_f32 v[120:121], v[120:121], v[10:11] op_sel:[0,0] op_sel_hi:[1,0]
 v_pk_mul_f32 v[122:123], v[122:123], v[10:11] op_sel:[0,0] op_sel_hi:[1,0]
pk 120,120,121
pk 121,122,123
 v_pk_max_i16 v120, v120, 0
 v_pk_max_i16 v121, v121, 0
 v_pk_fma_f32 v[124:125], v[200:201], v[12:13], v[124:125] op_sel:[0,1,0] op_sel_hi:[1,1,1]
 v_pk_fma_f32 v[126:127], v[202:203], v[12:13], v[126:127] op_sel:[0,1,0] op_sel_hi:[1,1,1]
 v_pk_mul_f32 v[124:125], v[124:125], v[12:13] op_sel:[0,0] op_sel_hi:[1,0]
 v_pk_mul_f32 v[126:127], v[126:127], v[12:13] op_sel:[0,0] op_sel_hi:[1,0]
pk 122,124,125
pk 123,126,127
 v_pk_max_i16 v122, v122, 0
 v_pk_max_i16 v123, v123, 0
 s_lshl_b32 s52, s26, 6
 v_add_u32 v204, s52, v26
rq 200,204,512
 v_permlane16_swap_b32 v120, v122
 v_permlane16_swap_b32 v121, v123
 buffer_store_dwordx4 v[120:123], v14, s[16:19], s54 offen offset:2048 sc1
wl 12
mg 144,v,216,a,56,144
mg 148,v,216,a,120,148
mg 144,v,220,a,60,144
mg 148,v,220,a,124,148
 s_lshl_b32 s54, s25, 9
 s_add_u32 s54, s54, s48
 s_add_u32 s54, s54, 4096
wl 5
 v_pk_fma_f32 v[136:137], v[192:193], v[10:11], v[136:137] op_sel:[0,1,0] op_sel_hi:[1,1,1]
 v_pk_fma_f32 v[138:139], v[194:195], v[10:11], v[138:139] op_sel:[0,1,0] op_sel_hi:[1,1,1]
 v_pk_mul_f32 v[136:137], v[136:137], v[10:11] op_sel:[0,0] op_sel_hi:[1,0]
 v_pk_mul_f32 v[138:139], v[138:139], v[10:11] op_sel:[0,0] op_sel_hi:[1,0]
pk 136,136,137
pk 137,138,139
 v_pk_max_i16 v136, v136, 0
 v_pk_max_i16 v137, v137, 0
 v_pk_fma_f32 v[140:141], v[192:193], v[12:13], v[140:141] op_sel:[0,1,0] op_sel_hi:[1,1,1]
 v_pk_fma_f32 v[142:143], v[194:195], v[12:13], v[142:143] op_sel:[0,1,0] op_sel_hi:[1,1,1]
 v_pk_mul_f32 v[140:141], v[140:141], v[12:13] op_sel:[0,0] op_sel_hi:[1,0]
 v_pk_mul_f32 v[142:143], v[142:143], v[12:13] op_sel:[0,0] op_sel_hi:[1,0]
pk 138,140,141
pk 139,142,143
 v_pk_max_i16 v138, v138, 0
 v_pk_max_i16 v139, v139, 0
 s_lshl_b32 s52, s27, 6
 v_add_u32 v196, s52, v26
rq 192,196,512
 v_permlane16_swap_b32 v136, v138
 v_permlane16_swap_b32 v137, v139
 buffer_store_dwordx4 v[136:139], v14, s[16:19], s54 offen offset:0 sc1
wl 7
mg 152,v,224,a,56,152
mg 156,v,224,a,120,156
mg 152,v,228,a,60,152
mg 156,v,228,a,124,156
 s_lshl_b32 s54, s26, 9
 s_add_u32 s54, s54, s48
 s_add_u32 s54, s54, 4096
wl 1
 v_pk_fma_f32 v[144:145], v[200:201], v[10:11], v[144:145] op_sel:[0,1,0] op_sel_hi:[1,1,1]
 v_pk_fma_f32 v[146:147], v[202:203], v[10:11], v[146:147] op_sel:[0,1,0] op_sel_hi:[1,1,1]
 v_pk_mul_f32 v[144:145], v[144:145], v[10:11] op_sel:[0,0] op_sel_hi:[1,0]
 v_pk_mul_f32 v[146:147], v[146:147], v[10:11] op_sel:[0,0] op_sel_hi:[1,0]
pk 144,144,145
pk 145,146,147
 v_pk_max_i16 v144, v144, 0
 v_pk_max_i16 v145, v145, 0
 v_pk_fma_f32 v[148:149], v[200:201], v[12:13], v[148:149] op_sel:[0,1,0] op_sel_hi:[1,1,1]
 v_pk_fma_f32 v[150:151], v[202:203], v[12:13], v[150:151] op_sel:[0,1,0] op_sel_hi:[1,1,1]
 v_pk_mul_f32 v[148:149], v[148:149], v[12:13] op_sel:[0,0] op_sel_hi:[1,0]
 v_pk_mul_f32 v[150:151], v[150:151], v[12:13] op_sel:[0,0] op_sel_hi:[1,0]
pk 146,148,149
pk 147,150,151
 v_pk_max_i16 v146, v146, 0
 v_pk_max_i16 v147, v147, 0
 s_lshl_b32 s52, s25, 6
 s_and_b32 s52, s52, 64
 v_add_u32 v204, s52, v26
rq 200,204,768
 v_permlane16_swap_b32 v144, v146
 v_permlane16_swap_b32 v145, v147
 buffer_store_dwordx4 v[144:147], v14, s[16:19], s54 offen offset:0 sc1
wl 3
mg 168,v,232,a,56,168
mg 172,v,232,a,120,172
mg 168,v,236,a,60,168
mg 172,v,236,a,124,172
 s_lshl_b32 s54, s27, 9
 s_add_u32 s54, s54, s48
 s_add_u32 s54, s54, 4096
wl 1
 v_pk_fma_f32 v[152:153], v[192:193], v[10:11], v[152:153] op_sel:[0,1,0] op_sel_hi:[1,1,1]
 v_pk_fma_f32 v[154:155], v[194:195], v[10:11], v[154:155] op_sel:[0,1,0] op_sel_hi:[1,1,1]
 v_pk_mul_f32 v[152:153], v[152:153], v[10:11] op_sel:[0,0] op_sel_hi:[1,0]
 v_pk_mul_f32 v[154:155], v[154:155], v[10:11] op_sel:[0,0] op_sel_hi:[1,0]
pk 152,152,153
pk 153,154,155
 v_pk_max_i16 v152, v152, 0
 v_pk_max_i16 v153, v153, 0
 v_pk_fma_f32 v[156:157], v[192:193], v[12:13], v[156:157] op_sel:[0,1,0] op_sel_hi:[1,1,1]
 v_pk_fma_f32 v[158:159], v[194:195], v[12:13], v[158:159] op_sel:[0,1,0] op_sel_hi:[1,1,1]
 v_pk_mul_f32 v[156:157], v[156:157], v[12:13] op_sel:[0,0] op_sel_hi:[1,0]
 v_pk_mul_f32 v[158:159], v[158:159], v[12:13] op_sel:[0,0] op_sel_hi:[1,0]
pk 154,156,157
pk 155,158,159
 v_pk_max_i16 v154, v154, 0
 v_pk_max_i16 v155, v155, 0
 s_nop 1
 v_permlane16_swap_b32 v152, v154
 v_permlane16_swap_b32 v153, v155
 buffer_store_dwordx4 v[152:155], v14, s[16:19], s54 offen offset:0 sc1
 s_nop 7
 s_lshl_b32 s54, s25, 9
 s_and_b32 s54, s54, 512
 s_add_u32 s54, s54, s53
wl 0
 v_pk_fma_f32 v[168:169], v[200:201], v[10:11], v[168:169] op_sel:[0,1,0] op_sel_hi:[1,1,1]
 v_pk_fma_f32 v[170:171], v[202:203], v[10:11], v[170:171] op_sel:[0,1,0] op_sel_hi:[1,1,1]
 v_pk_mul_f32 v[168:169], v[168:169], v[10:11] op_sel:[0,0] op_sel_hi:[1,0]
 v_pk_mul_f32 v[170:171], v[170:171], v[10:11] op_sel:[0,0] op_sel_hi:[1,0]
pk 168,168,169
pk 169,170,171
 v_pk_max_i16 v168, v168, 0
 v_pk_max_i16 v169, v169, 0
 v_pk_fma_f32 v[172:173], v[200:201], v[12:13], v[172:173] op_sel:[0,1,0] op_sel_hi:[1,1,1]
 v_pk_fma_f32 v[174:175], v[202:203], v[12:13], v[174:175] op_sel:[0,1,0] op_sel_hi:[1,1,1]
 v_pk_mul_f32 v[172:173], v[172:173], v[12:13] op_sel:[0,0] op_sel_hi:[1,0]
 v_pk_mul_f32 v[174:175], v[174:175], v[12:13] op_sel:[0,0] op_sel_hi:[1,0]
pk 170,172,173
pk 171,174,175
 v_pk_max_i16 v170, v170, 0
 v_pk_max_i16 v171, v171, 0
 s_nop 1
 v_permlane16_swap_b32 v168, v170
 v_permlane16_swap_b32 v169, v171
 buffer_store_dwordx4 v[168:171], v14, s[16:19], s54 offen offset:0 sc1
 s_endpgm
.globl k2_kernel
.p2align 8
.type k2_kernel,@function
k2_kernel:
 s_cmp_ge_u32 s2, 256
 s_cbranch_scc1 K2_exit
 s_load_dwordx2 s[40:41], s[0:1], 64
 s_load_dwordx2 s[28:29], s[0:1], 0
 s_load_dwordx2 s[24:25], s[0:1], 48
 v_lshrrev_b32 v1, 6, v0
 s_nop 0
 v_readfirstlane_b32 s3, v1
 v_and_b32 v1, 63, v0
wl 0
 s_mov_b32 s16, s40
 s_and_b32 s17, s41, 0xffff
 s_mov_b32 s18, 25165824
 s_mov_b32 s19, 0x00020000
 s_mov_b32 s8, s28
 s_and_b32 s9, s29, 0xffff
 s_mov_b32 s10, 2097152
 s_mov_b32 s11, 0x00020000
 s_mov_b32 s12, s24
 s_and_b32 s13, s25, 0xffff
 s_mov_b32 s14, 2097152
 s_mov_b32 s15, 0x00020000
 s_cmp_ge_u32 s3, 8
 s_cbranch_scc1 K2_ffn
 v_and_b32 v2, 31, v1
 v_lshrrev_b32 v3, 5, v1
 s_and_b32 s42, s2, 7
 s_lshr_b32 s43, s2, 3
 s_and_b32 s43, s43, 3
 s_lshl_b32 s43, s43, 3
 s_add_u32 s42, s42, s43
 s_lshl_b32 s44, s42, 16
 s_lshr_b32 s43, s2, 5
 s_lshl_b32 s43, s43, 8
 s_lshl_b32 s45, s3, 5
 s_add_u32 s43, s43, s45
 v_lshlrev_b32 v108, 5, v2
 v_lshl_add_u32 v108, v3, 4, v108
 s_lshl_b32 s45, s43, 5
 s_add_u32 s45, s45, s44
 buffer_load_dwordx4 v[4:7], v108, s[16:19], s45 offen
 s_lshl_b32 s45, s3, 10
 s_add_u32 s46, s45, s44
 s_add_u32 s47, s46, 4194304
 s_add_u32 s46, s46, 2097152
 v_lshlrev_b32 v109, 4, v1
 s_mul_i32 s48, s3, 1040
 s_add_u32 s48, s48, 65536
 s_mov_b32 s49, s45
 s_add_u32 m0, s49, 0
 s_nop 0
 buffer_load_dwordx4 v108, s[16:19], s46 offen lds
 s_add_u32 s46, s46, 8192
 s_add_u32 m0, s48, 0
 s_nop 0
 buffer_load_dwordx4 v109, s[16:19], s47 offen lds
 s_add_u32 s47, s47, 8192
 s_movk_i32 s45, 1040
 v_mul_lo_u32 v110, v1, s45
 v_add_u32 v110, 66560, v110
 v_mov_b32 v112, 0x3f803f80
 v_mov_b32 v113, 0x3f803f80
 v_mov_b32 v114, 0x3f803f80
 v_mov_b32 v115, 0x3f803f80
 ds_write_b128 v110, v[112:115]
 v_lshlrev_b32 v110, 4, v2
 v_lshl_add_u32 v110, v3, 8, v110
 v_add_u32 v114, 512, v110
 v_cmp_gt_u32 vcc, 16, v2
 v_mov_b32 v115, 1024
 v_cndmask_b32 v110, v115, v110, vcc
 v_cndmask_b32 v114, v115, v114, vcc
 v_add_u32 v110, 65536, v110
 v_add_u32 v114, 65536, v114
 v_mov_b32 v115, 148484
 v_mov_b32 v116, 1
 v_mov_b32 v112, 0xff800000
 v_mov_b32 v113, 0xff800000
 s_waitcnt vmcnt(0) lgkmcnt(0)
 s_barrier
rq 8,109,0
rq 12,109,1024
rq 16,109,2048
wl 2
 v_mfma_f32_32x32x16_bf16 v[36:51], v[8:11], v[4:7], 0
rq 8,109,3072
wl 2
 v_mfma_f32_32x32x16_bf16 v[52:67], v[12:15], v[4:7], 0
wl 1
 v_mfma_f32_32x32x16_bf16 v[68:83], v[16:19], v[4:7], 0
 v_max3_f32 v112, v36, v37, v112
 v_max3_f32 v113, v38, v39, v113
 v_max3_f32 v112, v40, v41, v112
 v_max3_f32 v113, v42, v43, v113
 v_max3_f32 v112, v44, v45, v112
 v_max3_f32 v113, v46, v47, v113
 v_max3_f32 v112, v48, v49, v112
 v_max3_f32 v113, v50, v51, v113
wl 0
 v_mfma_f32_32x32x16_bf16 v[36:51], v[8:11], v[4:7], 0
 v_max3_f32 v112, v52, v53, v112
 v_max3_f32 v113, v54, v55, v113
 v_max3_f32 v112, v56, v57, v112
 v_max3_f32 v113, v58, v59, v113
 v_max3_f32 v112, v60, v61, v112
 v_max3_f32 v113, v62, v63, v113
 v_max3_f32 v112, v64, v65, v112
 v_max3_f32 v113, v66, v67, v113
 s_nop 3
 v_max3_f32 v112, v68, v69, v112
 v_max3_f32 v113, v70, v71, v113
 v_max3_f32 v112, v72, v73, v112
 v_max3_f32 v113, v74, v75, v113
 v_max3_f32 v112, v76, v77, v112
 v_max3_f32 v113, v78, v79, v113
 v_max3_f32 v112, v80, v81, v112
 v_max3_f32 v113, v82, v83, v113
 s_nop 7
 v_max3_f32 v112, v36, v37, v112
 v_max3_f32 v113, v38, v39, v113
 v_max3_f32 v112, v40, v41, v112
 v_max3_f32 v113, v42, v43, v113
 v_max3_f32 v112, v44, v45, v112
 v_max3_f32 v113, v46, v47, v113
 v_max3_f32 v112, v48, v49, v112
 v_max3_f32 v113, v50, v51, v113
 s_mov_b32 s58, 0
 v_mov_b32 v111, 0xc2800000
K2_setmax:
 v_max_f32 v112, v112, v113
 v_mov_b32 v113, v112
 s_nop 1
 v_permlane32_swap_b32 v112, v113
 s_nop 1
 v_max_f32 v112, v112, v113
 v_sub_f32 v112, v111, v112
 v_mov_b32 v68, v112
 v_mov_b32 v69, v112
 v_mov_b32 v70, v112
 v_mov_b32 v71, v112
 v_mov_b32 v72, v112
 v_mov_b32 v73, v112
 v_mov_b32 v74, v112
 v_mov_b32 v75, v112
 v_mov_b32 v76, v112
 v_mov_b32 v77, v112
 v_mov_b32 v78, v112
 v_mov_b32 v79, v112
 v_mov_b32 v80, v112
 v_mov_b32 v81, v112
 v_mov_b32 v82, v112
 v_mov_b32 v83, v112
 s_cmp_ge_u32 s3, 4
 s_cselect_b64 vcc, -1, 0
 s_setprio 2
rq 8,109,0
rq 12,109,1024
rq 20,110,0
rq 24,114,0
wl 3
mw 36,8,4,68
 s_nop 7
 s_nop 3
 s_cbranch_vccnz K2_pr0
 s_setprio 3
K2_pr0:
rq 16,109,2048
rq 28,110,1040
rq 32,114,1040
wl 5
mw 52,12,4,68
ex 36,36
ex 37,37
ex 38,38
ex 39,39
pk 84,36,37
ex 40,40
ex 41,41
pk 85,38,39
ex 42,42
ex 43,43
pk 86,40,41
wl 3
pk 87,42,43
 s_nop 1
 v_mfma_f32_32x32x16_bf16 v[92:107], v[20:23], v[84:87], 0
ex 44,44
ex 45,45
ex 46,46
ex 47,47
pk 88,44,45
ex 48,48
ex 49,49
pk 89,46,47
ex 50,50
ex 51,51
pk 90,48,49
 s_nop 0
pk 91,50,51
 s_nop 1
mw 92,24,88,92
rq 8,109,3072
rq 20,110,2080
rq 24,114,2080
wl 5
mw 36,16,4,68
ex 52,52
ex 53,53
ex 54,54
ex 55,55
pk 84,52,53
ex 56,56
ex 57,57
pk 85,54,55
ex 58,58
ex 59,59
pk 86,56,57
wl 3
pk 87,58,59
 s_nop 1
mw 92,28,84,92
ex 60,60
ex 61,61
ex 62,62
ex 63,63
pk 88,60,61
ex 64,64
ex 65,65
pk 89,62,63
ex 66,66
ex 67,67
pk 90,64,65
 s_nop 0
pk 91,66,67
 s_nop 1
mw 92,32,88,92
 s_cbranch_vccnz K2_pr2
 s_setprio 1
K2_pr2:
rq 12,109,4096
rq 28,110,3120
rq 32,114,3120
wl 5
mw 52,8,4,68
ex 36,36
ex 37,37
ex 38,38
ex 39,39
pk 84,36,37
ex 40,40
ex 41,41
pk 85,38,39
ex 42,42
ex 43,43
pk 86,40,41
wl 3
pk 87,42,43
 s_nop 1
mw 92,20,84,92
ex 44,44
ex 45,45
ex 46,46
ex 47,47
pk 88,44,45
ex 48,48
ex 49,49
pk 89,46,47
ex 50,50
ex 51,51
pk 90,48,49
 s_nop 0
pk 91,50,51
 s_nop 1
mw 92,24,88,92
 s_cbranch_vccnz K2_pr3
 s_setprio 3
K2_pr3:
rq 16,109,5120
rq 20,110,4160
rq 24,114,4160
wl 5
mw 36,12,4,68
ex 52,52
ex 53,53
ex 54,54
ex 55,55
pk 84,52,53
ex 56,56
ex 57,57
pk 85,54,55
ex 58,58
ex 59,59
pk 86,56,57
wl 3
pk 87,58,59
 s_nop 1
mw 92,28,84,92
ex 60,60
ex 61,61
ex 62,62
ex 63,63
pk 88,60,61
ex 64,64
ex 65,65
pk 89,62,63
ex 66,66
ex 67,67
pk 90,64,65
 s_nop 0
pk 91,66,67
 s_nop 1
mw 92,32,88,92
rq 8,109,6144
rq 28,110,5200
rq 32,114,5200
wl 5
mw 52,16,4,68
ex 36,36
ex 37,37
ex 38,38
ex 39,39
pk 84,36,37
ex 40,40
ex 41,41
pk 85,38,39
ex 42,42
ex 43,43
pk 86,40,41
wl 3
pk 87,42,43
 s_nop 1
mw 92,20,84,92
ex 44,44
ex 45,45
ex 46,46
ex 47,47
pk 88,44,45
ex 48,48
ex 49,49
pk 89,46,47
ex 50,50
ex 51,51
pk 90,48,49
 s_nop 0
pk 91,50,51
 s_nop 1
mw 92,24,88,92
 s_cbranch_vccnz K2_pr5
 s_setprio 1
K2_pr5:
rq 12,109,7168
rq 20,110,6240
rq 24,114,6240
wl 5
mw 36,8,4,68
ex 52,52
ex 53,53
ex 54,54
ex 55,55
pk 84,52,53
ex 56,56
ex 57,57
pk 85,54,55
ex 58,58
ex 59,59
pk 86,56,57
wl 3
pk 87,58,59
 s_nop 1
mw 92,28,84,92
ex 60,60
ex 61,61
ex 62,62
ex 63,63
pk 88,60,61
ex 64,64
ex 65,65
pk 89,62,63
ex 66,66
ex 67,67
pk 90,64,65
 s_nop 0
pk 91,66,67
 s_nop 1
mw 92,32,88,92
 s_cbranch_vccnz K2_pr6
 s_setprio 3
K2_pr6:
K2_poll6:
 ds_read_b32 v117, v115
wl 0
 v_readfirstlane_b32 s59, v117
 s_cmp_lt_u32 s59, 4
 s_cbranch_scc1 K2_poll6
rq 16,109,8192
rq 28,110,7280
rq 32,114,7280
wl 5
mw 52,12,4,68
ex 36,36
ex 37,37
ex 38,38
ex 39,39
pk 84,36,37
ex 40,40
ex 41,41
pk 85,38,39
ex 42,42
ex 43,43
pk 86,40,41
wl 3
pk 87,42,43
 s_nop 1
mw 92,20,84,92
ex 44,44
ex 45,45
ex 46,46
ex 47,47
pk 88,44,45
ex 48,48
ex 49,49
pk 89,46,47
ex 50,50
ex 51,51
pk 90,48,49
 s_nop 0
pk 91,50,51
 s_nop 1
mw 92,24,88,92
rq 8,109,9216
rq 20,110,8320
rq 24,114,8320
wl 5
mw 36,16,4,68
ex 52,52
ex 53,53
ex 54,54
ex 55,55
pk 84,52,53
ex 56,56
ex 57,57
pk 85,54,55
ex 58,58
ex 59,59
pk 86,56,57
wl 3
pk 87,58,59
 s_nop 1
mw 92,28,84,92
ex 60,60
ex 61,61
ex 62,62
ex 63,63
pk 88,60,61
ex 64,64
ex 65,65
pk 89,62,63
ex 66,66
ex 67,67
pk 90,64,65
 s_nop 0
pk 91,66,67
 s_nop 1
mw 92,32,88,92
 s_cbranch_vccnz K2_pr8
 s_setprio 1
K2_pr8:
rq 12,109,10240
rq 28,110,9360
rq 32,114,9360
wl 5
mw 52,8,4,68
ex 36,36
ex 37,37
ex 38,38
ex 39,39
pk 84,36,37
ex 40,40
ex 41,41
pk 85,38,39
ex 42,42
ex 43,43
pk 86,40,41
wl 3
pk 87,42,43
 s_nop 1
mw 92,20,84,92
ex 44,44
ex 45,45
ex 46,46
ex 47,47
pk 88,44,45
ex 48,48
ex 49,49
pk 89,46,47
ex 50,50
ex 51,51
pk 90,48,49
 s_nop 0
pk 91,50,51
 s_nop 1
mw 92,24,88,92
 s_cbranch_vccnz K2_pr9
 s_setprio 3
K2_pr9:
rq 16,109,11264
rq 20,110,10400
rq 24,114,10400
wl 5
mw 36,12,4,68
ex 52,52
ex 53,53
ex 54,54
ex 55,55
pk 84,52,53
ex 56,56
ex 57,57
pk 85,54,55
ex 58,58
ex 59,59
pk 86,56,57
wl 3
pk 87,58,59
 s_nop 1
mw 92,28,84,92
ex 60,60
ex 61,61
ex 62,62
ex 63,63
pk 88,60,61
ex 64,64
ex 65,65
pk 89,62,63
ex 66,66
ex 67,67
pk 90,64,65
 s_nop 0
pk 91,66,67
 s_nop 1
mw 92,32,88,92
rq 8,109,12288
rq 28,110,11440
rq 32,114,11440
wl 5
mw 52,16,4,68
ex 36,36
ex 37,37
ex 38,38
ex 39,39
pk 84,36,37
ex 40,40
ex 41,41
pk 85,38,39
ex 42,42
ex 43,43
pk 86,40,41
wl 3
pk 87,42,43
 s_nop 1
mw 92,20,84,92
ex 44,44
ex 45,45
ex 46,46
ex 47,47
pk 88,44,45
ex 48,48
ex 49,49
pk 89,46,47
ex 50,50
ex 51,51
pk 90,48,49
 s_nop 0
pk 91,50,51
 s_nop 1
mw 92,24,88,92
 s_cbranch_vccnz K2_pr11
 s_setprio 1
K2_pr11:
rq 12,109,13312
rq 20,110,12480
rq 24,114,12480
wl 5
mw 36,8,4,68
ex 52,52
ex 53,53
ex 54,54
ex 55,55
pk 84,52,53
ex 56,56
ex 57,57
pk 85,54,55
ex 58,58
ex 59,59
pk 86,56,57
wl 3
pk 87,58,59
 s_nop 1
mw 92,28,84,92
ex 60,60
ex 61,61
ex 62,62
ex 63,63
pk 88,60,61
ex 64,64
ex 65,65
pk 89,62,63
ex 66,66
ex 67,67
pk 90,64,65
 s_nop 0
pk 91,66,67
 s_nop 1
mw 92,32,88,92
 s_cbranch_vccnz K2_pr12
 s_setprio 3
K2_pr12:
rq 16,109,14336
rq 28,110,13520
rq 32,114,13520
wl 5
mw 52,12,4,68
ex 36,36
ex 37,37
ex 38,38
ex 39,39
pk 84,36,37
ex 40,40
ex 41,41
pk 85,38,39
ex 42,42
ex 43,43
pk 86,40,41
wl 3
pk 87,42,43
 s_nop 1
mw 92,20,84,92
ex 44,44
ex 45,45
ex 46,46
ex 47,47
pk 88,44,45
ex 48,48
ex 49,49
pk 89,46,47
ex 50,50
ex 51,51
pk 90,48,49
 s_nop 0
pk 91,50,51
 s_nop 1
mw 92,24,88,92
rq 8,109,15360
rq 20,110,14560
rq 24,114,14560
wl 5
mw 36,16,4,68
ex 52,52
ex 53,53
ex 54,54
ex 55,55
pk 84,52,53
ex 56,56
ex 57,57
pk 85,54,55
ex 58,58
ex 59,59
pk 86,56,57
wl 3
pk 87,58,59
 s_nop 1
mw 92,28,84,92
ex 60,60
ex 61,61
ex 62,62
ex 63,63
pk 88,60,61
ex 64,64
ex 65,65
pk 89,62,63
ex 66,66
ex 67,67
pk 90,64,65
 s_nop 0
pk 91,66,67
 s_nop 1
mw 92,32,88,92
 s_cbranch_vccnz K2_pr14
 s_setprio 1
K2_pr14:
rq 12,109,16384
rq 28,110,15600
rq 32,114,15600
wl 5
mw 52,8,4,68
ex 36,36
ex 37,37
ex 38,38
ex 39,39
pk 84,36,37
ex 40,40
ex 41,41
pk 85,38,39
ex 42,42
ex 43,43
pk 86,40,41
wl 3
pk 87,42,43
 s_nop 1
mw 92,20,84,92
ex 44,44
ex 45,45
ex 46,46
ex 47,47
pk 88,44,45
ex 48,48
ex 49,49
pk 89,46,47
ex 50,50
ex 51,51
pk 90,48,49
 s_nop 0
pk 91,50,51
 s_nop 1
mw 92,24,88,92
 s_cbranch_vccnz K2_pr15
 s_setprio 3
K2_pr15:
rq 16,109,17408
rq 20,110,16640
rq 24,114,16640
wl 5
mw 36,12,4,68
ex 52,52
ex 53,53
ex 54,54
ex 55,55
pk 84,52,53
ex 56,56
ex 57,57
pk 85,54,55
ex 58,58
ex 59,59
pk 86,56,57
wl 3
pk 87,58,59
 s_nop 1
mw 92,28,84,92
ex 60,60
ex 61,61
ex 62,62
ex 63,63
pk 88,60,61
ex 64,64
ex 65,65
pk 89,62,63
ex 66,66
ex 67,67
pk 90,64,65
 s_nop 0
pk 91,66,67
 s_nop 1
mw 92,32,88,92
rq 8,109,18432
rq 28,110,17680
rq 32,114,17680
wl 5
mw 52,16,4,68
ex 36,36
ex 37,37
ex 38,38
ex 39,39
pk 84,36,37
ex 40,40
ex 41,41
pk 85,38,39
ex 42,42
ex 43,43
pk 86,40,41
wl 3
pk 87,42,43
 s_nop 1
mw 92,20,84,92
ex 44,44
ex 45,45
ex 46,46
ex 47,47
pk 88,44,45
ex 48,48
ex 49,49
pk 89,46,47
ex 50,50
ex 51,51
pk 90,48,49
 s_nop 0
pk 91,50,51
 s_nop 1
mw 92,24,88,92
 s_cbranch_vccnz K2_pr17
 s_setprio 1
K2_pr17:
rq 12,109,19456
rq 20,110,18720
rq 24,114,18720
wl 5
mw 36,8,4,68
ex 52,52
ex 53,53
ex 54,54
ex 55,55
pk 84,52,53
ex 56,56
ex 57,57
pk 85,54,55
ex 58,58
ex 59,59
pk 86,56,57
wl 3
pk 87,58,59
 s_nop 1
mw 92,28,84,92
ex 60,60
ex 61,61
ex 62,62
ex 63,63
pk 88,60,61
ex 64,64
ex 65,65
pk 89,62,63
ex 66,66
ex 67,67
pk 90,64,65
 s_nop 0
pk 91,66,67
 s_nop 1
mw 92,32,88,92
 s_cbranch_vccnz K2_pr18
 s_setprio 3
K2_pr18:
rq 16,109,20480
rq 28,110,19760
rq 32,114,19760
wl 5
mw 52,12,4,68
ex 36,36
ex 37,37
ex 38,38
ex 39,39
pk 84,36,37
ex 40,40
ex 41,41
pk 85,38,39
ex 42,42
ex 43,43
pk 86,40,41
wl 3
pk 87,42,43
 s_nop 1
mw 92,20,84,92
ex 44,44
ex 45,45
ex 46,46
ex 47,47
pk 88,44,45
ex 48,48
ex 49,49
pk 89,46,47
ex 50,50
ex 51,51
pk 90,48,49
 s_nop 0
pk 91,50,51
 s_nop 1
mw 92,24,88,92
rq 8,109,21504
rq 20,110,20800
rq 24,114,20800
wl 5
mw 36,16,4,68
ex 52,52
ex 53,53
ex 54,54
ex 55,55
pk 84,52,53
ex 56,56
ex 57,57
pk 85,54,55
ex 58,58
ex 59,59
pk 86,56,57
wl 3
pk 87,58,59
 s_nop 1
mw 92,28,84,92
ex 60,60
ex 61,61
ex 62,62
ex 63,63
pk 88,60,61
ex 64,64
ex 65,65
pk 89,62,63
ex 66,66
ex 67,67
pk 90,64,65
 s_nop 0
pk 91,66,67
 s_nop 1
mw 92,32,88,92
 s_cbranch_vccnz K2_pr20
 s_setprio 1
K2_pr20:
rq 12,109,22528
rq 28,110,21840
rq 32,114,21840
wl 5
mw 52,8,4,68
ex 36,36
ex 37,37
ex 38,38
ex 39,39
pk 84,36,37
ex 40,40
ex 41,41
pk 85,38,39
ex 42,42
ex 43,43
pk 86,40,41
wl 3
pk 87,42,43
 s_nop 1
mw 92,20,84,92
ex 44,44
ex 45,45
ex 46,46
ex 47,47
pk 88,44,45
ex 48,48
ex 49,49
pk 89,46,47
ex 50,50
ex 51,51
pk 90,48,49
 s_nop 0
pk 91,50,51
 s_nop 1
mw 92,24,88,92
 s_cbranch_vccnz K2_pr21
 s_setprio 3
K2_pr21:
rq 16,109,23552
rq 20,110,22880
rq 24,114,22880
wl 5
mw 36,12,4,68
ex 52,52
ex 53,53
ex 54,54
ex 55,55
pk 84,52,53
ex 56,56
ex 57,57
pk 85,54,55
ex 58,58
ex 59,59
pk 86,56,57
wl 3
pk 87,58,59
 s_nop 1
mw 92,28,84,92
ex 60,60
ex 61,61
ex 62,62
ex 63,63
pk 88,60,61
ex 64,64
ex 65,65
pk 89,62,63
ex 66,66
ex 67,67
pk 90,64,65
 s_nop 0
pk 91,66,67
 s_nop 1
mw 92,32,88,92
rq 8,109,24576
rq 28,110,23920
rq 32,114,23920
wl 5
mw 52,16,4,68
ex 36,36
ex 37,37
ex 38,38
ex 39,39
pk 84,36,37
ex 40,40
ex 41,41
pk 85,38,39
ex 42,42
ex 43,43
pk 86,40,41
wl 3
pk 87,42,43
 s_nop 1
mw 92,20,84,92
ex 44,44
ex 45,45
ex 46,46
ex 47,47
pk 88,44,45
ex 48,48
ex 49,49
pk 89,46,47
ex 50,50
ex 51,51
pk 90,48,49
 s_nop 0
pk 91,50,51
 s_nop 1
mw 92,24,88,92
 s_cbranch_vccnz K2_pr23
 s_setprio 1
K2_pr23:
rq 12,109,25600
rq 20,110,24960
rq 24,114,24960
wl 5
mw 36,8,4,68
ex 52,52
ex 53,53
ex 54,54
ex 55,55
pk 84,52,53
ex 56,56
ex 57,57
pk 85,54,55
ex 58,58
ex 59,59
pk 86,56,57
wl 3
pk 87,58,59
 s_nop 1
mw 92,28,84,92
ex 60,60
ex 61,61
ex 62,62
ex 63,63
pk 88,60,61
ex 64,64
ex 65,65
pk 89,62,63
ex 66,66
ex 67,67
pk 90,64,65
 s_nop 0
pk 91,66,67
 s_nop 1
mw 92,32,88,92
 s_cbranch_vccnz K2_pr24
 s_setprio 3
K2_pr24:
rq 16,109,26624
rq 28,110,26000
rq 32,114,26000
wl 5
mw 52,12,4,68
ex 36,36
ex 37,37
ex 38,38
ex 39,39
pk 84,36,37
ex 40,40
ex 41,41
pk 85,38,39
ex 42,42
ex 43,43
pk 86,40,41
wl 3
pk 87,42,43
 s_nop 1
mw 92,20,84,92
ex 44,44
ex 45,45
ex 46,46
ex 47,47
pk 88,44,45
ex 48,48
ex 49,49
pk 89,46,47
ex 50,50
ex 51,51
pk 90,48,49
 s_nop 0
pk 91,50,51
 s_nop 1
mw 92,24,88,92
rq 8,109,27648
rq 20,110,27040
rq 24,114,27040
wl 5
mw 36,16,4,68
ex 52,52
ex 53,53
ex 54,54
ex 55,55
pk 84,52,53
ex 56,56
ex 57,57
pk 85,54,55
ex 58,58
ex 59,59
pk 86,56,57
wl 3
pk 87,58,59
 s_nop 1
mw 92,28,84,92
ex 60,60
ex 61,61
ex 62,62
ex 63,63
pk 88,60,61
ex 64,64
ex 65,65
pk 89,62,63
ex 66,66
ex 67,67
pk 90,64,65
 s_nop 0
pk 91,66,67
 s_nop 1
mw 92,32,88,92
 s_cbranch_vccnz K2_pr26
 s_setprio 1
K2_pr26:
rq 12,109,28672
rq 28,110,28080
rq 32,114,28080
wl 5
mw 52,8,4,68
ex 36,36
ex 37,37
ex 38,38
ex 39,39
pk 84,36,37
ex 40,40
ex 41,41
pk 85,38,39
ex 42,42
ex 43,43
pk 86,40,41
wl 3
pk 87,42,43
 s_nop 1
mw 92,20,84,92
ex 44,44
ex 45,45
ex 46,46
ex 47,47
pk 88,44,45
ex 48,48
ex 49,49
pk 89,46,47
ex 50,50
ex 51,51
pk 90,48,49
 s_nop 0
pk 91,50,51
 s_nop 1
mw 92,24,88,92
 s_cbranch_vccnz K2_pr27
 s_setprio 3
K2_pr27:
rq 16,109,29696
rq 20,110,29120
rq 24,114,29120
wl 5
mw 36,12,4,68
ex 52,52
ex 53,53
ex 54,54
ex 55,55
pk 84,52,53
ex 56,56
ex 57,57
pk 85,54,55
ex 58,58
ex 59,59
pk 86,56,57
wl 3
pk 87,58,59
 s_nop 1
mw 92,28,84,92
ex 60,60
ex 61,61
ex 62,62
ex 63,63
pk 88,60,61
ex 64,64
ex 65,65
pk 89,62,63
ex 66,66
ex 67,67
pk 90,64,65
 s_nop 0
pk 91,66,67
 s_nop 1
mw 92,32,88,92
rq 8,109,30720
rq 28,110,30160
rq 32,114,30160
wl 5
mw 52,16,4,68
ex 36,36
ex 37,37
ex 38,38
ex 39,39
pk 84,36,37
ex 40,40
ex 41,41
pk 85,38,39
ex 42,42
ex 43,43
pk 86,40,41
wl 3
pk 87,42,43
 s_nop 1
mw 92,20,84,92
ex 44,44
ex 45,45
ex 46,46
ex 47,47
pk 88,44,45
ex 48,48
ex 49,49
pk 89,46,47
ex 50,50
ex 51,51
pk 90,48,49
 s_nop 0
pk 91,50,51
 s_nop 1
mw 92,24,88,92
 s_cbranch_vccnz K2_pr29
 s_setprio 1
K2_pr29:
rq 12,109,31744
rq 20,110,31200
rq 24,114,31200
wl 5
mw 36,8,4,68
ex 52,52
ex 53,53
ex 54,54
ex 55,55
pk 84,52,53
ex 56,56
ex 57,57
pk 85,54,55
ex 58,58
ex 59,59
pk 86,56,57
wl 3
pk 87,58,59
 s_nop 1
mw 92,28,84,92
ex 60,60
ex 61,61
ex 62,62
ex 63,63
pk 88,60,61
ex 64,64
ex 65,65
pk 89,62,63
ex 66,66
ex 67,67
pk 90,64,65
 s_nop 0
pk 91,66,67
 s_nop 1
mw 92,32,88,92
 s_cbranch_vccnz K2_pr30
 s_setprio 3
K2_pr30:
K2_poll30:
 ds_read_b32 v117, v115
wl 0
 v_readfirstlane_b32 s59, v117
 s_cmp_lt_u32 s59, 8
 s_cbranch_scc1 K2_poll30
rq 16,109,32768
rq 28,110,32240
rq 32,114,32240
wl 5
mw 52,12,4,68
ex 36,36
ex 37,37
ex 38,38
ex 39,39
pk 84,36,37
ex 40,40
ex 41,41
pk 85,38,39
ex 42,42
ex 43,43
pk 86,40,41
wl 3
pk 87,42,43
 s_nop 1
mw 92,20,84,92
ex 44,44
ex 45,45
ex 46,46
ex 47,47
pk 88,44,45
ex 48,48
ex 49,49
pk 89,46,47
ex 50,50
ex 51,51
pk 90,48,49
 s_nop 0
pk 91,50,51
 s_nop 1
mw 92,24,88,92
rq 8,109,33792
rq 20,110,33280
rq 24,114,33280
wl 5
mw 36,16,4,68
ex 52,52
ex 53,53
ex 54,54
ex 55,55
pk 84,52,53
ex 56,56
ex 57,57
pk 85,54,55
ex 58,58
ex 59,59
pk 86,56,57
wl 3
pk 87,58,59
 s_nop 1
mw 92,28,84,92
ex 60,60
ex 61,61
ex 62,62
ex 63,63
pk 88,60,61
ex 64,64
ex 65,65
pk 89,62,63
ex 66,66
ex 67,67
pk 90,64,65
 s_nop 0
pk 91,66,67
 s_nop 1
mw 92,32,88,92
 s_cbranch_vccnz K2_pr32
 s_setprio 1
K2_pr32:
rq 12,109,34816
rq 28,110,34320
rq 32,114,34320
wl 5
mw 52,8,4,68
ex 36,36
ex 37,37
ex 38,38
ex 39,39
pk 84,36,37
ex 40,40
ex 41,41
pk 85,38,39
ex 42,42
ex 43,43
pk 86,40,41
wl 3
pk 87,42,43
 s_nop 1
mw 92,20,84,92
ex 44,44
ex 45,45
ex 46,46
ex 47,47
pk 88,44,45
ex 48,48
ex 49,49
pk 89,46,47
ex 50,50
ex 51,51
pk 90,48,49
 s_nop 0
pk 91,50,51
 s_nop 1
mw 92,24,88,92
 s_cbranch_vccnz K2_pr33
 s_setprio 3
K2_pr33:
rq 16,109,35840
rq 20,110,35360
rq 24,114,35360
wl 5
mw 36,12,4,68
ex 52,52
ex 53,53
ex 54,54
ex 55,55
pk 84,52,53
ex 56,56
ex 57,57
pk 85,54,55
ex 58,58
ex 59,59
pk 86,56,57
wl 3
pk 87,58,59
 s_nop 1
mw 92,28,84,92
ex 60,60
ex 61,61
ex 62,62
ex 63,63
pk 88,60,61
ex 64,64
ex 65,65
pk 89,62,63
ex 66,66
ex 67,67
pk 90,64,65
 s_nop 0
pk 91,66,67
 s_nop 1
mw 92,32,88,92
rq 8,109,36864
rq 28,110,36400
rq 32,114,36400
wl 5
mw 52,16,4,68
ex 36,36
ex 37,37
ex 38,38
ex 39,39
pk 84,36,37
ex 40,40
ex 41,41
pk 85,38,39
ex 42,42
ex 43,43
pk 86,40,41
wl 3
pk 87,42,43
 s_nop 1
mw 92,20,84,92
ex 44,44
ex 45,45
ex 46,46
ex 47,47
pk 88,44,45
ex 48,48
ex 49,49
pk 89,46,47
ex 50,50
ex 51,51
pk 90,48,49
 s_nop 0
pk 91,50,51
 s_nop 1
mw 92,24,88,92
 s_cbranch_vccnz K2_pr35
 s_setprio 1
K2_pr35:
rq 12,109,37888
rq 20,110,37440
rq 24,114,37440
wl 5
mw 36,8,4,68
ex 52,52
ex 53,53
ex 54,54
ex 55,55
pk 84,52,53
ex 56,56
ex 57,57
pk 85,54,55
ex 58,58
ex 59,59
pk 86,56,57
wl 3
pk 87,58,59
 s_nop 1
mw 92,28,84,92
ex 60,60
ex 61,61
ex 62,62
ex 63,63
pk 88,60,61
ex 64,64
ex 65,65
pk 89,62,63
ex 66,66
ex 67,67
pk 90,64,65
 s_nop 0
pk 91,66,67
 s_nop 1
mw 92,32,88,92
 s_cbranch_vccnz K2_pr36
 s_setprio 3
K2_pr36:
rq 16,109,38912
rq 28,110,38480
rq 32,114,38480
wl 5
mw 52,12,4,68
ex 36,36
ex 37,37
ex 38,38
ex 39,39
pk 84,36,37
ex 40,40
ex 41,41
pk 85,38,39
ex 42,42
ex 43,43
pk 86,40,41
wl 3
pk 87,42,43
 s_nop 1
mw 92,20,84,92
ex 44,44
ex 45,45
ex 46,46
ex 47,47
pk 88,44,45
ex 48,48
ex 49,49
pk 89,46,47
ex 50,50
ex 51,51
pk 90,48,49
 s_nop 0
pk 91,50,51
 s_nop 1
mw 92,24,88,92
rq 8,109,39936
rq 20,110,39520
rq 24,114,39520
wl 5
mw 36,16,4,68
ex 52,52
ex 53,53
ex 54,54
ex 55,55
pk 84,52,53
ex 56,56
ex 57,57
pk 85,54,55
ex 58,58
ex 59,59
pk 86,56,57
wl 3
pk 87,58,59
 s_nop 1
mw 92,28,84,92
ex 60,60
ex 61,61
ex 62,62
ex 63,63
pk 88,60,61
ex 64,64
ex 65,65
pk 89,62,63
ex 66,66
ex 67,67
pk 90,64,65
 s_nop 0
pk 91,66,67
 s_nop 1
mw 92,32,88,92
 s_cbranch_vccnz K2_pr38
 s_setprio 1
K2_pr38:
rq 12,109,40960
rq 28,110,40560
rq 32,114,40560
wl 5
mw 52,8,4,68
ex 36,36
ex 37,37
ex 38,38
ex 39,39
pk 84,36,37
ex 40,40
ex 41,41
pk 85,38,39
ex 42,42
ex 43,43
pk 86,40,41
wl 3
pk 87,42,43
 s_nop 1
mw 92,20,84,92
ex 44,44
ex 45,45
ex 46,46
ex 47,47
pk 88,44,45
ex 48,48
ex 49,49
pk 89,46,47
ex 50,50
ex 51,51
pk 90,48,49
 s_nop 0
pk 91,50,51
 s_nop 1
mw 92,24,88,92
 s_cbranch_vccnz K2_pr39
 s_setprio 3
K2_pr39:
rq 16,109,41984
rq 20,110,41600
rq 24,114,41600
wl 5
mw 36,12,4,68
ex 52,52
ex 53,53
ex 54,54
ex 55,55
pk 84,52,53
ex 56,56
ex 57,57
pk 85,54,55
ex 58,58
ex 59,59
pk 86,56,57
wl 3
pk 87,58,59
 s_nop 1
mw 92,28,84,92
ex 60,60
ex 61,61
ex 62,62
ex 63,63
pk 88,60,61
ex 64,64
ex 65,65
pk 89,62,63
ex 66,66
ex 67,67
pk 90,64,65
 s_nop 0
pk 91,66,67
 s_nop 1
mw 92,32,88,92
rq 8,109,43008
rq 28,110,42640
rq 32,114,42640
wl 5
mw 52,16,4,68
ex 36,36
ex 37,37
ex 38,38
ex 39,39
pk 84,36,37
ex 40,40
ex 41,41
pk 85,38,39
ex 42,42
ex 43,43
pk 86,40,41
wl 3
pk 87,42,43
 s_nop 1
mw 92,20,84,92
ex 44,44
ex 45,45
ex 46,46
ex 47,47
pk 88,44,45
ex 48,48
ex 49,49
pk 89,46,47
ex 50,50
ex 51,51
pk 90,48,49
 s_nop 0
pk 91,50,51
 s_nop 1
mw 92,24,88,92
 s_cbranch_vccnz K2_pr41
 s_setprio 1
K2_pr41:
rq 12,109,44032
rq 20,110,43680
rq 24,114,43680
wl 5
mw 36,8,4,68
ex 52,52
ex 53,53
ex 54,54
ex 55,55
pk 84,52,53
ex 56,56
ex 57,57
pk 85,54,55
ex 58,58
ex 59,59
pk 86,56,57
wl 3
pk 87,58,59
 s_nop 1
mw 92,28,84,92
ex 60,60
ex 61,61
ex 62,62
ex 63,63
pk 88,60,61
ex 64,64
ex 65,65
pk 89,62,63
ex 66,66
ex 67,67
pk 90,64,65
 s_nop 0
pk 91,66,67
 s_nop 1
mw 92,32,88,92
 s_cbranch_vccnz K2_pr42
 s_setprio 3
K2_pr42:
rq 16,109,45056
rq 28,110,44720
rq 32,114,44720
wl 5
mw 52,12,4,68
ex 36,36
ex 37,37
ex 38,38
ex 39,39
pk 84,36,37
ex 40,40
ex 41,41
pk 85,38,39
ex 42,42
ex 43,43
pk 86,40,41
wl 3
pk 87,42,43
 s_nop 1
mw 92,20,84,92
ex 44,44
ex 45,45
ex 46,46
ex 47,47
pk 88,44,45
ex 48,48
ex 49,49
pk 89,46,47
ex 50,50
ex 51,51
pk 90,48,49
 s_nop 0
pk 91,50,51
 s_nop 1
mw 92,24,88,92
rq 8,109,46080
rq 20,110,45760
rq 24,114,45760
wl 5
mw 36,16,4,68
ex 52,52
ex 53,53
ex 54,54
ex 55,55
pk 84,52,53
ex 56,56
ex 57,57
pk 85,54,55
ex 58,58
ex 59,59
pk 86,56,57
wl 3
pk 87,58,59
 s_nop 1
mw 92,28,84,92
ex 60,60
ex 61,61
ex 62,62
ex 63,63
pk 88,60,61
ex 64,64
ex 65,65
pk 89,62,63
ex 66,66
ex 67,67
pk 90,64,65
 s_nop 0
pk 91,66,67
 s_nop 1
mw 92,32,88,92
 s_cbranch_vccnz K2_pr44
 s_setprio 1
K2_pr44:
rq 12,109,47104
rq 28,110,46800
rq 32,114,46800
wl 5
mw 52,8,4,68
ex 36,36
ex 37,37
ex 38,38
ex 39,39
pk 84,36,37
ex 40,40
ex 41,41
pk 85,38,39
ex 42,42
ex 43,43
pk 86,40,41
wl 3
pk 87,42,43
 s_nop 1
mw 92,20,84,92
ex 44,44
ex 45,45
ex 46,46
ex 47,47
pk 88,44,45
ex 48,48
ex 49,49
pk 89,46,47
ex 50,50
ex 51,51
pk 90,48,49
 s_nop 0
pk 91,50,51
 s_nop 1
mw 92,24,88,92
 s_cbranch_vccnz K2_pr45
 s_setprio 3
K2_pr45:
rq 16,109,48128
rq 20,110,47840
rq 24,114,47840
wl 5
mw 36,12,4,68
ex 52,52
ex 53,53
ex 54,54
ex 55,55
pk 84,52,53
ex 56,56
ex 57,57
pk 85,54,55
ex 58,58
ex 59,59
pk 86,56,57
wl 3
pk 87,58,59
 s_nop 1
mw 92,28,84,92
ex 60,60
ex 61,61
ex 62,62
ex 63,63
pk 88,60,61
ex 64,64
ex 65,65
pk 89,62,63
ex 66,66
ex 67,67
pk 90,64,65
 s_nop 0
pk 91,66,67
 s_nop 1
mw 92,32,88,92
rq 8,109,49152
rq 28,110,48880
rq 32,114,48880
wl 5
mw 52,16,4,68
ex 36,36
ex 37,37
ex 38,38
ex 39,39
pk 84,36,37
ex 40,40
ex 41,41
pk 85,38,39
ex 42,42
ex 43,43
pk 86,40,41
wl 3
pk 87,42,43
 s_nop 1
mw 92,20,84,92
ex 44,44
ex 45,45
ex 46,46
ex 47,47
pk 88,44,45
ex 48,48
ex 49,49
pk 89,46,47
ex 50,50
ex 51,51
pk 90,48,49
 s_nop 0
pk 91,50,51
 s_nop 1
mw 92,24,88,92
 s_cbranch_vccnz K2_pr47
 s_setprio 1
K2_pr47:
rq 12,109,50176
rq 20,110,49920
rq 24,114,49920
wl 5
mw 36,8,4,68
ex 52,52
ex 53,53
ex 54,54
ex 55,55
pk 84,52,53
ex 56,56
ex 57,57
pk 85,54,55
ex 58,58
ex 59,59
pk 86,56,57
wl 3
pk 87,58,59
 s_nop 1
mw 92,28,84,92
ex 60,60
ex 61,61
ex 62,62
ex 63,63
pk 88,60,61
ex 64,64
ex 65,65
pk 89,62,63
ex 66,66
ex 67,67
pk 90,64,65
 s_nop 0
pk 91,66,67
 s_nop 1
mw 92,32,88,92
 s_cbranch_vccnz K2_pr48
 s_setprio 3
K2_pr48:
rq 16,109,51200
rq 28,110,50960
rq 32,114,50960
wl 5
mw 52,12,4,68
ex 36,36
ex 37,37
ex 38,38
ex 39,39
pk 84,36,37
ex 40,40
ex 41,41
pk 85,38,39
ex 42,42
ex 43,43
pk 86,40,41
wl 3
pk 87,42,43
 s_nop 1
mw 92,20,84,92
ex 44,44
ex 45,45
ex 46,46
ex 47,47
pk 88,44,45
ex 48,48
ex 49,49
pk 89,46,47
ex 50,50
ex 51,51
pk 90,48,49
 s_nop 0
pk 91,50,51
 s_nop 1
mw 92,24,88,92
rq 8,109,52224
rq 20,110,52000
rq 24,114,52000
wl 5
mw 36,16,4,68
ex 52,52
ex 53,53
ex 54,54
ex 55,55
pk 84,52,53
ex 56,56
ex 57,57
pk 85,54,55
ex 58,58
ex 59,59
pk 86,56,57
wl 3
pk 87,58,59
 s_nop 1
mw 92,28,84,92
ex 60,60
ex 61,61
ex 62,62
ex 63,63
pk 88,60,61
ex 64,64
ex 65,65
pk 89,62,63
ex 66,66
ex 67,67
pk 90,64,65
 s_nop 0
pk 91,66,67
 s_nop 1
mw 92,32,88,92
 s_cbranch_vccnz K2_pr50
 s_setprio 1
K2_pr50:
rq 12,109,53248
rq 28,110,53040
rq 32,114,53040
wl 5
mw 52,8,4,68
ex 36,36
ex 37,37
ex 38,38
ex 39,39
pk 84,36,37
ex 40,40
ex 41,41
pk 85,38,39
ex 42,42
ex 43,43
pk 86,40,41
wl 3
pk 87,42,43
 s_nop 1
mw 92,20,84,92
ex 44,44
ex 45,45
ex 46,46
ex 47,47
pk 88,44,45
ex 48,48
ex 49,49
pk 89,46,47
ex 50,50
ex 51,51
pk 90,48,49
 s_nop 0
pk 91,50,51
 s_nop 1
mw 92,24,88,92
 s_cbranch_vccnz K2_pr51
 s_setprio 3
K2_pr51:
rq 16,109,54272
rq 20,110,54080
rq 24,114,54080
wl 5
mw 36,12,4,68
ex 52,52
ex 53,53
ex 54,54
ex 55,55
pk 84,52,53
ex 56,56
ex 57,57
pk 85,54,55
ex 58,58
ex 59,59
pk 86,56,57
wl 3
pk 87,58,59
 s_nop 1
mw 92,28,84,92
ex 60,60
ex 61,61
ex 62,62
ex 63,63
pk 88,60,61
ex 64,64
ex 65,65
pk 89,62,63
ex 66,66
ex 67,67
pk 90,64,65
 s_nop 0
pk 91,66,67
 s_nop 1
mw 92,32,88,92
rq 8,109,55296
rq 28,110,55120
rq 32,114,55120
wl 5
mw 52,16,4,68
ex 36,36
ex 37,37
ex 38,38
ex 39,39
pk 84,36,37
ex 40,40
ex 41,41
pk 85,38,39
ex 42,42
ex 43,43
pk 86,40,41
wl 3
pk 87,42,43
 s_nop 1
mw 92,20,84,92
ex 44,44
ex 45,45
ex 46,46
ex 47,47
pk 88,44,45
ex 48,48
ex 49,49
pk 89,46,47
ex 50,50
ex 51,51
pk 90,48,49
 s_nop 0
pk 91,50,51
 s_nop 1
mw 92,24,88,92
 s_cbranch_vccnz K2_pr53
 s_setprio 1
K2_pr53:
rq 12,109,56320
rq 20,110,56160
rq 24,114,56160
wl 5
mw 36,8,4,68
ex 52,52
ex 53,53
ex 54,54
ex 55,55
pk 84,52,53
ex 56,56
ex 57,57
pk 85,54,55
ex 58,58
ex 59,59
pk 86,56,57
wl 3
pk 87,58,59
 s_nop 1
mw 92,28,84,92
ex 60,60
ex 61,61
ex 62,62
ex 63,63
pk 88,60,61
ex 64,64
ex 65,65
pk 89,62,63
ex 66,66
ex 67,67
pk 90,64,65
 s_nop 0
pk 91,66,67
 s_nop 1
mw 92,32,88,92
 s_cbranch_vccnz K2_pr54
 s_setprio 3
K2_pr54:
rq 16,109,57344
rq 28,110,57200
rq 32,114,57200
wl 5
mw 52,12,4,68
ex 36,36
ex 37,37
ex 38,38
ex 39,39
pk 84,36,37
ex 40,40
ex 41,41
pk 85,38,39
ex 42,42
ex 43,43
pk 86,40,41
wl 3
pk 87,42,43
 s_nop 1
mw 92,20,84,92
ex 44,44
ex 45,45
ex 46,46
ex 47,47
pk 88,44,45
ex 48,48
ex 49,49
pk 89,46,47
ex 50,50
ex 51,51
pk 90,48,49
 s_nop 0
pk 91,50,51
 s_nop 1
mw 92,24,88,92
rq 8,109,58368
rq 20,110,58240
rq 24,114,58240
wl 5
mw 36,16,4,68
ex 52,52
ex 53,53
ex 54,54
ex 55,55
pk 84,52,53
ex 56,56
ex 57,57
pk 85,54,55
ex 58,58
ex 59,59
pk 86,56,57
wl 3
pk 87,58,59
 s_nop 1
mw 92,28,84,92
ex 60,60
ex 61,61
ex 62,62
ex 63,63
pk 88,60,61
ex 64,64
ex 65,65
pk 89,62,63
ex 66,66
ex 67,67
pk 90,64,65
 s_nop 0
pk 91,66,67
 s_nop 1
mw 92,32,88,92
 s_cbranch_vccnz K2_pr56
 s_setprio 1
K2_pr56:
 s_lshr_b32 s51, s2, 5
 s_lshr_b32 s53, s3, 1
 s_lshl_b32 s55, s53, 12
 s_add_u32 s55, s55, 20971520
 s_and_b32 s54, s53, 2
 s_add_u32 s54, s54, 0
 s_and_b32 s54, s54, 3
 s_lshl_b32 s56, s51, 2
 s_add_u32 s54, s54, s56
 s_mul_i32 s54, s54, 73728
 s_add_u32 s54, s54, s55
 buffer_load_dwordx4 v[118:121], v109, s[16:19], s54 offen offset:0
 buffer_load_dwordx4 v[122:125], v109, s[16:19], s54 offen offset:1024
 buffer_load_dwordx4 v[126:129], v109, s[16:19], s54 offen offset:2048
 buffer_load_dwordx4 v[130:133], v109, s[16:19], s54 offen offset:3072
 s_and_b32 s54, s53, 2
 s_add_u32 s54, s54, 1
 s_and_b32 s54, s54, 3
 s_lshl_b32 s56, s51, 2
 s_add_u32 s54, s54, s56
 s_mul_i32 s54, s54, 73728
 s_add_u32 s54, s54, s55
 buffer_load_dwordx4 v[134:137], v109, s[16:19], s54 offen offset:0
 buffer_load_dwordx4 v[138:141], v109, s[16:19], s54 offen offset:1024
 buffer_load_dwordx4 v[142:145], v109, s[16:19], s54 offen offset:2048
 buffer_load_dwordx4 v[146:149], v109, s[16:19], s54 offen offset:3072
 s_and_b32 s54, s53, 2
 s_add_u32 s54, s54, 2
 s_and_b32 s54, s54, 3
 s_lshl_b32 s56, s51, 2
 s_add_u32 s54, s54, s56
 s_mul_i32 s54, s54, 73728
 s_add_u32 s54, s54, s55
 buffer_load_dwordx4 v[150:153], v109, s[16:19], s54 offen offset:0
 buffer_load_dwordx4 v[154:157], v109, s[16:19], s54 offen offset:1024
 buffer_load_dwordx4 v[158:161], v109, s[16:19], s54 offen offset:2048
 buffer_load_dwordx4 v[162:165], v109, s[16:19], s54 offen offset:3072
rq 12,109,59392
rq 28,110,59280
rq 32,114,59280
wl 5
mw 52,8,4,68
ex 36,36
ex 37,37
ex 38,38
ex 39,39
pk 84,36,37
ex 40,40
ex 41,41
pk 85,38,39
ex 42,42
ex 43,43
pk 86,40,41
wl 3
pk 87,42,43
 s_nop 1
mw 92,20,84,92
ex 44,44
ex 45,45
ex 46,46
ex 47,47
pk 88,44,45
ex 48,48
ex 49,49
pk 89,46,47
ex 50,50
ex 51,51
pk 90,48,49
 s_nop 0
pk 91,50,51
 s_nop 1
mw 92,24,88,92
 s_cbranch_vccnz K2_pr57
 s_setprio 3
K2_pr57:
rq 16,109,60416
rq 20,110,60320
rq 24,114,60320
wl 5
mw 36,12,4,68
ex 52,52
ex 53,53
ex 54,54
ex 55,55
pk 84,52,53
ex 56,56
ex 57,57
pk 85,54,55
ex 58,58
ex 59,59
pk 86,56,57
wl 3
pk 87,58,59
 s_nop 1
mw 92,28,84,92
ex 60,60
ex 61,61
ex 62,62
ex 63,63
pk 88,60,61
ex 64,64
ex 65,65
pk 89,62,63
ex 66,66
ex 67,67
pk 90,64,65
 s_nop 0
pk 91,66,67
 s_nop 1
mw 92,32,88,92
rq 8,109,61440
rq 28,110,61360
rq 32,114,61360
wl 5
mw 52,16,4,68
ex 36,36
ex 37,37
ex 38,38
ex 39,39
pk 84,36,37
ex 40,40
ex 41,41
pk 85,38,39
ex 42,42
ex 43,43
pk 86,40,41
wl 3
pk 87,42,43
 s_nop 1
mw 92,20,84,92
ex 44,44
ex 45,45
ex 46,46
ex 47,47
pk 88,44,45
ex 48,48
ex 49,49
pk 89,46,47
ex 50,50
ex 51,51
pk 90,48,49
 s_nop 0
pk 91,50,51
 s_nop 1
mw 92,24,88,92
 s_cbranch_vccnz K2_pr59
 s_setprio 1
K2_pr59:
rq 12,109,62464
rq 20,110,62400
rq 24,114,62400
wl 5
mw 36,8,4,68
ex 52,52
ex 53,53
ex 54,54
ex 55,55
pk 84,52,53
ex 56,56
ex 57,57
pk 85,54,55
ex 58,58
ex 59,59
pk 86,56,57
wl 3
pk 87,58,59
 s_nop 1
mw 92,28,84,92
ex 60,60
ex 61,61
ex 62,62
ex 63,63
pk 88,60,61
ex 64,64
ex 65,65
pk 89,62,63
ex 66,66
ex 67,67
pk 90,64,65
 s_nop 0
pk 91,66,67
 s_nop 1
mw 92,32,88,92
 s_cbranch_vccnz K2_pr60
 s_setprio 3
K2_pr60:
rq 16,109,63488
rq 28,110,63440
rq 32,114,63440
wl 5
mw 52,12,4,68
ex 36,36
ex 37,37
ex 38,38
ex 39,39
pk 84,36,37
ex 40,40
ex 41,41
pk 85,38,39
ex 42,42
ex 43,43
pk 86,40,41
wl 3
pk 87,42,43
 s_nop 1
mw 92,20,84,92
ex 44,44
ex 45,45
ex 46,46
ex 47,47
pk 88,44,45
ex 48,48
ex 49,49
pk 89,46,47
ex 50,50
ex 51,51
pk 90,48,49
 s_nop 0
pk 91,50,51
 s_nop 1
mw 92,24,88,92
rq 8,109,64512
rq 20,110,64480
rq 24,114,64480
wl 5
mw 36,16,4,68
ex 52,52
ex 53,53
ex 54,54
ex 55,55
pk 84,52,53
ex 56,56
ex 57,57
pk 85,54,55
ex 58,58
ex 59,59
pk 86,56,57
wl 3
pk 87,58,59
 s_nop 1
mw 92,28,84,92
ex 60,60
ex 61,61
ex 62,62
ex 63,63
pk 88,60,61
ex 64,64
ex 65,65
pk 89,62,63
ex 66,66
ex 67,67
pk 90,64,65
 s_nop 0
pk 91,66,67
 s_nop 1
mw 92,32,88,92
 s_cbranch_vccnz K2_pr62
 s_setprio 1
K2_pr62:
rq 28,110,65520
rq 32,114,65520
wl 4
mw 52,8,4,68
ex 36,36
ex 37,37
ex 38,38
ex 39,39
pk 84,36,37
ex 40,40
ex 41,41
pk 85,38,39
ex 42,42
ex 43,43
pk 86,40,41
wl 2
pk 87,42,43
 s_nop 1
mw 92,20,84,92
ex 44,44
ex 45,45
ex 46,46
ex 47,47
pk 88,44,45
ex 48,48
ex 49,49
pk 89,46,47
ex 50,50
ex 51,51
pk 90,48,49
 s_nop 0
pk 91,50,51
 s_nop 1
mw 92,24,88,92
 s_cbranch_vccnz K2_pr63
 s_setprio 3
K2_pr63:
ex 52,52
ex 53,53
ex 54,54
ex 55,55
pk 84,52,53
ex 56,56
ex 57,57
pk 85,54,55
ex 58,58
ex 59,59
pk 86,56,57
wl 0
pk 87,58,59
 s_nop 1
mw 92,28,84,92
ex 60,60
ex 61,61
ex 62,62
ex 63,63
pk 88,60,61
ex 64,64
ex 65,65
pk 89,62,63
ex 66,66
ex 67,67
pk 90,64,65
 s_nop 0
pk 91,66,67
 s_nop 1
mw 92,32,88,92
 s_nop 7
 s_nop 7
 v_cmp_ngt_f32 vcc, 0x7b800000, v100
 s_movk_i32 s59, 0x207
 v_cmp_class_f32 s[60:61], v92, s59
 s_or_b64 vcc, vcc, s[60:61]
 v_cmp_class_f32 s[60:61], v93, s59
 s_or_b64 vcc, vcc, s[60:61]
 v_cmp_class_f32 s[60:61], v94, s59
 s_or_b64 vcc, vcc, s[60:61]
 v_cmp_class_f32 s[60:61], v95, s59
 s_or_b64 vcc, vcc, s[60:61]
 v_cmp_class_f32 s[60:61], v96, s59
 s_or_b64 vcc, vcc, s[60:61]
 v_cmp_class_f32 s[60:61], v97, s59
 s_or_b64 vcc, vcc, s[60:61]
 v_cmp_class_f32 s[60:61], v98, s59
 s_or_b64 vcc, vcc, s[60:61]
 v_cmp_class_f32 s[60:61], v99, s59
 s_or_b64 vcc, vcc, s[60:61]
 s_cbranch_vccz K2_ok
 s_cmp_lg_u32 s58, 0
 s_cbranch_scc1 K2_ok
 s_mov_b32 s58, 1
 s_movk_i32 s59, 64
 v_mov_b32 v111, v109
 v_mov_b32 v112, 0xff800000
 v_mov_b32 v113, 0xff800000
K2_slow:
 ds_read_b128 v[8:11], v111
wl 0
 v_mfma_f32_32x32x16_bf16 v[36:51], v[8:11], v[4:7], 0
 v_add_u32 v111, 1024, v111
 s_nop 7
 s_nop 7
 v_max3_f32 v112, v36, v37, v112
 v_max3_f32 v113, v38, v39, v113
 v_max3_f32 v112, v40, v41, v112
 v_max3_f32 v113, v42, v43, v113
 v_max3_f32 v112, v44, v45, v112
 v_max3_f32 v113, v46, v47, v113
 v_max3_f32 v112, v48, v49, v112
 v_max3_f32 v113, v50, v51, v113
 s_sub_u32 s59, s59, 1
 s_cmp_lg_u32 s59, 0
 s_cbranch_scc1 K2_slow
 v_mov_b32 v111, 0
 s_branch K2_setmax
K2_ok:
 s_and_b32 s50, s2, 7
 s_lshl_b32 s50, s50, 2
 s_lshr_b32 s51, s2, 3
 s_and_b32 s51, s51, 3
 s_add_u32 s50, s50, s51
 s_lshr_b32 s51, s2, 5
 s_and_b32 s52, s3, 1
 s_lshr_b32 s53, s3, 1
 v_lshlrev_b32 v10, 4, v1
 s_lshr_b32 s51, s2, 5
 s_lshr_b32 s53, s3, 1
 s_lshl_b32 s55, s53, 12
 s_add_u32 s55, s55, 20971520
 s_and_b32 s54, s53, 2
 s_add_u32 s54, s54, 3
 s_and_b32 s54, s54, 3
 s_lshl_b32 s56, s51, 2
 s_add_u32 s54, s54, s56
 s_mul_i32 s54, s54, 73728
 s_add_u32 s54, s54, s55
 buffer_load_dwordx4 v[20:23], v109, s[16:19], s54 offen offset:0
 buffer_load_dwordx4 v[24:27], v109, s[16:19], s54 offen offset:1024
 buffer_load_dwordx4 v[28:31], v109, s[16:19], s54 offen offset:2048
 buffer_load_dwordx4 v[32:35], v109, s[16:19], s54 offen offset:3072
 v_rcp_f32 v4, v100
 s_nop 0
 v_mul_f32 v92, v92, v4
 v_mul_f32 v93, v93, v4
 v_mul_f32 v94, v94, v4
 v_mul_f32 v95, v95, v4
 v_mul_f32 v96, v96, v4
 v_mul_f32 v97, v97, v4
 v_mul_f32 v98, v98, v4
 v_mul_f32 v99, v99, v4
pk 84,92,93
pk 85,94,95
pk 86,96,97
pk 87,98,99
 v_lshrrev_b32 v5, 4, v2
 v_lshlrev_b32 v5, 14, v5
 v_and_b32 v6, 15, v2
 v_lshl_add_u32 v5, v6, 4, v5
 v_permlane32_swap_b32 v84, v86
 v_permlane32_swap_b32 v85, v87
 v_lshl_add_u32 v5, v3, 8, v5
 s_lshl_b32 s45, s43, 10
 s_lshl_b32 s46, s42, 9
 s_add_u32 s45, s45, s46
 s_add_u32 s45, s45, 14680064
 buffer_store_dwordx4 v[84:87], v5, s[16:19], s45 offen sc1
 v_mov_b32 v7, 148488
 v_mov_b32 v8, 1
 s_lshl_b32 s57, s51, 13
 s_add_u32 s57, s57, 16777216
 v_lshlrev_b32 v6, 8, v1
 s_and_b32 s54, s2, 7
 s_lshl_b32 s54, s54, 5
 s_lshr_b32 s56, s2, 3
 s_add_u32 s54, s54, s56
 s_lshl_b32 s54, s54, 8
 s_add_u32 s54, s54, 16777216
 v_mov_b32 v9, s54
 s_and_b32 s44, s53, 1
 s_lshl_b32 s47, s52, 1
 s_add_u32 s44, s44, s47
 s_lshl_b32 s46, s50, 2
 s_add_u32 s46, s46, s44
 s_lshl_b32 s46, s46, 14
 s_lshl_b32 s47, s53, 12
 s_add_u32 s46, s46, s47
 s_add_u32 s46, s46, 14680064
 s_xor_b32 s47, s46, 16384
 s_and_b32 s54, s53, 2
 s_lshl_b32 s54, s54, 2
 s_add_u32 s54, s54, s44
 s_lshl_b32 s54, s54, 10
 s_add_u32 s54, s54, 132096
 v_add_u32 v11, s54, v10
 s_xor_b32 s54, s53, 0
 s_lshl_b32 s54, s54, 1
 s_add_u32 s54, s54, s52
 s_mul_i32 s54, s54, 6144
 v_add_u32 v12, s54, v10
 s_xor_b32 s54, s53, 1
 s_lshl_b32 s54, s54, 1
 s_add_u32 s54, s54, s52
 s_mul_i32 s54, s54, 6144
 v_add_u32 v13, s54, v10
 s_xor_b32 s54, s53, 2
 s_lshl_b32 s54, s54, 1
 s_add_u32 s54, s54, s52
 s_mul_i32 s54, s54, 6144
 v_add_u32 v14, s54, v10
 s_xor_b32 s54, s53, 3
 s_lshl_b32 s54, s54, 1
 s_add_u32 s54, s54, s52
 s_mul_i32 s54, s54, 6144
 v_add_u32 v15, s54, v10
 s_lshl_b32 s54, s50, 6
 s_lshl_b32 s56, s44, 4
 s_add_u32 s54, s54, s56
 v_and_b32 v16, 15, v1
 v_add_u32 v16, s54, v16
 v_lshlrev_b32 v16, 10, v16
 v_bfe_u32 v17, v1, 4, 1
 v_lshl_add_u32 v16, v17, 5, v16
 v_lshl_add_u32 v16, v3, 4, v16
 s_lshl_b32 s48, s51, 7
 s_and_b32 s54, s53, 2
 s_lshl_b32 s54, s54, 5
 s_add_u32 s48, s48, s54
 s_waitcnt vmcnt(0)
 s_mov_b64 exec, 1
 ds_add_rtn_u32 v17, v7, v8
wl 0
 v_readfirstlane_b32 s54, v17
 s_cmp_lg_u32 s54, 7
 s_cbranch_scc1 K2_bar
 s_mov_b32 exec_lo, -1
 s_mov_b32 exec_hi, 0
 buffer_atomic_add v8, v6, s[16:19], s57 offen sc1
 s_mov_b64 exec, 1
 s_mov_b32 s55, 0x100000
 buffer_load_dword v68, v9, s[16:19], 0 offen sc1
 buffer_load_dword v69, v9, s[16:19], 0 offen sc1
 buffer_load_dword v70, v9, s[16:19], 0 offen sc1
K2_gp:
 buffer_load_dword v71, v9, s[16:19], 0 offen sc1
 s_waitcnt vmcnt(3)
 v_readfirstlane_b32 s54, v68
 s_cmp_ge_u32 s54, 32
 s_cbranch_scc1 K2_bar
 buffer_load_dword v68, v9, s[16:19], 0 offen sc1
 s_waitcnt vmcnt(3)
 v_readfirstlane_b32 s54, v69
 s_cmp_ge_u32 s54, 32
 s_cbranch_scc1 K2_bar
 buffer_load_dword v69, v9, s[16:19], 0 offen sc1
 s_waitcnt vmcnt(3)
 v_readfirstlane_b32 s54, v70
 s_cmp_ge_u32 s54, 32
 s_cbranch_scc1 K2_bar
 buffer_load_dword v70, v9, s[16:19], 0 offen sc1
 s_waitcnt vmcnt(3)
 v_readfirstlane_b32 s54, v71
 s_cmp_ge_u32 s54, 32
 s_cbranch_scc1 K2_bar
 s_sub_u32 s55, s55, 1
 s_cmp_lg_u32 s55, 0
 s_cbranch_scc1 K2_gp
K2_bar:
 s_mov_b64 exec, -1
 s_barrier
 buffer_load_dwordx4 v[36:39], v10, s[16:19], s46 offen offset:0 sc1
 buffer_load_dwordx4 v[40:43], v10, s[16:19], s47 offen offset:0 sc1
 buffer_load_dwordx4 v[44:47], v10, s[16:19], s46 offen offset:1024 sc1
 buffer_load_dwordx4 v[48:51], v10, s[16:19], s47 offen offset:1024 sc1
 buffer_load_dwordx4 v[52:55], v10, s[16:19], s46 offen offset:2048 sc1
 buffer_load_dwordx4 v[56:59], v10, s[16:19], s47 offen offset:2048 sc1
 buffer_load_dwordx4 v[60:63], v10, s[16:19], s46 offen offset:3072 sc1
 buffer_load_dwordx4 v[64:67], v10, s[16:19], s47 offen offset:3072 sc1
rq 84,11,0
rq 92,11,4096
wl 0
 s_waitcnt vmcnt(7)
 v_mfma_f32_16x16x32_bf16 v[100:103], v[150:153], v[36:39], 0
 v_mfma_f32_16x16x32_bf16 v[108:111], v[20:23], v[36:39], 0
mg 84,v,118,v,36,84
mg 92,v,134,v,36,92
 s_waitcnt vmcnt(6)
 v_mfma_f32_16x16x32_bf16 v[104:107], v[150:153], v[40:43], 0
 v_mfma_f32_16x16x32_bf16 v[112:115], v[20:23], v[40:43], 0
 v_mfma_f32_16x16x32_bf16 v[88:91], v[118:121], v[40:43], 0
 v_mfma_f32_16x16x32_bf16 v[96:99], v[134:137], v[40:43], 0
 s_waitcnt vmcnt(5)
mg 100,v,154,v,44,100
mg 108,v,24,v,44,108
mg 84,v,122,v,44,84
mg 92,v,138,v,44,92
 s_waitcnt vmcnt(4)
mg 104,v,154,v,48,104
mg 112,v,24,v,48,112
mg 88,v,122,v,48,88
mg 96,v,138,v,48,96
 s_waitcnt vmcnt(3)
mg 100,v,158,v,52,100
mg 108,v,28,v,52,108
mg 84,v,126,v,52,84
mg 92,v,142,v,52,92
 s_waitcnt vmcnt(2)
mg 104,v,158,v,56,104
mg 112,v,28,v,56,112
mg 88,v,126,v,56,88
mg 96,v,142,v,56,96
 s_waitcnt vmcnt(1)
mg 100,v,162,v,60,100
mg 108,v,32,v,60,108
mg 84,v,130,v,60,84
mg 92,v,146,v,60,92
 s_waitcnt vmcnt(0)
mg 104,v,162,v,64,104
mg 112,v,32,v,64,112
mg 88,v,130,v,64,88
mg 96,v,146,v,64,96
 s_nop 7
 ds_write_b128 v14, v[100:103] offset:2048
 ds_write_b128 v14, v[108:111] offset:3072
 ds_write_b128 v15, v[104:107] offset:4096
 ds_write_b128 v15, v[112:115] offset:5120
 ds_write_b128 v13, v[88:91] offset:0
 ds_write_b128 v13, v[96:99] offset:1024
wl 0
 s_barrier
rq 20,12,0
rq 24,12,2048
rq 28,12,4096
rq 32,12,1024
rq 36,12,3072
rq 40,12,5120
wl 5
 v_add_f32 v84, v84, v20
 v_add_f32 v85, v85, v21
 v_add_f32 v86, v86, v22
 v_add_f32 v87, v87, v23
wl 4
 v_add_f32 v84, v84, v24
 v_add_f32 v85, v85, v25
 v_add_f32 v86, v86, v26
 v_add_f32 v87, v87, v27
wl 3
 v_add_f32 v84, v84, v28
 v_add_f32 v85, v85, v29
 v_add_f32 v86, v86, v30
 v_add_f32 v87, v87, v31
pk 100,84,85
pk 101,86,87
wl 2
 v_add_f32 v92, v92, v32
 v_add_f32 v93, v93, v33
 v_add_f32 v94, v94, v34
 v_add_f32 v95, v95, v35
wl 1
 v_add_f32 v92, v92, v36
 v_add_f32 v93, v93, v37
 v_add_f32 v94, v94, v38
 v_add_f32 v95, v95, v39
wl 0
 v_add_f32 v92, v92, v40
 v_add_f32 v93, v93, v41
 v_add_f32 v94, v94, v42
 v_add_f32 v95, v95, v43
pk 102,92,93
pk 103,94,95
 s_nop 1
 v_permlane16_swap_b32 v100, v102
 v_permlane16_swap_b32 v101, v103
 buffer_store_dwordx4 v[100:103], v16, s[12:15], s48 offen sc1
K2_exit:
 s_endpgm
K2_ffn:
 s_and_b32 s42, s2, 7
 s_lshl_b32 s42, s42, 2
 s_lshr_b32 s43, s2, 3
 s_and_b32 s43, s43, 3
 s_add_u32 s42, s42, s43
 s_lshl_b32 s42, s42, 6
 s_lshr_b32 s43, s2, 5
 s_lshl_b32 s43, s43, 6
 v_lshrrev_b32 v2, 4, v1
 v_and_b32 v3, 15, v1
 s_sub_u32 s44, s3, 8
 s_mul_i32 s45, s44, 14
 v_lshlrev_b32 v4, 4, v1
 s_lshr_b32 s46, s42, 4
 s_mul_i32 s46, s46, 56
 s_add_u32 s46, s46, s45
 s_lshl_b32 s46, s46, 10
 s_add_u32 s46, s46, 6291456
 v_add_u32 v5, s46, v4
 s_lshr_b32 s46, s43, 4
 s_mul_i32 s46, s46, 72
 s_add_u32 s46, s46, s45
 s_lshl_b32 s46, s46, 10
 s_add_u32 s46, s46, 20987904
 v_add_u32 v4, s46, v4
 s_mov_b32 s52, 57344
 s_mov_b32 s55, 73728
 s_mov_b32 s53, 114688
 s_mov_b32 s56, 147456
 s_mov_b32 s54, 172032
 s_mov_b32 s57, 221184
 v_mov_b32 v8, 0
 v_mov_b32 v9, 0
 v_mov_b32 v10, 0
 v_mov_b32 v11, 0
 v_mov_b32 v7, 148480
 ds_write_b128 v7, v[8:11]
 s_and_b32 s60, s2, 7
 s_lshr_b32 s61, s2, 3
 s_and_b32 s61, s61, 3
 s_lshl_b32 s61, s61, 3
 s_add_u32 s60, s60, s61
 s_lshl_b32 s60, s60, 16
 s_lshl_b32 s61, s3, 10
 s_add_u32 s62, s60, s61
 s_add_u32 s63, s62, 4194304
 s_add_u32 s62, s62, 2097152
 s_mul_i32 s59, s3, 1040
 s_add_u32 s59, s59, 65536
 v_and_b32 v10, 31, v1
 v_lshrrev_b32 v11, 5, v1
 v_lshlrev_b32 v10, 5, v10
 v_lshl_add_u32 v10, v11, 4, v10
 v_lshlrev_b32 v11, 4, v1
 v_mov_b32 v12, 148484
 v_mov_b32 v13, 1
wl 0
 s_barrier
 s_setprio 3
 s_add_u32 m0, s61, 0
 s_nop 0
 buffer_load_dwordx4 v10, s[16:19], s62 offen lds
 s_add_u32 s62, s62, 4096
 s_add_u32 m0, s59, 0
 s_nop 0
 buffer_load_dwordx4 v11, s[16:19], s63 offen lds
 s_add_u32 s63, s63, 4096
 s_add_u32 m0, s61, 4096
 s_nop 0
 buffer_load_dwordx4 v10, s[16:19], s62 offen lds
 s_add_u32 s62, s62, 4096
 s_add_u32 m0, s59, 4160
 s_nop 0
 buffer_load_dwordx4 v11, s[16:19], s63 offen lds
 s_add_u32 s63, s63, 4096
 s_add_u32 m0, s61, 8192
 s_nop 0
 buffer_load_dwordx4 v10, s[16:19], s62 offen lds
 s_add_u32 s62, s62, 4096
 s_add_u32 m0, s59, 8320
 s_nop 0
 buffer_load_dwordx4 v11, s[16:19], s63 offen lds
 s_add_u32 s63, s63, 4096
 s_add_u32 m0, s61, 12288
 s_nop 0
 buffer_load_dwordx4 v10, s[16:19], s62 offen lds
 s_add_u32 s62, s62, 4096
 s_add_u32 m0, s59, 12480
 s_nop 0
 buffer_load_dwordx4 v11, s[16:19], s63 offen lds
 s_add_u32 s63, s63, 4096
 s_add_u32 m0, s61, 16384
 s_nop 0
 buffer_load_dwordx4 v10, s[16:19], s62 offen lds
 s_add_u32 s62, s62, 4096
 s_add_u32 m0, s59, 16640
 s_nop 0
 buffer_load_dwordx4 v11, s[16:19], s63 offen lds
 s_add_u32 s63, s63, 4096
 s_add_u32 m0, s61, 20480
 s_nop 0
 buffer_load_dwordx4 v10, s[16:19], s62 offen lds
 s_add_u32 s62, s62, 4096
 s_add_u32 m0, s59, 20800
 s_nop 0
 buffer_load_dwordx4 v11, s[16:19], s63 offen lds
 s_add_u32 s63, s63, 4096
 s_add_u32 m0, s61, 24576
 s_nop 0
 buffer_load_dwordx4 v10, s[16:19], s62 offen lds
 s_add_u32 s62, s62, 4096
 s_add_u32 m0, s59, 24960
 s_nop 0
 buffer_load_dwordx4 v11, s[16:19], s63 offen lds
 s_add_u32 s63, s63, 4096
 s_add_u32 m0, s61, 28672
 s_nop 0
 buffer_load_dwordx4 v10, s[16:19], s62 offen lds
 s_add_u32 s62, s62, 4096
 s_add_u32 m0, s59, 29120
 s_nop 0
 buffer_load_dwordx4 v11, s[16:19], s63 offen lds
 s_add_u32 s63, s63, 4096
 s_add_u32 m0, s61, 32768
 s_nop 0
 buffer_load_dwordx4 v10, s[16:19], s62 offen lds
 s_add_u32 s62, s62, 4096
 s_add_u32 m0, s59, 33280
 s_nop 0
 buffer_load_dwordx4 v11, s[16:19], s63 offen lds
 s_add_u32 s63, s63, 4096
 s_add_u32 m0, s61, 36864
 s_nop 0
 buffer_load_dwordx4 v10, s[16:19], s62 offen lds
 s_add_u32 s62, s62, 4096
 s_add_u32 m0, s59, 37440
 s_nop 0
 buffer_load_dwordx4 v11, s[16:19], s63 offen lds
 s_add_u32 s63, s63, 4096
 s_add_u32 m0, s61, 40960
 s_nop 0
 buffer_load_dwordx4 v10, s[16:19], s62 offen lds
 s_add_u32 s62, s62, 4096
 s_add_u32 m0, s59, 41600
 s_nop 0
 buffer_load_dwordx4 v11, s[16:19], s63 offen lds
 s_add_u32 s63, s63, 4096
 s_add_u32 m0, s61, 45056
 s_nop 0
 buffer_load_dwordx4 v10, s[16:19], s62 offen lds
 s_add_u32 s62, s62, 4096
 s_add_u32 m0, s59, 45760
 s_nop 0
 buffer_load_dwordx4 v11, s[16:19], s63 offen lds
 s_add_u32 s63, s63, 4096
 s_add_u32 m0, s61, 49152
 s_nop 0
 buffer_load_dwordx4 v10, s[16:19], s62 offen lds
 s_add_u32 s62, s62, 4096
 s_add_u32 m0, s59, 49920
 s_nop 0
 buffer_load_dwordx4 v11, s[16:19], s63 offen lds
 s_add_u32 s63, s63, 4096
 s_add_u32 m0, s61, 53248
 s_nop 0
 buffer_load_dwordx4 v10, s[16:19], s62 offen lds
 s_add_u32 s62, s62, 4096
 s_add_u32 m0, s59, 54080
 s_nop 0
 buffer_load_dwordx4 v11, s[16:19], s63 offen lds
 s_add_u32 s63, s63, 4096
 s_waitcnt vmcnt(16)
 s_mov_b64 exec, 1
 ds_add_u32 v12, v13
 s_mov_b64 exec, -1
 s_setprio 0
 buffer_load_dwordx4 v[136:139], v4, s[16:19], 0 offen offset:0
 buffer_load_dwordx4 v[140:143], v4, s[16:19], 0 offen offset:1024
 buffer_load_dwordx4 v[72:75], v5, s[16:19], 0 offen offset:0
 buffer_load_dwordx4 v[76:79], v5, s[16:19], 0 offen offset:1024
 buffer_load_dwordx4 v[80:83], v5, s[16:19], s52 offen offset:0
 buffer_load_dwordx4 v[84:87], v5, s[16:19], s52 offen offset:1024
 buffer_load_dwordx4 v[88:91], v5, s[16:19], s53 offen offset:0
 buffer_load_dwordx4 v[92:95], v5, s[16:19], s53 offen offset:1024
 buffer_load_dwordx4 v[96:99], v5, s[16:19], s54 offen offset:0
 buffer_load_dwordx4 v[100:103], v5, s[16:19], s54 offen offset:1024
 v_add_u32 v5, 2048, v5
 buffer_load_dwordx4 v[144:147], v4, s[16:19], s55 offen offset:0
 buffer_load_dwordx4 v[148:151], v4, s[16:19], s55 offen offset:1024
 buffer_load_dwordx4 v[152:155], v4, s[16:19], s56 offen offset:0
 buffer_load_dwordx4 v[156:159], v4, s[16:19], s56 offen offset:1024
 buffer_load_dwordx4 v[160:163], v4, s[16:19], s57 offen offset:0
 buffer_load_dwordx4 v[164:167], v4, s[16:19], s57 offen offset:1024
 v_add_u32 v4, 2048, v4
 buffer_load_dwordx4 v[104:107], v5, s[16:19], 0 offen offset:0
 buffer_load_dwordx4 v[108:111], v5, s[16:19], 0 offen offset:1024
 buffer_load_dwordx4 v[112:115], v5, s[16:19], s52 offen offset:0
 buffer_load_dwordx4 v[116:119], v5, s[16:19], s52 offen offset:1024
 buffer_load_dwordx4 v[120:123], v5, s[16:19], s53 offen offset:0
 buffer_load_dwordx4 v[124:127], v5, s[16:19], s53 offen offset:1024
 buffer_load_dwordx4 v[128:131], v5, s[16:19], s54 offen offset:0
 buffer_load_dwordx4 v[132:135], v5, s[16:19], s54 offen offset:1024
 v_add_u32 v5, 2048, v5
 s_waitcnt vmcnt(14)
 s_mov_b64 exec, 1
 ds_add_u32 v12, v13
 s_mov_b64 exec, -1
 v_mfma_f32_16x16x32_bf16 v[8:11], v[136:139], v[72:75], 0
 v_mfma_f32_16x16x32_bf16 v[12:15], v[136:139], v[80:83], 0
 v_mfma_f32_16x16x32_bf16 v[16:19], v[136:139], v[88:91], 0
 v_mfma_f32_16x16x32_bf16 v[20:23], v[136:139], v[96:99], 0
mg 8,v,140,v,76,8
mg 12,v,140,v,84,12
mg 16,v,140,v,92,16
mg 20,v,140,v,100,20
 buffer_load_dwordx4 v[136:139], v4, s[16:19], 0 offen offset:0
 buffer_load_dwordx4 v[140:143], v4, s[16:19], 0 offen offset:1024
 s_waitcnt vmcnt(14)
 v_mfma_f32_16x16x32_bf16 v[24:27], v[144:147], v[72:75], 0
 v_mfma_f32_16x16x32_bf16 v[28:31], v[144:147], v[80:83], 0
 v_mfma_f32_16x16x32_bf16 v[32:35], v[144:147], v[88:91], 0
 v_mfma_f32_16x16x32_bf16 v[36:39], v[144:147], v[96:99], 0
mg 24,v,148,v,76,24
mg 28,v,148,v,84,28
mg 32,v,148,v,92,32
mg 36,v,148,v,100,36
 buffer_load_dwordx4 v[144:147], v4, s[16:19], s55 offen offset:0
 buffer_load_dwordx4 v[148:151], v4, s[16:19], s55 offen offset:1024
 s_waitcnt vmcnt(14)
 v_mfma_f32_16x16x32_bf16 v[40:43], v[152:155], v[72:75], 0
 v_mfma_f32_16x16x32_bf16 v[44:47], v[152:155], v[80:83], 0
 v_mfma_f32_16x16x32_bf16 v[48:51], v[152:155], v[88:91], 0
 v_mfma_f32_16x16x32_bf16 v[52:55], v[152:155], v[96:99], 0
mg 40,v,156,v,76,40
mg 44,v,156,v,84,44
mg 48,v,156,v,92,48
mg 52,v,156,v,100,52
 buffer_load_dwordx4 v[152:155], v4, s[16:19], s56 offen offset:0
 buffer_load_dwordx4 v[156:159], v4, s[16:19], s56 offen offset:1024
 s_waitcnt vmcnt(14)
 v_mfma_f32_16x16x32_bf16 v[56:59], v[160:163], v[72:75], 0
 v_mfma_f32_16x16x32_bf16 v[60:63], v[160:163], v[80:83], 0
 v_mfma_f32_16x16x32_bf16 v[64:67], v[160:163], v[88:91], 0
 v_mfma_f32_16x16x32_bf16 v[68:71], v[160:163], v[96:99], 0
mg 56,v,164,v,76,56
mg 60,v,164,v,84,60
mg 64,v,164,v,92,64
mg 68,v,164,v,100,68
 buffer_load_dwordx4 v[160:163], v4, s[16:19], s57 offen offset:0
 buffer_load_dwordx4 v[164:167], v4, s[16:19], s57 offen offset:1024
 v_add_u32 v4, 2048, v4
 buffer_load_dwordx4 v[72:75], v5, s[16:19], 0 offen offset:0
 buffer_load_dwordx4 v[76:79], v5, s[16:19], 0 offen offset:1024
 buffer_load_dwordx4 v[80:83], v5, s[16:19], s52 offen offset:0
 buffer_load_dwordx4 v[84:87], v5, s[16:19], s52 offen offset:1024
 buffer_load_dwordx4 v[88:91], v5, s[16:19], s53 offen offset:0
 buffer_load_dwordx4 v[92:95], v5, s[16:19], s53 offen offset:1024
 buffer_load_dwordx4 v[96:99], v5, s[16:19], s54 offen offset:0
 buffer_load_dwordx4 v[100:103], v5, s[16:19], s54 offen offset:1024
 v_add_u32 v5, 2048, v5
 s_waitcnt vmcnt(14)
mg 8,v,136,v,104,8
mg 12,v,136,v,112,12
mg 16,v,136,v,120,16
mg 20,v,136,v,128,20
mg 8,v,140,v,108,8
mg 12,v,140,v,116,12
mg 16,v,140,v,124,16
mg 20,v,140,v,132,20
 buffer_load_dwordx4 v[136:139], v4, s[16:19], 0 offen offset:0
 buffer_load_dwordx4 v[140:143], v4, s[16:19], 0 offen offset:1024
 s_waitcnt vmcnt(14)
mg 24,v,144,v,104,24
mg 28,v,144,v,112,28
mg 32,v,144,v,120,32
mg 36,v,144,v,128,36
mg 24,v,148,v,108,24
mg 28,v,148,v,116,28
mg 32,v,148,v,124,32
mg 36,v,148,v,132,36
 buffer_load_dwordx4 v[144:147], v4, s[16:19], s55 offen offset:0
 buffer_load_dwordx4 v[148:151], v4, s[16:19], s55 offen offset:1024
 s_waitcnt vmcnt(14)
mg 40,v,152,v,104,40
mg 44,v,152,v,112,44
mg 48,v,152,v,120,48
mg 52,v,152,v,128,52
mg 40,v,156,v,108,40
mg 44,v,156,v,116,44
mg 48,v,156,v,124,48
mg 52,v,156,v,132,52
 buffer_load_dwordx4 v[152:155], v4, s[16:19], s56 offen offset:0
 buffer_load_dwordx4 v[156:159], v4, s[16:19], s56 offen offset:1024
 s_waitcnt vmcnt(14)
mg 56,v,160,v,104,56
mg 60,v,160,v,112,60
mg 64,v,160,v,120,64
mg 68,v,160,v,128,68
mg 56,v,164,v,108,56
mg 60,v,164,v,116,60
mg 64,v,164,v,124,64
mg 68,v,164,v,132,68
 buffer_load_dwordx4 v[160:163], v4, s[16:19], s57 offen offset:0
 buffer_load_dwordx4 v[164:167], v4, s[16:19], s57 offen offset:1024
 v_add_u32 v4, 2048, v4
 buffer_load_dwordx4 v[104:107], v5, s[16:19], 0 offen offset:0
 buffer_load_dwordx4 v[108:111], v5, s[16:19], 0 offen offset:1024
 buffer_load_dwordx4 v[112:115], v5, s[16:19], s52 offen offset:0
 buffer_load_dwordx4 v[116:119], v5, s[16:19], s52 offen offset:1024
 buffer_load_dwordx4 v[120:123], v5, s[16:19], s53 offen offset:0
 buffer_load_dwordx4 v[124:127], v5, s[16:19], s53 offen offset:1024
 buffer_load_dwordx4 v[128:131], v5, s[16:19], s54 offen offset:0
 buffer_load_dwordx4 v[132:135], v5, s[16:19], s54 offen offset:1024
 v_add_u32 v5, 2048, v5
 s_waitcnt vmcnt(14)
mg 8,v,136,v,72,8
mg 12,v,136,v,80,12
mg 16,v,136,v,88,16
mg 20,v,136,v,96,20
mg 8,v,140,v,76,8
mg 12,v,140,v,84,12
mg 16,v,140,v,92,16
mg 20,v,140,v,100,20
 buffer_load_dwordx4 v[136:139], v4, s[16:19], 0 offen offset:0
 buffer_load_dwordx4 v[140:143], v4, s[16:19], 0 offen offset:1024
 s_waitcnt vmcnt(14)
mg 24,v,144,v,72,24
mg 28,v,144,v,80,28
mg 32,v,144,v,88,32
mg 36,v,144,v,96,36
mg 24,v,148,v,76,24
mg 28,v,148,v,84,28
mg 32,v,148,v,92,32
mg 36,v,148,v,100,36
 buffer_load_dwordx4 v[144:147], v4, s[16:19], s55 offen offset:0
 buffer_load_dwordx4 v[148:151], v4, s[16:19], s55 offen offset:1024
 s_waitcnt vmcnt(14)
mg 40,v,152,v,72,40
mg 44,v,152,v,80,44
mg 48,v,152,v,88,48
mg 52,v,152,v,96,52
mg 40,v,156,v,76,40
mg 44,v,156,v,84,44
mg 48,v,156,v,92,48
mg 52,v,156,v,100,52
 buffer_load_dwordx4 v[152:155], v4, s[16:19], s56 offen offset:0
 buffer_load_dwordx4 v[156:159], v4, s[16:19], s56 offen offset:1024
 s_waitcnt vmcnt(14)
mg 56,v,160,v,72,56
mg 60,v,160,v,80,60
mg 64,v,160,v,88,64
mg 68,v,160,v,96,68
mg 56,v,164,v,76,56
mg 60,v,164,v,84,60
mg 64,v,164,v,92,64
mg 68,v,164,v,100,68
 buffer_load_dwordx4 v[160:163], v4, s[16:19], s57 offen offset:0
 buffer_load_dwordx4 v[164:167], v4, s[16:19], s57 offen offset:1024
 v_add_u32 v4, 2048, v4
 buffer_load_dwordx4 v[72:75], v5, s[16:19], 0 offen offset:0
 buffer_load_dwordx4 v[76:79], v5, s[16:19], 0 offen offset:1024
 buffer_load_dwordx4 v[80:83], v5, s[16:19], s52 offen offset:0
 buffer_load_dwordx4 v[84:87], v5, s[16:19], s52 offen offset:1024
 buffer_load_dwordx4 v[88:91], v5, s[16:19], s53 offen offset:0
 buffer_load_dwordx4 v[92:95], v5, s[16:19], s53 offen offset:1024
 buffer_load_dwordx4 v[96:99], v5, s[16:19], s54 offen offset:0
 buffer_load_dwordx4 v[100:103], v5, s[16:19], s54 offen offset:1024
 v_add_u32 v5, 2048, v5
 s_waitcnt vmcnt(14)
mg 8,v,136,v,104,8
mg 12,v,136,v,112,12
mg 16,v,136,v,120,16
mg 20,v,136,v,128,20
mg 8,v,140,v,108,8
mg 12,v,140,v,116,12
mg 16,v,140,v,124,16
mg 20,v,140,v,132,20
 buffer_load_dwordx4 v[136:139], v4, s[16:19], 0 offen offset:0
 buffer_load_dwordx4 v[140:143], v4, s[16:19], 0 offen offset:1024
 s_waitcnt vmcnt(14)
mg 24,v,144,v,104,24
mg 28,v,144,v,112,28
mg 32,v,144,v,120,32
mg 36,v,144,v,128,36
mg 24,v,148,v,108,24
mg 28,v,148,v,116,28
mg 32,v,148,v,124,32
mg 36,v,148,v,132,36
 buffer_load_dwordx4 v[144:147], v4, s[16:19], s55 offen offset:0
 buffer_load_dwordx4 v[148:151], v4, s[16:19], s55 offen offset:1024
 s_waitcnt vmcnt(14)
mg 40,v,152,v,104,40
mg 44,v,152,v,112,44
mg 48,v,152,v,120,48
mg 52,v,152,v,128,52
mg 40,v,156,v,108,40
mg 44,v,156,v,116,44
mg 48,v,156,v,124,48
mg 52,v,156,v,132,52
 buffer_load_dwordx4 v[152:155], v4, s[16:19], s56 offen offset:0
 buffer_load_dwordx4 v[156:159], v4, s[16:19], s56 offen offset:1024
 s_waitcnt vmcnt(14)
mg 56,v,160,v,104,56
mg 60,v,160,v,112,60
mg 64,v,160,v,120,64
mg 68,v,160,v,128,68
mg 56,v,164,v,108,56
mg 60,v,164,v,116,60
mg 64,v,164,v,124,64
mg 68,v,164,v,132,68
 buffer_load_dwordx4 v[160:163], v4, s[16:19], s57 offen offset:0
 buffer_load_dwordx4 v[164:167], v4, s[16:19], s57 offen offset:1024
 v_add_u32 v4, 2048, v4
 buffer_load_dwordx4 v[104:107], v5, s[16:19], 0 offen offset:0
 buffer_load_dwordx4 v[108:111], v5, s[16:19], 0 offen offset:1024
 buffer_load_dwordx4 v[112:115], v5, s[16:19], s52 offen offset:0
 buffer_load_dwordx4 v[116:119], v5, s[16:19], s52 offen offset:1024
 buffer_load_dwordx4 v[120:123], v5, s[16:19], s53 offen offset:0
 buffer_load_dwordx4 v[124:127], v5, s[16:19], s53 offen offset:1024
 buffer_load_dwordx4 v[128:131], v5, s[16:19], s54 offen offset:0
 buffer_load_dwordx4 v[132:135], v5, s[16:19], s54 offen offset:1024
 v_add_u32 v5, 2048, v5
 s_waitcnt vmcnt(14)
mg 8,v,136,v,72,8
mg 12,v,136,v,80,12
mg 16,v,136,v,88,16
mg 20,v,136,v,96,20
mg 8,v,140,v,76,8
mg 12,v,140,v,84,12
mg 16,v,140,v,92,16
mg 20,v,140,v,100,20
 buffer_load_dwordx4 v[136:139], v4, s[16:19], 0 offen offset:0
 buffer_load_dwordx4 v[140:143], v4, s[16:19], 0 offen offset:1024
 s_waitcnt vmcnt(14)
mg 24,v,144,v,72,24
mg 28,v,144,v,80,28
mg 32,v,144,v,88,32
mg 36,v,144,v,96,36
mg 24,v,148,v,76,24
mg 28,v,148,v,84,28
mg 32,v,148,v,92,32
mg 36,v,148,v,100,36
 buffer_load_dwordx4 v[144:147], v4, s[16:19], s55 offen offset:0
 buffer_load_dwordx4 v[148:151], v4, s[16:19], s55 offen offset:1024
 s_waitcnt vmcnt(14)
mg 40,v,152,v,72,40
mg 44,v,152,v,80,44
mg 48,v,152,v,88,48
mg 52,v,152,v,96,52
mg 40,v,156,v,76,40
mg 44,v,156,v,84,44
mg 48,v,156,v,92,48
mg 52,v,156,v,100,52
 buffer_load_dwordx4 v[152:155], v4, s[16:19], s56 offen offset:0
 buffer_load_dwordx4 v[156:159], v4, s[16:19], s56 offen offset:1024
 s_waitcnt vmcnt(14)
mg 56,v,160,v,72,56
mg 60,v,160,v,80,60
mg 64,v,160,v,88,64
mg 68,v,160,v,96,68
mg 56,v,164,v,76,56
mg 60,v,164,v,84,60
mg 64,v,164,v,92,64
mg 68,v,164,v,100,68
 buffer_load_dwordx4 v[160:163], v4, s[16:19], s57 offen offset:0
 buffer_load_dwordx4 v[164:167], v4, s[16:19], s57 offen offset:1024
 v_add_u32 v4, 2048, v4
 buffer_load_dwordx4 v[72:75], v5, s[16:19], 0 offen offset:0
 buffer_load_dwordx4 v[76:79], v5, s[16:19], 0 offen offset:1024
 buffer_load_dwordx4 v[80:83], v5, s[16:19], s52 offen offset:0
 buffer_load_dwordx4 v[84:87], v5, s[16:19], s52 offen offset:1024
 buffer_load_dwordx4 v[88:91], v5, s[16:19], s53 offen offset:0
 buffer_load_dwordx4 v[92:95], v5, s[16:19], s53 offen offset:1024
 buffer_load_dwordx4 v[96:99], v5, s[16:19], s54 offen offset:0
 buffer_load_dwordx4 v[100:103], v5, s[16:19], s54 offen offset:1024
 v_add_u32 v5, 2048, v5
 s_waitcnt vmcnt(14)
mg 8,v,136,v,104,8
mg 12,v,136,v,112,12
mg 16,v,136,v,120,16
mg 20,v,136,v,128,20
mg 8,v,140,v,108,8
mg 12,v,140,v,116,12
mg 16,v,140,v,124,16
mg 20,v,140,v,132,20
 buffer_load_dwordx4 v[136:139], v4, s[16:19], 0 offen offset:0
 buffer_load_dwordx4 v[140:143], v4, s[16:19], 0 offen offset:1024
 s_waitcnt vmcnt(14)
mg 24,v,144,v,104,24
mg 28,v,144,v,112,28
mg 32,v,144,v,120,32
mg 36,v,144,v,128,36
mg 24,v,148,v,108,24
mg 28,v,148,v,116,28
mg 32,v,148,v,124,32
mg 36,v,148,v,132,36
 buffer_load_dwordx4 v[144:147], v4, s[16:19], s55 offen offset:0
 buffer_load_dwordx4 v[148:151], v4, s[16:19], s55 offen offset:1024
 s_waitcnt vmcnt(14)
mg 40,v,152,v,104,40
mg 44,v,152,v,112,44
mg 48,v,152,v,120,48
mg 52,v,152,v,128,52
mg 40,v,156,v,108,40
mg 44,v,156,v,116,44
mg 48,v,156,v,124,48
mg 52,v,156,v,132,52
 buffer_load_dwordx4 v[152:155], v4, s[16:19], s56 offen offset:0
 buffer_load_dwordx4 v[156:159], v4, s[16:19], s56 offen offset:1024
 s_waitcnt vmcnt(14)
mg 56,v,160,v,104,56
mg 60,v,160,v,112,60
mg 64,v,160,v,120,64
mg 68,v,160,v,128,68
mg 56,v,164,v,108,56
mg 60,v,164,v,116,60
mg 64,v,164,v,124,64
mg 68,v,164,v,132,68
 buffer_load_dwordx4 v[160:163], v4, s[16:19], s57 offen offset:0
 buffer_load_dwordx4 v[164:167], v4, s[16:19], s57 offen offset:1024
 v_add_u32 v4, 2048, v4
 s_waitcnt vmcnt(6)
mg 8,v,136,v,72,8
mg 12,v,136,v,80,12
mg 16,v,136,v,88,16
mg 20,v,136,v,96,20
mg 8,v,140,v,76,8
mg 12,v,140,v,84,12
mg 16,v,140,v,92,16
mg 20,v,140,v,100,20
 s_waitcnt vmcnt(4)
mg 24,v,144,v,72,24
mg 28,v,144,v,80,28
mg 32,v,144,v,88,32
mg 36,v,144,v,96,36
mg 24,v,148,v,76,24
mg 28,v,148,v,84,28
mg 32,v,148,v,92,32
mg 36,v,148,v,100,36
 s_waitcnt vmcnt(2)
mg 40,v,152,v,72,40
mg 44,v,152,v,80,44
mg 48,v,152,v,88,48
mg 52,v,152,v,96,52
mg 40,v,156,v,76,40
mg 44,v,156,v,84,44
mg 48,v,156,v,92,48
mg 52,v,156,v,100,52
 s_waitcnt vmcnt(0)
mg 56,v,160,v,72,56
mg 60,v,160,v,80,60
mg 64,v,160,v,88,64
mg 68,v,160,v,96,68
mg 56,v,164,v,76,56
mg 60,v,164,v,84,60
mg 64,v,164,v,92,64
mg 68,v,164,v,100,68
 s_setprio 3
 v_lshlrev_b32 v6, 4, v1
 v_add_u32 v6, 132096, v6
 v_mov_b32 v7, 148480
 s_cmp_eq_u32 s44, 0
 s_cbranch_scc1 K2_chain_w
 s_cmp_lg_u32 s44, 3
 s_cbranch_scc1 K2_poll
 v_add_u32 v4, s42, v3
 v_lshlrev_b32 v4, 10, v4
 v_lshl_add_u32 v4, v2, 3, v4
 s_lshl_b32 s45, s43, 1
 buffer_load_dwordx2 v[136:137], v4, s[8:11], s45 offen offset:0
 buffer_load_dwordx2 v[144:145], v4, s[8:11], s45 offen offset:32
 buffer_load_dwordx2 v[152:153], v4, s[8:11], s45 offen offset:64
 buffer_load_dwordx2 v[160:161], v4, s[8:11], s45 offen offset:96
 s_add_u32 s45, s45, 16384
 buffer_load_dwordx2 v[138:139], v4, s[8:11], s45 offen offset:0
 buffer_load_dwordx2 v[146:147], v4, s[8:11], s45 offen offset:32
 buffer_load_dwordx2 v[154:155], v4, s[8:11], s45 offen offset:64
 buffer_load_dwordx2 v[162:163], v4, s[8:11], s45 offen offset:96
 s_add_u32 s45, s45, 16384
 buffer_load_dwordx2 v[140:141], v4, s[8:11], s45 offen offset:0
 buffer_load_dwordx2 v[148:149], v4, s[8:11], s45 offen offset:32
 buffer_load_dwordx2 v[156:157], v4, s[8:11], s45 offen offset:64
 buffer_load_dwordx2 v[164:165], v4, s[8:11], s45 offen offset:96
 s_add_u32 s45, s45, 16384
 buffer_load_dwordx2 v[142:143], v4, s[8:11], s45 offen offset:0
 buffer_load_dwordx2 v[150:151], v4, s[8:11], s45 offen offset:32
 buffer_load_dwordx2 v[158:159], v4, s[8:11], s45 offen offset:64
 buffer_load_dwordx2 v[166:167], v4, s[8:11], s45 offen offset:96
 s_add_u32 s45, s45, 16384
K2_poll:
 s_sleep 2
 ds_read_b32 v72, v7
wl 0
 v_readfirstlane_b32 s45, v72
 s_cmp_lg_u32 s45, s44
 s_cbranch_scc1 K2_poll
rq 72,6,0
rq 76,6,1024
rq 80,6,2048
rq 84,6,3072
rq 88,6,4096
rq 92,6,5120
rq 96,6,6144
rq 100,6,7168
rq 104,6,8192
rq 108,6,9216
rq 112,6,10240
rq 116,6,11264
rq 120,6,12288
rq 124,6,13312
rq 128,6,14336
rq 132,6,15360
wl 15
 v_add_f32 v8, v8, v72
 v_add_f32 v9, v9, v73
 v_add_f32 v10, v10, v74
 v_add_f32 v11, v11, v75
wl 14
 v_add_f32 v12, v12, v76
 v_add_f32 v13, v13, v77
 v_add_f32 v14, v14, v78
 v_add_f32 v15, v15, v79
wl 13
 v_add_f32 v16, v16, v80
 v_add_f32 v17, v17, v81
 v_add_f32 v18, v18, v82
 v_add_f32 v19, v19, v83
wl 12
 v_add_f32 v20, v20, v84
 v_add_f32 v21, v21, v85
 v_add_f32 v22, v22, v86
 v_add_f32 v23, v23, v87
wl 11
 v_add_f32 v24, v24, v88
 v_add_f32 v25, v25, v89
 v_add_f32 v26, v26, v90
 v_add_f32 v27, v27, v91
wl 10
 v_add_f32 v28, v28, v92
 v_add_f32 v29, v29, v93
 v_add_f32 v30, v30, v94
 v_add_f32 v31, v31, v95
wl 9
 v_add_f32 v32, v32, v96
 v_add_f32 v33, v33, v97
 v_add_f32 v34, v34, v98
 v_add_f32 v35, v35, v99
wl 8
 v_add_f32 v36, v36, v100
 v_add_f32 v37, v37, v101
 v_add_f32 v38, v38, v102
 v_add_f32 v39, v39, v103
wl 7
 v_add_f32 v40, v40, v104
 v_add_f32 v41, v41, v105
 v_add_f32 v42, v42, v106
 v_add_f32 v43, v43, v107
wl 6
 v_add_f32 v44, v44, v108
 v_add_f32 v45, v45, v109
 v_add_f32 v46, v46, v110
 v_add_f32 v47, v47, v111
wl 5
 v_add_f32 v48, v48, v112
 v_add_f32 v49, v49, v113
 v_add_f32 v50, v50, v114
 v_add_f32 v51, v51, v115
wl 4
 v_add_f32 v52, v52, v116
 v_add_f32 v53, v53, v117
 v_add_f32 v54, v54, v118
 v_add_f32 v55, v55, v119
wl 3
 v_add_f32 v56, v56, v120
 v_add_f32 v57, v57, v121
 v_add_f32 v58, v58, v122
 v_add_f32 v59, v59, v123
wl 2
 v_add_f32 v60, v60, v124
 v_add_f32 v61, v61, v125
 v_add_f32 v62, v62, v126
 v_add_f32 v63, v63, v127
wl 1
 v_add_f32 v64, v64, v128
 v_add_f32 v65, v65, v129
 v_add_f32 v66, v66, v130
 v_add_f32 v67, v67, v131
wl 0
 v_add_f32 v68, v68, v132
 v_add_f32 v69, v69, v133
 v_add_f32 v70, v70, v134
 v_add_f32 v71, v71, v135
 s_cmp_eq_u32 s44, 3
 s_cbranch_scc1 K2_chain_end
K2_chain_w:
 s_nop 7
 ds_write_b128 v6, v[8:11] offset:0
 ds_write_b128 v6, v[12:15] offset:1024
 ds_write_b128 v6, v[16:19] offset:2048
 ds_write_b128 v6, v[20:23] offset:3072
 ds_write_b128 v6, v[24:27] offset:4096
 ds_write_b128 v6, v[28:31] offset:5120
 ds_write_b128 v6, v[32:35] offset:6144
 ds_write_b128 v6, v[36:39] offset:7168
 ds_write_b128 v6, v[40:43] offset:8192
 ds_write_b128 v6, v[44:47] offset:9216
 ds_write_b128 v6, v[48:51] offset:10240
 ds_write_b128 v6, v[52:55] offset:11264
 ds_write_b128 v6, v[56:59] offset:12288
 ds_write_b128 v6, v[60:63] offset:13312
 ds_write_b128 v6, v[64:67] offset:14336
 ds_write_b128 v6, v[68:71] offset:15360
 s_add_u32 s45, s44, 1
 v_mov_b32 v72, s45
wl 0
 ds_write_b32 v7, v72
wl 0
 s_branch K2_exit2
K2_chain_end:
 s_waitcnt vmcnt(0)
 v_lshlrev_b32 v72, 16, v136
 v_add_f32 v8, v8, v72
 v_and_b32 v136, 0xffff0000, v136
 v_add_f32 v9, v9, v136
 v_lshlrev_b32 v72, 16, v137
 v_add_f32 v10, v10, v72
 v_and_b32 v137, 0xffff0000, v137
 v_add_f32 v11, v11, v137
 ds_write_b128 v6, v[8:11] offset:0
 v_lshlrev_b32 v72, 16, v138
 v_add_f32 v12, v12, v72
 v_and_b32 v138, 0xffff0000, v138
 v_add_f32 v13, v13, v138
 v_lshlrev_b32 v72, 16, v139
 v_add_f32 v14, v14, v72
 v_and_b32 v139, 0xffff0000, v139
 v_add_f32 v15, v15, v139
 ds_write_b128 v6, v[12:15] offset:1024
 v_lshlrev_b32 v72, 16, v140
 v_add_f32 v16, v16, v72
 v_and_b32 v140, 0xffff0000, v140
 v_add_f32 v17, v17, v140
 v_lshlrev_b32 v72, 16, v141
 v_add_f32 v18, v18, v72
 v_and_b32 v141, 0xffff0000, v141
 v_add_f32 v19, v19, v141
 ds_write_b128 v6, v[16:19] offset:2048
 v_lshlrev_b32 v72, 16, v142
 v_add_f32 v20, v20, v72
 v_and_b32 v142, 0xffff0000, v142
 v_add_f32 v21, v21, v142
 v_lshlrev_b32 v72, 16, v143
 v_add_f32 v22, v22, v72
 v_and_b32 v143, 0xffff0000, v143
 v_add_f32 v23, v23, v143
 ds_write_b128 v6, v[20:23] offset:3072
 v_lshlrev_b32 v72, 16, v144
 v_add_f32 v24, v24, v72
 v_and_b32 v144, 0xffff0000, v144
 v_add_f32 v25, v25, v144
 v_lshlrev_b32 v72, 16, v145
 v_add_f32 v26, v26, v72
 v_and_b32 v145, 0xffff0000, v145
 v_add_f32 v27, v27, v145
 ds_write_b128 v6, v[24:27] offset:4096
 v_lshlrev_b32 v72, 16, v146
 v_add_f32 v28, v28, v72
 v_and_b32 v146, 0xffff0000, v146
 v_add_f32 v29, v29, v146
 v_lshlrev_b32 v72, 16, v147
 v_add_f32 v30, v30, v72
 v_and_b32 v147, 0xffff0000, v147
 v_add_f32 v31, v31, v147
 ds_write_b128 v6, v[28:31] offset:5120
 v_lshlrev_b32 v72, 16, v148
 v_add_f32 v32, v32, v72
 v_and_b32 v148, 0xffff0000, v148
 v_add_f32 v33, v33, v148
 v_lshlrev_b32 v72, 16, v149
 v_add_f32 v34, v34, v72
 v_and_b32 v149, 0xffff0000, v149
 v_add_f32 v35, v35, v149
 ds_write_b128 v6, v[32:35] offset:6144
 v_lshlrev_b32 v72, 16, v150
 v_add_f32 v36, v36, v72
 v_and_b32 v150, 0xffff0000, v150
 v_add_f32 v37, v37, v150
 v_lshlrev_b32 v72, 16, v151
 v_add_f32 v38, v38, v72
 v_and_b32 v151, 0xffff0000, v151
 v_add_f32 v39, v39, v151
 ds_write_b128 v6, v[36:39] offset:7168
 v_lshlrev_b32 v72, 16, v152
 v_add_f32 v40, v40, v72
 v_and_b32 v152, 0xffff0000, v152
 v_add_f32 v41, v41, v152
 v_lshlrev_b32 v72, 16, v153
 v_add_f32 v42, v42, v72
 v_and_b32 v153, 0xffff0000, v153
 v_add_f32 v43, v43, v153
 ds_write_b128 v6, v[40:43] offset:8192
 v_lshlrev_b32 v72, 16, v154
 v_add_f32 v44, v44, v72
 v_and_b32 v154, 0xffff0000, v154
 v_add_f32 v45, v45, v154
 v_lshlrev_b32 v72, 16, v155
 v_add_f32 v46, v46, v72
 v_and_b32 v155, 0xffff0000, v155
 v_add_f32 v47, v47, v155
 ds_write_b128 v6, v[44:47] offset:9216
 v_lshlrev_b32 v72, 16, v156
 v_add_f32 v48, v48, v72
 v_and_b32 v156, 0xffff0000, v156
 v_add_f32 v49, v49, v156
 v_lshlrev_b32 v72, 16, v157
 v_add_f32 v50, v50, v72
 v_and_b32 v157, 0xffff0000, v157
 v_add_f32 v51, v51, v157
 ds_write_b128 v6, v[48:51] offset:10240
 v_lshlrev_b32 v72, 16, v158
 v_add_f32 v52, v52, v72
 v_and_b32 v158, 0xffff0000, v158
 v_add_f32 v53, v53, v158
 v_lshlrev_b32 v72, 16, v159
 v_add_f32 v54, v54, v72
 v_and_b32 v159, 0xffff0000, v159
 v_add_f32 v55, v55, v159
 ds_write_b128 v6, v[52:55] offset:11264
 v_lshlrev_b32 v72, 16, v160
 v_add_f32 v56, v56, v72
 v_and_b32 v160, 0xffff0000, v160
 v_add_f32 v57, v57, v160
 v_lshlrev_b32 v72, 16, v161
 v_add_f32 v58, v58, v72
 v_and_b32 v161, 0xffff0000, v161
 v_add_f32 v59, v59, v161
 ds_write_b128 v6, v[56:59] offset:12288
 v_lshlrev_b32 v72, 16, v162
 v_add_f32 v60, v60, v72
 v_and_b32 v162, 0xffff0000, v162
 v_add_f32 v61, v61, v162
 v_lshlrev_b32 v72, 16, v163
 v_add_f32 v62, v62, v72
 v_and_b32 v163, 0xffff0000, v163
 v_add_f32 v63, v63, v163
 ds_write_b128 v6, v[60:63] offset:13312
 v_lshlrev_b32 v72, 16, v164
 v_add_f32 v64, v64, v72
 v_and_b32 v164, 0xffff0000, v164
 v_add_f32 v65, v65, v164
 v_lshlrev_b32 v72, 16, v165
 v_add_f32 v66, v66, v72
 v_and_b32 v165, 0xffff0000, v165
 v_add_f32 v67, v67, v165
 ds_write_b128 v6, v[64:67] offset:14336
 v_lshlrev_b32 v72, 16, v166
 v_add_f32 v68, v68, v72
 v_and_b32 v166, 0xffff0000, v166
 v_add_f32 v69, v69, v166
 v_lshlrev_b32 v72, 16, v167
 v_add_f32 v70, v70, v72
 v_and_b32 v167, 0xffff0000, v167
 v_add_f32 v71, v71, v167
 ds_write_b128 v6, v[68:71] offset:15360
wl 0
K2_exit2:
 s_endpgm
.section .rodata,"a"
.p2align 6
.amdhsa_kernel k1_kernel
  .amdhsa_next_free_vgpr 384
  .amdhsa_next_free_sgpr 64
  .amdhsa_accum_offset 256
  .amdhsa_group_segment_fixed_size 0
  .amdhsa_kernarg_size 72
  .amdhsa_user_sgpr_count 2
  .amdhsa_user_sgpr_kernarg_segment_ptr 1
  .amdhsa_system_sgpr_workgroup_id_x 1
.end_amdhsa_kernel
.p2align 6
.amdhsa_kernel k2_kernel
  .amdhsa_next_free_vgpr 168
  .amdhsa_next_free_sgpr 96
  .amdhsa_accum_offset 168
  .amdhsa_group_segment_fixed_size 0
  .amdhsa_kernarg_size 72
  .amdhsa_user_sgpr_count 2
  .amdhsa_user_sgpr_kernarg_segment_ptr 1
  .amdhsa_system_sgpr_workgroup_id_x 1
.end_amdhsa_kernel
```
